```python
import torch

def _softmax(x, axis=-1):
    return torch.softmax(x, dim=axis)
def _gelu(x):
    return torch.nn.functional.gelu(x, approximate="tanh")
def _silu(x):
    return torch.nn.functional.silu(x)
def _sigmoid(x):
    return torch.sigmoid(x)
def _layernorm(x, axis=-1, eps=1e-5):
    m = x.mean(dim=axis, keepdim=True)
    v = x.var(dim=axis, keepdim=True, unbiased=False)
    return (x - m) / torch.sqrt(v + eps)
def _scatter_add(tgt, idx, src, axis=0):
    return tgt.clone().index_add_(axis, idx, src)
def _segment_sum(src, seg, n):
    out = torch.zeros((n,) + src.shape[1:], dtype=src.dtype)
    return out.index_add_(0, seg, src)
def _pad(x, pw):
    flat = tuple(v for pair in reversed(pw) for v in pair)
    return torch.nn.functional.pad(x, flat)

kernel_name = 'sequential_preLN__ssm_conv_h3__glu_gated_reglu__prompt'

def setup_inputs():

    _w = (lambda a: (lambda t: t.to(torch.bfloat16) if t.is_floating_point() else t)(torch.as_tensor(a)))
    def _A_setup():
        B, S, D = 1, 2048, 640
        ks = 4
        return {
            "q": _w((lambda *s: torch.randn(*s, dtype=torch.bfloat16) * 0.05)(B, S, D)),
            "k": _w((lambda *s: torch.randn(*s, dtype=torch.bfloat16) * 0.2)(B, S, D)),
            "v": _w((lambda *s: torch.randn(*s, dtype=torch.bfloat16) * 0.2)(B, S, D)),
            "shift_k": _w((lambda *s: torch.randn(*s, dtype=torch.bfloat16) * 0.2)(D, ks) * 0.5),
            "ssm_k": _w((lambda *s: torch.randn(*s, dtype=torch.bfloat16) * 0.4)(D, S) * (1.0 / S ** 0.5)),
            "ssm_D": _w((lambda *s: torch.randn(*s, dtype=torch.bfloat16) * 0.2)(D)),
        }
    _A_in = _A_setup()

    def _B_setup():
        B, S, D, F = 1, 2048, 640, 1728
        return {
            "x": _w((lambda *s: torch.randn(*s, dtype=torch.bfloat16) * 0.05)(B, S, D)),
            "W_gate": _w((lambda *s: torch.randn(*s, dtype=torch.bfloat16) * 0.2)(D, F) * (2.0 / D) ** 0.5),
            "W_up": _w((lambda *s: torch.randn(*s, dtype=torch.bfloat16) * 0.2)(D, F) * (2.0 / D) ** 0.5),
            "W_down": _w((lambda *s: torch.randn(*s, dtype=torch.bfloat16) * 0.2)(F, D) * (1.0 / F) ** 0.5),
        }
    _B_in = _B_setup()

    return {
        "A_q": _A_in["q"],
        "A_k": _A_in["k"],
        "A_v": _A_in["v"],
        "A_shift_k": _A_in["shift_k"],
        "A_ssm_k": _A_in["ssm_k"],
        "A_ssm_D": _A_in["ssm_D"],
        "B_x": _B_in["x"],
        "B_W_gate": _B_in["W_gate"],
        "B_W_up": _B_in["W_up"],
        "B_W_down": _B_in["W_down"],
    }

def reference(A_q, A_k, A_v, A_shift_k, A_ssm_k, A_ssm_D, B_x, B_W_gate, B_W_up, B_W_down):
    def _A_ref(q, k, v, shift_k, ssm_k, ssm_D):
        B, S, D = q.shape
        ks = shift_k.shape[-1]
        k_pad = _pad(k, ((0, 0), (ks - 1, 0), (0, 0)))
        k_shift = torch.zeros_like(k)
        for t in range(ks):
            k_shift = k_shift + k_pad[:, t:t + S, :] * shift_k[:, ks - 1 - t][None, None, :]
        kv = k_shift * v
        L = 2 * S
        kv_pad = _pad(kv, ((0, 0), (0, S), (0, 0)))
        kf_pad = _pad(ssm_k, ((0, 0), (0, S)))
        kv_f = (lambda x, axes=(-2,-1): torch.fft.rfft2(x.float(), dim=axes))(kv_pad[:, None, :, :], axes=(1, 2))
        kf_f = (lambda x, axes=(-2,-1): torch.fft.rfft2(x.float(), dim=axes))(kf_pad[:, None, :], axes=(1, 2))
        kf_f = (lambda x, *d: x.permute(*d))(kf_f, 1, 2, 0)
        y_f = kv_f * kf_f[None, :, :, :]
        y = (lambda x, s, axes=(-2,-1): torch.fft.irfft2(x, s=s, dim=axes).to(torch.bfloat16))(y_f, (1, L), axes=(1, 2))[:, 0, :S, :]
        y = y + kv * ssm_D[None, None, :]
        return q * y

    def _B_ref(x, W_gate, W_up, W_down):
        gate = torch.einsum("bsd,df->bsf", x, W_gate)
        up = torch.einsum("bsd,df->bsf", x, W_up)
        gate = gate * (lambda x, dt: x.to(dt))(gate > 0, gate.dtype)
        h = gate * up
        return torch.einsum("bsf,fd->bsd", h, W_down)

    x = A_q
    h = x + _A_ref(_layernorm(x, axis=-1), A_k, A_v, A_shift_k, A_ssm_k, A_ssm_D)
    h2 = h + _B_ref(_layernorm(h, axis=-1), B_W_gate, B_W_up, B_W_down)
    return h2
```

```asm
; @launch grid=(256,1,1) block=(256,1,1) lds=163840
.amdgcn_target "amdgcn-amd-amdhsa--gfx950"
.text
.globl sequential_preLN__ssm_conv_h3__glu_gated_reglu__prompt_kernel
.p2align 8
.type sequential_preLN__ssm_conv_h3__glu_gated_reglu__prompt_kernel,@function
sequential_preLN__ssm_conv_h3__glu_gated_reglu__prompt_kernel:
  s_cmp_lt_u32 s2, 256
  s_cbranch_scc1 K_go
  s_endpgm
K_go:
  s_load_dwordx16 s[16:31], s[0:1], 0
  s_load_dwordx8 s[32:39], s[0:1], 64
  s_load_dwordx2 s[40:41], s[0:1], 96
  s_getpc_b64 s[68:69]
PC0:
  s_lshr_b32 s4, s2, 3
  s_lshl_b32 s4, s4, 11
  v_lshrrev_b32 v2, 4, v0
  v_lshl_add_u32 v2, v2, 7, s4
  v_min_u32 v3, CODE_END-PC0-4, v2
  global_load_dword v14, v3, s[68:69]
  v_lshrrev_b32 v2, 6, v0
  s_nop 0
  v_readfirstlane_b32 s3, v2
  v_and_b32 v1, 63, v0
  v_lshlrev_b32 v5, 4, v1
  v_and_b32 v12, 48, v1
  s_cmp_ge_u32 s2, 160
  s_cbranch_scc1 K_helper
  s_lshr_b32 s4, s2, 4
  s_and_b32 s12, s2, 15
  s_lshl_b32 s12, s12, 7
  s_lshl_b32 s6, s3, 5
  s_add_u32 s12, s12, s6
  v_and_b32 v17, 7, v1
  v_bfe_u32 v20, v1, 3, 1
  v_bfe_u32 v3, v1, 4, 1
  v_lshl_or_b32 v4, v20, 1, v3
  v_bfe_u32 v2, v1, 5, 1
  v_lshl_or_b32 v16, v2, 2, v4
  v_lshl_add_u32 v4, v16, 2, s12
  v_mul_u32_u24 v234, 1280, v4
  s_lshl_b32 s6, s4, 7
  v_lshl_add_u32 v4, v17, 4, s6
  v_add_u32 v234, v234, v4
  v_subrev_u32 v18, 3840, v234
  v_lshlrev_b32 v19, 2, v4
  s_waitcnt lgkmcnt(0)
  s_mov_b32 s44, s18
  s_and_b32 s45, s19, 0xffff
  s_mov_b32 s46, 0x280000
  s_mov_b32 s47, 0x20000
  buffer_load_dwordx4 v[22:25], v18, s[44:47], 0 offen offset:0 nt
  buffer_load_dwordx4 v[26:29], v18, s[44:47], 0 offen offset:1280 nt
  buffer_load_dwordx4 v[30:33], v18, s[44:47], 0 offen offset:2560 nt
  buffer_load_dwordx4 v[34:37], v234, s[44:47], 0 offen offset:0 nt
  buffer_load_dwordx4 v[38:41], v234, s[44:47], 0 offen offset:1280 nt
  buffer_load_dwordx4 v[42:45], v234, s[44:47], 0 offen offset:2560 nt
  buffer_load_dwordx4 v[46:49], v234, s[44:47], 0 offen offset:3840 nt
  s_mov_b32 s52, s22
  s_and_b32 s53, s23, 0xffff
  s_mov_b32 s54, 0x1400
  s_mov_b32 s55, 0x20000
  buffer_load_dwordx4 v[66:69], v19, s[52:55], 0 offen offset:0
  buffer_load_dwordx4 v[70:73], v19, s[52:55], 0 offen offset:16
  buffer_load_dwordx4 v[74:77], v19, s[52:55], 0 offen offset:32
  buffer_load_dwordx4 v[78:81], v19, s[52:55], 0 offen offset:48
  s_mov_b32 s48, s20
  s_and_b32 s49, s21, 0xffff
  s_mov_b32 s50, 0x280000
  s_mov_b32 s51, 0x20000
  buffer_load_dwordx4 v[50:53], v234, s[48:51], 0 offen offset:0 nt
  buffer_load_dwordx4 v[54:57], v234, s[48:51], 0 offen offset:1280 nt
  buffer_load_dwordx4 v[58:61], v234, s[48:51], 0 offen offset:2560 nt
  buffer_load_dwordx4 v[62:65], v234, s[48:51], 0 offen offset:3840 nt
  s_cmp_ge_u32 s3, 2
  s_cselect_b32 s64, s32, s30
  s_cselect_b32 s65, s33, s31
  s_and_b32 s65, s65, 0xffff
  s_mov_b32 s66, 0x21c000
  s_mov_b32 s67, 0x20000
  v_bfe_u32 v3, v1, 4, 1
  v_bfe_u32 v2, v1, 5, 1
  s_lshr_b32 s4, s2, 4
  s_mov_b32 s43, 0x1820000
  s_load_dword s43, s[40:41], s43
  s_lshl_b32 s7, s2, 2
  s_add_u32 s7, s7, s3
  s_lshl_b32 s6, s7, 12
  s_load_dword s9, s[24:25], s6
  s_lshl_b32 s5, s7, 1
  s_and_b32 s5, s5, 0xfffc
  s_load_dword s10, s[26:27], s5
  s_mov_b32 s60, s40
  s_and_b32 s61, s41, 0xffff
  s_mov_b32 s62, 0x1e00000
  s_mov_b32 s63, 0x20000
  v_min_u32 v245, 3, v1
  v_lshlrev_b32 v245, 20, v245
  s_mov_b32 s6, 0x800000
  buffer_load_dword v245, v245, s[60:63], s6 offen
  s_mov_b32 s56, s24
  s_and_b32 s57, s25, 0xffff
  s_mov_b32 s58, 0x280000
  s_mov_b32 s59, 0x20000
  s_mul_i32 s8, s3, 13312
  v_lshl_or_b32 v4, v2, 1, v20
  s_lshl_b32 s6, s3, 2
  s_sub_u32 s5, 15, s6
  v_sub_u32 v4, s5, v4
  v_lshlrev_b32 v2, 1, v17
  v_xor_b32 v4, v4, v2
  v_lshlrev_b32 v4, 4, v4
  v_lshl_add_u32 v4, v3, 10, v4
  v_and_b32 v3, 1, v17
  v_lshl_add_u32 v4, v3, 11, v4
  v_lshrrev_b32 v3, 1, v17
  v_mul_u32_u24 v3, 13312, v3
  v_add_u32 v82, v3, v4
  v_lshrrev_b32 v2, 4, v1
  v_and_b32 v3, 2, v2
  v_or_b32 v3, s6, v3
  v_and_b32 v4, 15, v1
  v_xor_b32 v3, v3, v4
  v_lshl_add_u32 v3, v3, 4, s8
  v_lshl_add_u32 v83, v2, 10, v3
  v_mul_u32_u24 v2, 20480, v2
  v_lshl_add_u32 v21, v4, 4, v2
  s_lshl_b32 s5, s4, 4
  s_add_u32 s5, s5, s6
  s_mul_i32 s50, s5, 20480
  s_andn2_b32 s6, 15, s2
  s_lshl_b32 s6, s6, 8
  s_add_u32 s50, s50, s6
  s_add_u32 s50, s50, 0x800000
  s_mov_b32 s13, 0x05040100
  s_mov_b32 s14, 0x07060302
  s_and_b32 s4, s2, 3
  s_mul_i32 s4, s4, 27
  s_lshr_b32 s4, s4, 2
  v_and_b32 v2, 7, v1
  v_add_u32 v2, s4, v2
  v_min_u32 v2, 26, v2
  v_lshrrev_b32 v3, 3, v1
  v_mul_u32_u24 v3, 3456, v3
  v_lshl_add_u32 v243, v2, 7, v3
  s_bfe_u32 s16, s2, 65538
  s_lshl_b32 s16, s16, 3
  s_lshr_b32 s5, s2, 5
  s_add_u32 s16, s16, s5
  s_and_b32 s17, s2, 3
  s_lshl_b32 s17, s17, 2
  s_bfe_u32 s5, s2, 131075
  s_add_u32 s17, s17, s5
  s_mul_i32 s18, s3, 13
  s_add_u32 s18, s18, 3
  s_lshr_b32 s18, s18, 2
  s_lshr_b32 s31, s3, 1
  s_mul_i32 s31, s31, 10
  s_add_u32 s31, s31, 3
  s_and_b32 s6, s17, 1
  s_lshl_b32 s6, s6, 3
  s_mul_i32 s42, s17, 216
  s_sub_u32 s42, s42, s6
  s_lshr_b32 s4, s3, 1
  s_mul_i32 s38, s4, 7184
  s_and_b32 s4, s3, 1
  s_mul_i32 s5, s4, 3584
  s_add_u32 s38, s38, s5
  s_add_u32 s38, s38, 53248
  s_mul_i32 s4, s4, 55296
  v_mul_u32_u24 v2, 37, v1
  v_lshrrev_b32 v2, 9, v2
  v_mul_u32_u24 v2, 3232, v2
  v_add3_u32 v226, v2, v5, s4
  v_add_u32 v227, 26752, v226
  v_add_u32 v228, 12032, v226
  v_add_u32 v229, 38784, v226
  v_lshrrev_b32 v2, 5, v1
  v_bfe_u32 v3, v1, 2, 3
  v_lshl_add_u32 v2, v2, 4, v3
  v_mul_u32_u24 v2, 224, v2
  s_add_u32 s6, s6, 53248
  v_add_u32 v2, s6, v2
  s_lshl_b32 s4, s18, 4
  v_and_b32 v3, 3, v1
  v_lshl_add_u32 v3, v3, 3, v2
  v_add_u32 v230, s4, v3
  v_and_b32 v3, 1, v1
  v_lshl_add_u32 v2, v3, 3, v2
  v_bfe_u32 v4, v1, 1, 1
  v_mul_u32_u24 v233, 7184, v4
  v_add_u32 v2, v2, v233
  s_add_u32 s4, s4, 32
  v_add_u32 v231, s4, v2
  s_lshl_b32 s4, s31, 4
  v_add_u32 v232, s4, v2
  v_add_u32 v233, 1792, v232
  v_lshlrev_b32 v4, 3, v4
  v_add_u32 v4, 60416, v4
  s_lshr_b32 s4, s3, 1
  v_and_b32 v3, s4, v3
  v_cmp_ne_u32 vcc, 0, v3
  s_nop 1
  v_cndmask_b32 v232, v232, v4, vcc
  v_cndmask_b32 v233, v233, v4, vcc
  v_mov_b32 v236, 0
  v_mov_b32 v237, 0
  v_mov_b32 v238, 0x3f803f80
  v_mov_b32 v239, 0x3f803f80
  v_min_u32 v2, 6, v1
  v_mul_u32_u24 v2, 14368, v2
  ds_write_b128 v2, v[236:239] offset:60416
  s_waitcnt vmcnt(9)
  s_lshl_b32 s6, s7, 12
  s_add_u32 m0, s8, 4192
  s_nop 0
  buffer_load_dwordx4 v5, s[56:59], s6 offen offset:0 nt lds
  buffer_load_dwordx4 v5, s[56:59], s6 offen offset:1024 nt lds
  buffer_load_dwordx4 v5, s[56:59], s6 offen offset:2048 nt lds
  buffer_load_dwordx4 v5, s[56:59], s6 offen offset:3072 nt lds
  v_perm_b32 v101, v22, v26, s13
  v_perm_b32 v102, v26, v30, s13
  v_perm_b32 v103, v30, v34, s13
  v_perm_b32 v104, v34, v38, s13
  v_perm_b32 v105, v38, v42, s13
  v_perm_b32 v106, v42, v46, s13
  v_perm_b32 v109, v22, v26, s14
  v_perm_b32 v110, v26, v30, s14
  v_perm_b32 v111, v30, v34, s14
  v_perm_b32 v112, v34, v38, s14
  v_perm_b32 v113, v38, v42, s14
  v_perm_b32 v114, v42, v46, s14
  v_perm_b32 v117, v23, v27, s13
  v_perm_b32 v118, v27, v31, s13
  v_perm_b32 v119, v31, v35, s13
  v_perm_b32 v120, v35, v39, s13
  v_perm_b32 v121, v39, v43, s13
  v_perm_b32 v122, v43, v47, s13
  v_perm_b32 v125, v23, v27, s14
  v_perm_b32 v126, v27, v31, s14
  v_perm_b32 v127, v31, v35, s14
  v_perm_b32 v128, v35, v39, s14
  v_perm_b32 v129, v39, v43, s14
  v_perm_b32 v130, v43, v47, s14
  v_perm_b32 v133, v24, v28, s13
  v_perm_b32 v134, v28, v32, s13
  v_perm_b32 v135, v32, v36, s13
  v_perm_b32 v136, v36, v40, s13
  v_perm_b32 v137, v40, v44, s13
  v_perm_b32 v138, v44, v48, s13
  v_perm_b32 v141, v24, v28, s14
  v_perm_b32 v142, v28, v32, s14
  v_perm_b32 v143, v32, v36, s14
  v_perm_b32 v144, v36, v40, s14
  v_perm_b32 v145, v40, v44, s14
  v_perm_b32 v146, v44, v48, s14
  v_perm_b32 v149, v25, v29, s13
  v_perm_b32 v150, v29, v33, s13
  v_perm_b32 v151, v33, v37, s13
  v_perm_b32 v152, v37, v41, s13
  v_perm_b32 v153, v41, v45, s13
  v_perm_b32 v154, v45, v49, s13
  v_perm_b32 v157, v25, v29, s14
  v_perm_b32 v158, v29, v33, s14
  v_perm_b32 v159, v33, v37, s14
  v_perm_b32 v160, v37, v41, s14
  v_perm_b32 v161, v41, v45, s14
  v_perm_b32 v162, v45, v49, s14
  s_waitcnt vmcnt(12)
  v_dot2_f32_bf16 v164, v103, v66, 0
  v_dot2_f32_bf16 v165, v104, v66, 0
  v_dot2_f32_bf16 v166, v105, v66, 0
  v_dot2_f32_bf16 v167, v106, v66, 0
  v_dot2_f32_bf16 v164, v101, v67, v164
  v_dot2_f32_bf16 v165, v102, v67, v165
  v_dot2_f32_bf16 v166, v103, v67, v166
  v_dot2_f32_bf16 v167, v104, v67, v167
  v_dot2_f32_bf16 v168, v111, v68, 0
  v_dot2_f32_bf16 v169, v112, v68, 0
  v_dot2_f32_bf16 v170, v113, v68, 0
  v_dot2_f32_bf16 v171, v114, v68, 0
  v_dot2_f32_bf16 v168, v109, v69, v168
  v_dot2_f32_bf16 v169, v110, v69, v169
  v_dot2_f32_bf16 v170, v111, v69, v170
  v_dot2_f32_bf16 v171, v112, v69, v171
  s_waitcnt vmcnt(11)
  v_dot2_f32_bf16 v172, v119, v70, 0
  v_dot2_f32_bf16 v173, v120, v70, 0
  v_dot2_f32_bf16 v174, v121, v70, 0
  v_dot2_f32_bf16 v175, v122, v70, 0
  v_dot2_f32_bf16 v172, v117, v71, v172
  v_dot2_f32_bf16 v173, v118, v71, v173
  v_dot2_f32_bf16 v174, v119, v71, v174
  v_dot2_f32_bf16 v175, v120, v71, v175
  v_dot2_f32_bf16 v176, v127, v72, 0
  v_dot2_f32_bf16 v177, v128, v72, 0
  v_dot2_f32_bf16 v178, v129, v72, 0
  v_dot2_f32_bf16 v179, v130, v72, 0
  v_dot2_f32_bf16 v176, v125, v73, v176
  v_dot2_f32_bf16 v177, v126, v73, v177
  v_dot2_f32_bf16 v178, v127, v73, v178
  v_dot2_f32_bf16 v179, v128, v73, v179
  s_waitcnt vmcnt(10)
  v_dot2_f32_bf16 v180, v135, v74, 0
  v_dot2_f32_bf16 v181, v136, v74, 0
  v_dot2_f32_bf16 v182, v137, v74, 0
  v_dot2_f32_bf16 v183, v138, v74, 0
  v_dot2_f32_bf16 v180, v133, v75, v180
  v_dot2_f32_bf16 v181, v134, v75, v181
  v_dot2_f32_bf16 v182, v135, v75, v182
  v_dot2_f32_bf16 v183, v136, v75, v183
  v_dot2_f32_bf16 v184, v143, v76, 0
  v_dot2_f32_bf16 v185, v144, v76, 0
  v_dot2_f32_bf16 v186, v145, v76, 0
  v_dot2_f32_bf16 v187, v146, v76, 0
  v_dot2_f32_bf16 v184, v141, v77, v184
  v_dot2_f32_bf16 v185, v142, v77, v185
  v_dot2_f32_bf16 v186, v143, v77, v186
  v_dot2_f32_bf16 v187, v144, v77, v187
  s_waitcnt vmcnt(9)
  v_dot2_f32_bf16 v188, v151, v78, 0
  v_dot2_f32_bf16 v189, v152, v78, 0
  v_dot2_f32_bf16 v190, v153, v78, 0
  v_dot2_f32_bf16 v191, v154, v78, 0
  v_dot2_f32_bf16 v188, v149, v79, v188
  v_dot2_f32_bf16 v189, v150, v79, v189
  v_dot2_f32_bf16 v190, v151, v79, v190
  v_dot2_f32_bf16 v191, v152, v79, v191
  v_dot2_f32_bf16 v192, v159, v80, 0
  v_dot2_f32_bf16 v193, v160, v80, 0
  v_dot2_f32_bf16 v194, v161, v80, 0
  v_dot2_f32_bf16 v195, v162, v80, 0
  v_dot2_f32_bf16 v192, v157, v81, v192
  v_dot2_f32_bf16 v193, v158, v81, v193
  v_dot2_f32_bf16 v194, v159, v81, v194
  v_dot2_f32_bf16 v195, v160, v81, v195
  s_waitcnt vmcnt(8)
  v_lshlrev_b32 v100, 16, v50
  s_waitcnt vmcnt(7)
  v_lshlrev_b32 v101, 16, v54
  s_waitcnt vmcnt(6)
  v_lshlrev_b32 v102, 16, v58
  s_waitcnt vmcnt(5)
  v_lshlrev_b32 v103, 16, v62
  v_lshlrev_b32 v132, 16, v52
  v_lshlrev_b32 v133, 16, v56
  v_lshlrev_b32 v134, 16, v60
  v_lshlrev_b32 v135, 16, v64
  v_pk_mul_f32 v[164:165], v[164:165], v[100:101]
  v_pk_mul_f32 v[166:167], v[166:167], v[102:103]
  v_pk_mul_f32 v[180:181], v[180:181], v[132:133]
  v_pk_mul_f32 v[182:183], v[182:183], v[134:135]
  v_cvt_pk_bf16_f32 v86, v167, v166
  v_cvt_pk_bf16_f32 v87, v165, v164
  v_cvt_pk_bf16_f32 v84, v183, v182
  v_cvt_pk_bf16_f32 v85, v181, v180
  s_nop 0
  v_permlane16_swap_b32 v86, v84
  v_permlane16_swap_b32 v87, v85
  ds_write_b128 v82, v[84:87] offset:8320
  v_and_b32 v108, 0xffff0000, v50
  v_and_b32 v109, 0xffff0000, v54
  v_and_b32 v110, 0xffff0000, v58
  v_and_b32 v111, 0xffff0000, v62
  v_and_b32 v140, 0xffff0000, v52
  v_and_b32 v141, 0xffff0000, v56
  v_and_b32 v142, 0xffff0000, v60
  v_and_b32 v143, 0xffff0000, v64
  v_pk_mul_f32 v[168:169], v[168:169], v[108:109]
  v_pk_mul_f32 v[170:171], v[170:171], v[110:111]
  v_pk_mul_f32 v[184:185], v[184:185], v[140:141]
  v_pk_mul_f32 v[186:187], v[186:187], v[142:143]
  v_cvt_pk_bf16_f32 v90, v171, v170
  v_cvt_pk_bf16_f32 v91, v169, v168
  v_cvt_pk_bf16_f32 v88, v187, v186
  v_cvt_pk_bf16_f32 v89, v185, v184
  s_nop 0
  v_permlane16_swap_b32 v90, v88
  v_permlane16_swap_b32 v91, v89
  ds_write_b128 v82, v[88:91] offset:8576
  v_lshlrev_b32 v116, 16, v51
  v_lshlrev_b32 v117, 16, v55
  v_lshlrev_b32 v118, 16, v59
  v_lshlrev_b32 v119, 16, v63
  v_lshlrev_b32 v148, 16, v53
  v_lshlrev_b32 v149, 16, v57
  v_lshlrev_b32 v150, 16, v61
  v_lshlrev_b32 v151, 16, v65
  v_pk_mul_f32 v[172:173], v[172:173], v[116:117]
  v_pk_mul_f32 v[174:175], v[174:175], v[118:119]
  v_pk_mul_f32 v[188:189], v[188:189], v[148:149]
  v_pk_mul_f32 v[190:191], v[190:191], v[150:151]
  v_cvt_pk_bf16_f32 v94, v175, v174
  v_cvt_pk_bf16_f32 v95, v173, v172
  v_cvt_pk_bf16_f32 v92, v191, v190
  v_cvt_pk_bf16_f32 v93, v189, v188
  s_nop 0
  v_permlane16_swap_b32 v94, v92
  v_permlane16_swap_b32 v95, v93
  ds_write_b128 v82, v[92:95] offset:8832
  v_and_b32 v124, 0xffff0000, v51
  v_and_b32 v125, 0xffff0000, v55
  v_and_b32 v126, 0xffff0000, v59
  v_and_b32 v127, 0xffff0000, v63
  v_and_b32 v156, 0xffff0000, v53
  v_and_b32 v157, 0xffff0000, v57
  v_and_b32 v158, 0xffff0000, v61
  v_and_b32 v159, 0xffff0000, v65
  v_pk_mul_f32 v[176:177], v[176:177], v[124:125]
  v_pk_mul_f32 v[178:179], v[178:179], v[126:127]
  v_pk_mul_f32 v[192:193], v[192:193], v[156:157]
  v_pk_mul_f32 v[194:195], v[194:195], v[158:159]
  v_cvt_pk_bf16_f32 v98, v179, v178
  v_cvt_pk_bf16_f32 v99, v177, v176
  v_cvt_pk_bf16_f32 v96, v195, v194
  v_cvt_pk_bf16_f32 v97, v193, v192
  s_nop 0
  v_permlane16_swap_b32 v98, v96
  v_permlane16_swap_b32 v99, v97
  ds_write_b128 v82, v[96:99] offset:9088
  s_waitcnt lgkmcnt(0)
  s_barrier
  ds_read_b128 v[84:87], v83 offset:8320
  ds_read_b128 v[88:91], v83 offset:8576
  ds_read_b128 v[92:95], v83 offset:8832
  ds_read_b128 v[96:99], v83 offset:9088
  s_mul_i32 s100, s43, 0x9e3779b1
  s_add_u32 s100, s100, 0x7f4a7c15
  s_mov_b32 s101, s100
  v_mov_b32 v255, s100
  s_waitcnt lgkmcnt(3)
  v_add_u32 v84, s100, v84
  buffer_store_dwordx4 v[84:87], v21, s[60:63], s50 offen sc1
  v_add3_u32 v100, v84, v85, v86
  v_add3_u32 v100, v100, v87, s100
  s_add_u32 s50, s50, 4096
  s_waitcnt lgkmcnt(2)
  v_add_u32 v88, s100, v88
  buffer_store_dwordx4 v[88:91], v21, s[60:63], s50 offen sc1
  v_add3_u32 v101, v88, v89, v90
  v_add3_u32 v101, v101, v91, s100
  s_add_u32 s50, s50, 4096
  s_waitcnt lgkmcnt(1)
  v_add_u32 v92, s100, v92
  buffer_store_dwordx4 v[92:95], v21, s[60:63], s50 offen sc1
  v_add3_u32 v102, v92, v93, v94
  v_add3_u32 v102, v102, v95, s100
  s_add_u32 s50, s50, 4096
  s_waitcnt lgkmcnt(0)
  v_add_u32 v96, s100, v96
  buffer_store_dwordx4 v[96:99], v21, s[60:63], s50 offen sc1
  v_add3_u32 v103, v96, v97, v98
  v_add3_u32 v103, v103, v99, s100
  s_add_u32 s50, s50, 4096
  buffer_store_dwordx4 v[100:103], v21, s[60:63], s50 offen sc1
  s_cmp_ge_u32 s2, 64
  s_cbranch_scc1 T1_skip
  s_bitcmp1_b32 s3, 0
  s_cbranch_scc1 T1_skip
  s_lshr_b32 s5, s2, 3
  s_add_u32 s5, s5, 32
  s_mul_i32 s5, s5, 27648
  buffer_load_dword v14, v243, s[64:67], s5 offen
T1_skip:
  s_mov_b32 exec_hi, 0xffffff
  s_add_u32 m0, s38, 0
  s_add_u32 s49, s42, 0
  buffer_load_dwordx4 v226, s[64:67], s49 offen offset:0 lds
  buffer_load_dwordx4 v227, s[64:67], s49 offen offset:896 lds
  buffer_load_dwordx4 v228, s[64:67], s49 offen offset:1792 lds
  buffer_load_dwordx4 v229, s[64:67], s49 offen offset:2688 lds
  s_add_u32 m0, s38, 14368
  s_add_u32 s49, s42, 110592
  buffer_load_dwordx4 v226, s[64:67], s49 offen offset:0 lds
  buffer_load_dwordx4 v227, s[64:67], s49 offen offset:896 lds
  buffer_load_dwordx4 v228, s[64:67], s49 offen offset:1792 lds
  buffer_load_dwordx4 v229, s[64:67], s49 offen offset:2688 lds
  s_mov_b32 exec_hi, -1
  v_and_b32 v219, 15, v1
  v_lshrrev_b32 v220, 4, v1
  v_lshlrev_b32 v217, 5, v219
  v_lshl_add_u32 v217, v220, 3, v217
  v_lshlrev_b32 v249, 2, v1
  v_add_u32 v3, 4128, v249
  v_cmp_gt_u32 vcc, 8, v1
  s_nop 1
  v_cndmask_b32 v3, v3, v249, vcc
  v_add_u32 v2, 12416, v249
  v_cmp_gt_u32 vcc, 16, v1
  s_nop 1
  v_cndmask_b32 v3, v2, v3, vcc
  v_add_u32 v221, s8, v3
  v_mov_b32 v208, 0
  v_mov_b32 v209, 0
  v_lshl_add_u32 v2, v1, 3, s8
  ds_write_b64 v2, v[208:209] offset:12416
  v_lshl_add_u32 v2, v220, 3, v219
  v_lshrrev_b32 v2, 1, v2
  v_lshl_add_u32 v2, v2, 2, s8
  v_and_b32 v3, 1, v219
  v_mul_u32_u24 v3, 4164, v3
  v_add_u32 v212, v2, v3
  v_add_u32 v213, 1024, v212
  v_add_u32 v214, 2048, v212
  v_add_u32 v215, 3072, v212
  v_lshlrev_b32 v2, 5, v219
  v_sub_u32 v2, 8800, v2
  v_lshl_add_u32 v2, v220, 4, v2
  v_add_u32 v216, s8, v2
  v_and_b32 v2, 1, v220
  v_lshlrev_b32 v2, 9, v2
  v_lshl_add_u32 v2, v219, 5, v2
  v_lshrrev_b32 v3, 1, v220
  v_lshl_add_u32 v218, v3, 4, v2
  v_add_u32 v246, s8, v5
  s_and_b32 s39, s2, 3
  s_mul_i32 s39, s39, 3072
  s_add_u32 s39, s39, 0x1810000
  s_lshl_b32 s4, s16, 3
  s_lshr_b32 s5, s17, 3
  s_lshl_b32 s5, s5, 2
  s_add_u32 s4, s4, s5
  s_and_b32 s5, s17, 3
  s_add_u32 s4, s4, s5
  s_lshl_b32 s28, s4, 9
  s_and_b32 s5, s17, 4
  s_add_u32 s5, s5, s3
  s_lshl_b32 s5, s5, 2
  s_add_u32 s28, s28, s5
  s_add_u32 s28, s28, 0x780000
  v_lshrrev_b32 v2, 4, v1
  v_bfe_u32 v3, v1, 2, 2
  v_cmp_eq_u32 vcc, v2, v3
  v_and_b32 v2, 15, v1
  v_lshlrev_b32 v2, 5, v2
  v_mov_b32 v3, 0x7f000000
  v_cndmask_b32 v247, v3, v2, vcc
  v_mov_b32 v236, -1
  v_mov_b32 v237, -1
  v_mov_b32 v238, -1
  v_mov_b32 v239, -1
  s_waitcnt vmcnt(13)
  s_lshl_b32 s5, s9, 16
  v_mov_b32 v2, s5
  v_cmp_eq_u32 vcc, 7, v1
  s_nop 1
  v_cndmask_b32 v4, 0, v2, vcc
  ds_write_b32 v221, v4
  s_bitcmp1_b32 s7, 0
  s_cselect_b32 s5, 16, 0
  s_lshr_b32 s10, s10, s5
  s_and_b32 s10, s10, 0xffff
  v_lshlrev_b32 v2, 3, v220
  v_add_u32 v2, v2, v219
  v_sub_u32 v2, 15, v2
  v_and_b32 v3, 1, v2
  v_lshlrev_b32 v3, 4, v3
  v_lshlrev_b32 v3, v3, s10
  v_ashrrev_i32 v2, 1, v2
  s_waitcnt lgkmcnt(0)
  v_cmp_eq_u32 vcc, 0, v2
  s_nop 1
  v_cndmask_b32 v208, 0, v3, vcc
  v_cmp_eq_u32 vcc, 1, v2
  s_nop 1
  v_cndmask_b32 v209, 0, v3, vcc
  v_cmp_eq_u32 vcc, 2, v2
  s_nop 1
  v_cndmask_b32 v210, 0, v3, vcc
  v_cmp_eq_u32 vcc, 3, v2
  s_nop 1
  v_cndmask_b32 v211, 0, v3, vcc
  ds_read_b128 v[80:83], v246 offset:4192
  ds_read_b32 v96, v246 offset:4208
  ds_read_b128 v[84:87], v246 offset:5216
  ds_read_b32 v97, v246 offset:5232
  ds_read_b128 v[88:91], v246 offset:6240
  ds_read_b32 v98, v246 offset:6256
  ds_read_b128 v[92:95], v246 offset:7264
  ds_read_b32 v99, v246 offset:7280
  s_waitcnt lgkmcnt(7)
  v_alignbit_b32 v80, v81, v80, 16
  v_alignbit_b32 v81, v82, v81, 16
  v_alignbit_b32 v82, v83, v82, 16
  s_waitcnt lgkmcnt(6)
  v_alignbit_b32 v83, v96, v83, 16
  ds_write_b128 v246, v[80:83] offset:32
  s_waitcnt lgkmcnt(6)
  v_alignbit_b32 v84, v85, v84, 16
  v_alignbit_b32 v85, v86, v85, 16
  v_alignbit_b32 v86, v87, v86, 16
  s_waitcnt lgkmcnt(5)
  v_alignbit_b32 v87, v97, v87, 16
  ds_write_b128 v246, v[84:87] offset:1056
  s_waitcnt lgkmcnt(5)
  v_alignbit_b32 v88, v89, v88, 16
  v_alignbit_b32 v89, v90, v89, 16
  v_alignbit_b32 v90, v91, v90, 16
  s_waitcnt lgkmcnt(4)
  v_alignbit_b32 v91, v98, v91, 16
  ds_write_b128 v246, v[88:91] offset:2080
  s_waitcnt lgkmcnt(4)
  v_alignbit_b32 v92, v93, v92, 16
  v_alignbit_b32 v93, v94, v93, 16
  v_alignbit_b32 v94, v95, v94, 16
  s_waitcnt lgkmcnt(3)
  v_alignbit_b32 v95, v99, v95, 16
  ds_write_b128 v246, v[92:95] offset:3104
  s_waitcnt lgkmcnt(0)
  ds_read2_b32 v[48:49], v212 offset0:0 offset1:1
  ds_read2_b32 v[50:51], v212 offset0:2 offset1:3
  ds_read2_b32 v[52:53], v212 offset0:128 offset1:129
  ds_read2_b32 v[54:55], v212 offset0:130 offset1:131
  ds_read2_b32 v[56:57], v213 offset0:0 offset1:1
  ds_read2_b32 v[58:59], v213 offset0:2 offset1:3
  ds_read2_b32 v[60:61], v213 offset0:128 offset1:129
  ds_read2_b32 v[62:63], v213 offset0:130 offset1:131
  ds_read2_b32 v[64:65], v214 offset0:0 offset1:1
  ds_read2_b32 v[66:67], v214 offset0:2 offset1:3
  ds_read2_b32 v[68:69], v214 offset0:128 offset1:129
  ds_read2_b32 v[70:71], v214 offset0:130 offset1:131
  ds_read2_b32 v[72:73], v215 offset0:0 offset1:1
  ds_read2_b32 v[74:75], v215 offset0:2 offset1:3
  ds_read2_b32 v[76:77], v215 offset0:128 offset1:129
  ds_read2_b32 v[78:79], v215 offset0:130 offset1:131
  s_mov_b32 exec_hi, 0xffffff
  s_add_u32 m0, s38, 28736
  s_add_u32 s49, s42, 221184
  buffer_load_dwordx4 v226, s[64:67], s49 offen offset:0 lds
  buffer_load_dwordx4 v227, s[64:67], s49 offen offset:896 lds
  buffer_load_dwordx4 v228, s[64:67], s49 offen offset:1792 lds
  buffer_load_dwordx4 v229, s[64:67], s49 offen offset:2688 lds
  s_add_u32 m0, s38, 43104
  s_add_u32 s49, s42, 331776
  buffer_load_dwordx4 v226, s[64:67], s49 offen offset:0 lds
  buffer_load_dwordx4 v227, s[64:67], s49 offen offset:896 lds
  buffer_load_dwordx4 v228, s[64:67], s49 offen offset:1792 lds
  buffer_load_dwordx4 v229, s[64:67], s49 offen offset:2688 lds
  s_mov_b32 exec_hi, -1
  s_mul_i32 s44, s2, 20480
  s_lshl_b32 s4, s3, 10
  s_add_u32 s44, s44, s4
  s_add_u32 s44, s44, 0x800000
  s_add_u32 s45, s44, 4096
  s_add_u32 s46, s44, 8192
  s_add_u32 s47, s44, 12288
  s_add_u32 s51, s44, 16384
  v_add_u32 v246, s4, v5
  s_mov_b32 exec_hi, 0xffffff
  s_add_u32 m0, s38, 57472
  s_add_u32 s49, s42, 884736
  buffer_load_dwordx4 v226, s[64:67], s49 offen offset:0 lds
  buffer_load_dwordx4 v227, s[64:67], s49 offen offset:896 lds
  buffer_load_dwordx4 v228, s[64:67], s49 offen offset:1792 lds
  buffer_load_dwordx4 v229, s[64:67], s49 offen offset:2688 lds
  s_add_u32 m0, s38, 71840
  s_add_u32 s49, s42, 995328
  buffer_load_dwordx4 v226, s[64:67], s49 offen offset:0 lds
  buffer_load_dwordx4 v227, s[64:67], s49 offen offset:896 lds
  buffer_load_dwordx4 v228, s[64:67], s49 offen offset:1792 lds
  buffer_load_dwordx4 v229, s[64:67], s49 offen offset:2688 lds
  s_add_u32 m0, s38, 86208
  s_add_u32 s49, s42, 1105920
  buffer_load_dwordx4 v226, s[64:67], s49 offen offset:0 lds
  buffer_load_dwordx4 v227, s[64:67], s49 offen offset:896 lds
  buffer_load_dwordx4 v228, s[64:67], s49 offen offset:1792 lds
  buffer_load_dwordx4 v229, s[64:67], s49 offen offset:2688 lds
  s_mov_b32 exec_hi, -1
  buffer_load_dwordx4 v[96:99], v5, s[60:63], s51 offen sc1
  buffer_load_dwordx4 v[80:83], v5, s[60:63], s44 offen sc1
  buffer_load_dwordx4 v[84:87], v5, s[60:63], s45 offen sc1
  buffer_load_dwordx4 v[88:91], v5, s[60:63], s46 offen sc1
  buffer_load_dwordx4 v[92:95], v5, s[60:63], s47 offen sc1
  s_waitcnt vmcnt(17)
  s_barrier
  ds_read_b64_tr_b16 a[0:1], v230 offset:0
  ds_read_b64_tr_b16 a[2:3], v230 offset:1792
  ds_read_b64_tr_b16 a[4:5], v230 offset:7184
  ds_read_b64_tr_b16 a[6:7], v230 offset:8976
  ds_read_b64_tr_b16 a[8:9], v231 offset:0
  ds_read_b64_tr_b16 a[10:11], v231 offset:1792
  ds_read_b64_tr_b16 a[12:13], v232 offset:0
  ds_read_b64_tr_b16 a[14:15], v233 offset:0
  ds_read_b64_tr_b16 a[16:17], v230 offset:14368
  ds_read_b64_tr_b16 a[18:19], v230 offset:16160
  ds_read_b64_tr_b16 a[20:21], v230 offset:21552
  ds_read_b64_tr_b16 a[22:23], v230 offset:23344
  ds_read_b64_tr_b16 a[24:25], v231 offset:14368
  ds_read_b64_tr_b16 a[26:27], v231 offset:16160
  ds_read_b64_tr_b16 a[28:29], v232 offset:14368
  ds_read_b64_tr_b16 a[30:31], v233 offset:14368
  ds_read_b64_tr_b16 a[32:33], v230 offset:28736
  ds_read_b64_tr_b16 a[34:35], v230 offset:30528
  ds_read_b64_tr_b16 a[36:37], v230 offset:35920
  ds_read_b64_tr_b16 a[38:39], v230 offset:37712
  ds_read_b64_tr_b16 a[40:41], v231 offset:28736
  ds_read_b64_tr_b16 a[42:43], v231 offset:30528
  ds_read_b64_tr_b16 a[44:45], v232 offset:28736
  ds_read_b64_tr_b16 a[46:47], v233 offset:28736
  ds_read_b64_tr_b16 a[48:49], v230 offset:43104
  ds_read_b64_tr_b16 a[50:51], v230 offset:44896
  ds_read_b64_tr_b16 a[52:53], v230 offset:50288
  ds_read_b64_tr_b16 a[54:55], v230 offset:52080
  ds_read_b64_tr_b16 a[56:57], v231 offset:43104
  ds_read_b64_tr_b16 a[58:59], v231 offset:44896
  ds_read_b64_tr_b16 a[60:61], v232 offset:43104
  ds_read_b64_tr_b16 a[62:63], v233 offset:43104
  s_lshl_b32 s4, s7, 12
  s_mov_b32 s50, s13
  s_add_u32 s13, s4, 0x500000
  s_add_u32 s12, s4, 0x280000
  s_mov_b32 s52, 0x05040302
  v_mov_b32 v15, 0x3f803f80
  s_lshl_b32 s57, s3, 11
  s_add_u32 s56, s57, 0x7a0000
  s_add_u32 s57, s57, 153824
  v_mov_b32 v2, 153824
  v_lshl_add_u32 v221, v217, 1, v2
  v_min_u32 v222, 15, v1
  v_lshlrev_b32 v222, 7, v222
  v_min_u32 v223, 39, v1
  v_lshrrev_b32 v2, 1, v223
  v_and_b32 v223, 1, v223
  v_lshlrev_b32 v223, 3, v223
  v_lshl_add_u32 v223, v2, 7, v223
  s_add_u32 s58, s39, 0xffff5000
  s_waitcnt vmcnt(3)
  v_add3_u32 v100, v80, v81, v82
  v_add3_u32 v100, v100, v83, s100
  v_subrev_u32 v80, s100, v80
  ds_write_b128 v246, v[80:83] offset:8320
  v_xor_b32 v100, v100, v96
  s_waitcnt vmcnt(2)
  v_add3_u32 v101, v84, v85, v86
  v_add3_u32 v101, v101, v87, s100
  v_subrev_u32 v84, s100, v84
  ds_write_b128 v246, v[84:87] offset:21632
  v_xor_b32 v101, v101, v97
  s_waitcnt vmcnt(1)
  v_add3_u32 v102, v88, v89, v90
  v_add3_u32 v102, v102, v91, s100
  v_subrev_u32 v88, s100, v88
  ds_write_b128 v246, v[88:91] offset:34944
  v_xor_b32 v102, v102, v98
  s_waitcnt vmcnt(0)
  v_add3_u32 v103, v92, v93, v94
  v_add3_u32 v103, v103, v95, s100
  v_subrev_u32 v92, s100, v92
  ds_write_b128 v246, v[92:95] offset:48256
  v_xor_b32 v103, v103, v99
  v_or3_b32 v100, v100, v101, v102
  v_or_b32 v100, v100, v103
  v_cmp_ne_u32 vcc, 0, v100
  s_waitcnt lgkmcnt(0)
  s_cbranch_vccz U_ok
  s_mov_b32 s11, 20000
  buffer_load_dwordx4 v[96:99], v5, s[60:63], s51 offen sc1
  buffer_load_dwordx4 v[80:83], v5, s[60:63], s44 offen sc1
  buffer_load_dwordx4 v[84:87], v5, s[60:63], s45 offen sc1
  buffer_load_dwordx4 v[88:91], v5, s[60:63], s46 offen sc1
  buffer_load_dwordx4 v[92:95], v5, s[60:63], s47 offen sc1
U_spin:
  s_waitcnt vmcnt(0)
  v_add3_u32 v100, v80, v81, v82
  v_add3_u32 v100, v100, v83, s100
  v_subrev_u32 v80, s100, v80
  ds_write_b128 v246, v[80:83] offset:8320
  v_xor_b32 v100, v100, v96
  v_add3_u32 v101, v84, v85, v86
  v_add3_u32 v101, v101, v87, s100
  v_subrev_u32 v84, s100, v84
  ds_write_b128 v246, v[84:87] offset:21632
  v_xor_b32 v101, v101, v97
  v_add3_u32 v102, v88, v89, v90
  v_add3_u32 v102, v102, v91, s100
  v_subrev_u32 v88, s100, v88
  ds_write_b128 v246, v[88:91] offset:34944
  v_xor_b32 v102, v102, v98
  v_add3_u32 v103, v92, v93, v94
  v_add3_u32 v103, v103, v95, s100
  v_subrev_u32 v92, s100, v92
  ds_write_b128 v246, v[92:95] offset:48256
  v_xor_b32 v103, v103, v99
  v_or3_b32 v100, v100, v101, v102
  v_or_b32 v100, v100, v103
  v_cmp_ne_u32 vcc, 0, v100
  s_waitcnt lgkmcnt(0)
  s_cbranch_vccz U_done
  buffer_load_dwordx4 v[96:99], v5, s[60:63], s51 offen sc1
  buffer_load_dwordx4 v[80:83], v5, s[60:63], s44 offen sc1
  buffer_load_dwordx4 v[84:87], v5, s[60:63], s45 offen sc1
  buffer_load_dwordx4 v[88:91], v5, s[60:63], s46 offen sc1
  buffer_load_dwordx4 v[92:95], v5, s[60:63], s47 offen sc1
  s_sub_u32 s11, s11, 1
  s_cbranch_scc0 U_spin
  s_waitcnt vmcnt(0)
U_done:
U_ok:
  s_barrier
  ds_read_b128 v[16:19], v216 offset:3584
  ds_read_b128 v[20:23], v216 offset:3072
  ds_read_b128 v[24:27], v216 offset:2560
  ds_read_b128 v[28:31], v216 offset:2048
  ds_read_b128 v[32:35], v216 offset:1536
  ds_read_b128 v[36:39], v216 offset:1024
  ds_read_b128 v[40:43], v216 offset:512
  ds_read_b128 v[44:47], v216 offset:0
  s_waitcnt lgkmcnt(7)
  v_mfma_f32_16x16x32_bf16 v[176:179], v[48:51], v[16:19], 0
  s_waitcnt lgkmcnt(6)
  v_mfma_f32_16x16x32_bf16 v[180:183], v[48:51], v[20:23], 0
  s_add_u32 m0, s38, 0
  s_add_u32 s49, s42, 1216512
  s_mov_b32 exec_hi, 0xffffff
  buffer_load_dwordx4 v226, s[64:67], s49 offen offset:0 lds
  buffer_load_dwordx4 v227, s[64:67], s49 offen offset:896 lds
  s_mov_b32 exec_hi, -1
  v_mfma_f32_16x16x32_bf16 v[180:183], v[52:55], v[16:19], v[180:183]
  v_mfma_f32_16x16x32_bf16 v[184:187], v[52:55], v[20:23], 0
  s_waitcnt lgkmcnt(5)
  v_mfma_f32_16x16x32_bf16 v[184:187], v[48:51], v[24:27], v[184:187]
  ds_read_b128 v[80:83], v216 offset:3648
  v_mfma_f32_16x16x32_bf16 v[184:187], v[56:59], v[16:19], v[184:187]
  v_mfma_f32_16x16x32_bf16 v[188:191], v[52:55], v[24:27], 0
  ds_read2_b32 v[112:113], v212 offset0:16 offset1:17
  v_mfma_f32_16x16x32_bf16 v[188:191], v[56:59], v[20:23], v[188:191]
  ds_read2_b32 v[114:115], v212 offset0:18 offset1:19
  s_add_u32 m0, s38, 0
  s_mov_b32 exec_hi, 0xffffff
  buffer_load_dwordx4 v228, s[64:67], s49 offen offset:1792 lds
  buffer_load_dwordx4 v229, s[64:67], s49 offen offset:2688 lds
  s_mov_b32 exec_hi, -1
  v_mfma_f32_16x16x32_bf16 v[192:195], v[56:59], v[24:27], 0
  s_waitcnt lgkmcnt(7)
  v_mfma_f32_16x16x32_bf16 v[188:191], v[48:51], v[28:31], v[188:191]
  ds_read_b128 v[84:87], v216 offset:3136
  v_mfma_f32_16x16x32_bf16 v[188:191], v[60:63], v[16:19], v[188:191]
  ds_read2_b32 v[116:117], v212 offset0:144 offset1:145
  v_mfma_f32_16x16x32_bf16 v[192:195], v[52:55], v[28:31], v[192:195]
  v_mfma_f32_16x16x32_bf16 v[192:195], v[60:63], v[20:23], v[192:195]
  ds_read2_b32 v[118:119], v212 offset0:146 offset1:147
  v_mfma_f32_16x16x32_bf16 v[196:199], v[56:59], v[28:31], 0
  ds_read_b128 v[88:91], v216 offset:2624
  s_add_u32 m0, s38, 14368
  s_add_u32 s49, s42, 1327104
  s_mov_b32 exec_hi, 0xffffff
  buffer_load_dwordx4 v226, s[64:67], s49 offen offset:0 lds
  buffer_load_dwordx4 v227, s[64:67], s49 offen offset:896 lds
  s_mov_b32 exec_hi, -1
  v_mfma_f32_16x16x32_bf16 v[196:199], v[60:63], v[24:27], v[196:199]
  v_mfma_f32_16x16x32_bf16 v[200:203], v[60:63], v[28:31], 0
  s_waitcnt lgkmcnt(10)
  ds_read2_b32 v[120:121], v213 offset0:16 offset1:17
  v_mfma_f32_16x16x32_bf16 v[192:195], v[48:51], v[32:35], v[192:195]
  ds_read2_b32 v[122:123], v213 offset0:18 offset1:19
  v_mfma_f32_16x16x32_bf16 v[192:195], v[64:67], v[16:19], v[192:195]
  v_mfma_f32_16x16x32_bf16 v[196:199], v[52:55], v[32:35], v[196:199]
  ds_read_b128 v[92:95], v216 offset:2112
  v_mfma_f32_16x16x32_bf16 v[196:199], v[64:67], v[20:23], v[196:199]
  ds_read2_b32 v[124:125], v213 offset0:144 offset1:145
  s_add_u32 m0, s38, 14368
  s_mov_b32 exec_hi, 0xffffff
  buffer_load_dwordx4 v228, s[64:67], s49 offen offset:1792 lds
  buffer_load_dwordx4 v229, s[64:67], s49 offen offset:2688 lds
  s_mov_b32 exec_hi, -1
  v_mfma_f32_16x16x32_bf16 v[200:203], v[56:59], v[32:35], v[200:203]
  v_mfma_f32_16x16x32_bf16 v[200:203], v[64:67], v[24:27], v[200:203]
  ds_read2_b32 v[126:127], v213 offset0:146 offset1:147
  v_mfma_f32_16x16x32_bf16 v[204:207], v[60:63], v[32:35], 0
  ds_read_b128 v[96:99], v216 offset:1600
  v_mfma_f32_16x16x32_bf16 v[204:207], v[64:67], v[28:31], v[204:207]
  s_waitcnt lgkmcnt(15)
  v_mfma_f32_16x16x32_bf16 v[196:199], v[48:51], v[36:39], v[196:199]
  ds_read2_b32 v[128:129], v214 offset0:16 offset1:17
  s_barrier
  v_mfma_f32_16x16x32_bf16 v[196:199], v[68:71], v[16:19], v[196:199]
  ds_read2_b32 v[130:131], v214 offset0:18 offset1:19
  s_add_u32 m0, s38, 28736
  s_add_u32 s49, s42, 1437696
  s_mov_b32 exec_hi, 0xffffff
  buffer_load_dwordx4 v226, s[64:67], s49 offen offset:0 lds
  buffer_load_dwordx4 v227, s[64:67], s49 offen offset:896 lds
  s_mov_b32 exec_hi, -1
  v_mfma_f32_16x16x32_bf16 v[200:203], v[52:55], v[36:39], v[200:203]
  v_add_u32 v230, 0xe080, v230
  v_add_u32 v231, 0xe080, v231
  v_mfma_f32_16x16x32_bf16 v[200:203], v[68:71], v[20:23], v[200:203]
  ds_read_b128 v[100:103], v216 offset:1088
  v_add_u32 v232, 0xe080, v232
  v_mfma_f32_16x16x32_bf16 v[204:207], v[56:59], v[36:39], v[204:207]
  ds_read2_b32 v[132:133], v214 offset0:144 offset1:145
  v_add_u32 v233, 0xe080, v233
  v_mfma_f32_16x16x32_bf16 v[204:207], v[68:71], v[24:27], v[204:207]
  s_waitcnt lgkmcnt(15)
  ds_read_b64_tr_b16 a[64:65], v230 offset:0
  ds_read_b64_tr_b16 a[66:67], v230 offset:1792
  v_mfma_f32_16x16x32_bf16 v[200:203], v[48:51], v[40:43], v[200:203]
  ds_read2_b32 v[134:135], v214 offset0:146 offset1:147
  ds_read_b64_tr_b16 a[68:69], v230 offset:7184
  v_mfma_f32_16x16x32_bf16 v[200:203], v[72:75], v[16:19], v[200:203]
  ds_read_b128 v[104:107], v216 offset:576
  s_add_u32 m0, s38, 28736
  s_mov_b32 exec_hi, 0xffffff
  buffer_load_dwordx4 v228, s[64:67], s49 offen offset:1792 lds
  buffer_load_dwordx4 v229, s[64:67], s49 offen offset:2688 lds
  s_mov_b32 exec_hi, -1
  v_mfma_f32_16x16x32_bf16 v[204:207], v[52:55], v[40:43], v[204:207]
  ds_read_b64_tr_b16 a[70:71], v230 offset:8976
  ds_read_b64_tr_b16 a[72:73], v231 offset:0
  v_mfma_f32_16x16x32_bf16 v[204:207], v[72:75], v[20:23], v[204:207]
  ds_read2_b32 v[136:137], v215 offset0:16 offset1:17
  ds_read_b64_tr_b16 a[74:75], v231 offset:1792
  v_mfma_f32_16x16x32_bf16 v[204:207], v[48:51], v[44:47], v[204:207]
  ds_read2_b32 v[138:139], v215 offset0:18 offset1:19
  ds_read_b64_tr_b16 a[76:77], v232 offset:0
  v_mfma_f32_16x16x32_bf16 v[204:207], v[76:79], v[16:19], v[204:207]
  ds_read_b64_tr_b16 a[78:79], v233 offset:0
  ds_read_b64_tr_b16 a[80:81], v230 offset:14368
  v_mfma_f32_16x16x32_bf16 v[176:179], v[208:211], v[16:19], v[176:179]
  ds_read_b128 v[108:111], v216 offset:64
  ds_read_b64_tr_b16 a[82:83], v230 offset:16160
  v_mfma_f32_16x16x32_bf16 v[180:183], v[208:211], v[20:23], v[180:183]
  ds_read2_b32 v[140:141], v215 offset0:144 offset1:145
  s_add_u32 m0, s38, 43104
  s_add_u32 s49, s42, 1548288
  s_mov_b32 exec_hi, 0xffffff
  buffer_load_dwordx4 v226, s[64:67], s49 offen offset:0 lds
  buffer_load_dwordx4 v227, s[64:67], s49 offen offset:896 lds
  s_mov_b32 exec_hi, -1
  v_mfma_f32_16x16x32_bf16 v[184:187], v[208:211], v[24:27], v[184:187]
  ds_read_b64_tr_b16 a[84:85], v230 offset:21552
  ds_read_b64_tr_b16 a[86:87], v230 offset:23344
  v_mfma_f32_16x16x32_bf16 v[188:191], v[208:211], v[28:31], v[188:191]
  ds_read2_b32 v[142:143], v215 offset0:146 offset1:147
  ds_read_b64_tr_b16 a[88:89], v231 offset:14368
  v_mfma_f32_16x16x32_bf16 v[192:195], v[208:211], v[32:35], v[192:195]
  ds_read_b64_tr_b16 a[90:91], v231 offset:16160
  ds_read_b64_tr_b16 a[92:93], v232 offset:14368
  v_mfma_f32_16x16x32_bf16 v[196:199], v[208:211], v[36:39], v[196:199]
  ds_read_b64_tr_b16 a[94:95], v233 offset:14368
  ds_read_b64_tr_b16 a[96:97], v230 offset:28736
  v_mfma_f32_16x16x32_bf16 v[200:203], v[208:211], v[40:43], v[200:203]
  ds_read_b64_tr_b16 a[98:99], v230 offset:30528
  ds_read_b64_tr_b16 a[100:101], v230 offset:35920
  v_mfma_f32_16x16x32_bf16 v[204:207], v[208:211], v[44:47], v[204:207]
  s_waitcnt lgkmcnt(15)
  s_add_u32 m0, s38, 43104
  s_mov_b32 exec_hi, 0xffffff
  buffer_load_dwordx4 v228, s[64:67], s49 offen offset:1792 lds
  buffer_load_dwordx4 v229, s[64:67], s49 offen offset:2688 lds
  s_mov_b32 exec_hi, -1
  v_mfma_f32_16x16x32_bf16 v[176:179], v[112:115], v[80:83], v[176:179]
  ds_read_b64_tr_b16 a[102:103], v230 offset:37712
  ds_read_b64_tr_b16 a[104:105], v231 offset:28736
  v_mfma_f32_16x16x32_bf16 v[180:183], v[112:115], v[84:87], v[180:183]
  ds_read_b64_tr_b16 a[106:107], v231 offset:30528
  ds_read_b64_tr_b16 a[108:109], v232 offset:28736
  v_mfma_f32_16x16x32_bf16 v[180:183], v[116:119], v[80:83], v[180:183]
  ds_read_b64_tr_b16 a[110:111], v233 offset:28736
  v_mfma_f32_16x16x32_bf16 v[184:187], v[116:119], v[84:87], v[184:187]
  v_mfma_f32_16x16x32_bf16 v[184:187], v[112:115], v[88:91], v[184:187]
  ds_read_b128 v[16:19], v216 offset:3712
  v_mfma_f32_16x16x32_bf16 v[184:187], v[120:123], v[80:83], v[184:187]
  s_waitcnt lgkmcnt(1)
  s_barrier
  v_mfma_f32_16x16x32_bf16 v[188:191], v[116:119], v[88:91], v[188:191]
  ds_read2_b32 v[48:49], v212 offset0:32 offset1:33
  s_add_u32 m0, s38, 57472
  s_add_u32 s49, s42, 1658880
  s_mov_b32 exec_hi, 0xffffff
  buffer_load_dwordx4 v226, s[64:67], s49 offen offset:0 lds
  buffer_load_dwordx4 v227, s[64:67], s49 offen offset:896 lds
  s_mov_b32 exec_hi, -1
  v_mfma_f32_16x16x32_bf16 v[188:191], v[120:123], v[84:87], v[188:191]
  ds_read2_b32 v[50:51], v212 offset0:34 offset1:35
  v_mfma_f32_16x16x32_bf16 v[192:195], v[120:123], v[88:91], v[192:195]
  v_mfma_f32_16x16x32_bf16 v[188:191], v[112:115], v[92:95], v[188:191]
  ds_read_b128 v[20:23], v216 offset:3200
  v_mfma_f32_16x16x32_bf16 v[188:191], v[124:127], v[80:83], v[188:191]
  ds_read2_b32 v[52:53], v212 offset0:160 offset1:161
  v_mfma_f32_16x16x32_bf16 v[192:195], v[116:119], v[92:95], v[192:195]
  v_mfma_f32_16x16x32_bf16 v[192:195], v[124:127], v[84:87], v[192:195]
  ds_read2_b32 v[54:55], v212 offset0:162 offset1:163
  s_add_u32 m0, s38, 57472
  s_mov_b32 exec_hi, 0xffffff
  buffer_load_dwordx4 v228, s[64:67], s49 offen offset:1792 lds
  buffer_load_dwordx4 v229, s[64:67], s49 offen offset:2688 lds
  s_mov_b32 exec_hi, -1
  v_mfma_f32_16x16x32_bf16 v[196:199], v[120:123], v[92:95], v[196:199]
  ds_read_b128 v[24:27], v216 offset:2688
  v_mfma_f32_16x16x32_bf16 v[196:199], v[124:127], v[88:91], v[196:199]
  v_mfma_f32_16x16x32_bf16 v[200:203], v[124:127], v[92:95], v[200:203]
  ds_read2_b32 v[56:57], v213 offset0:32 offset1:33
  v_mfma_f32_16x16x32_bf16 v[192:195], v[112:115], v[96:99], v[192:195]
  ds_read2_b32 v[58:59], v213 offset0:34 offset1:35
  v_mfma_f32_16x16x32_bf16 v[192:195], v[128:131], v[80:83], v[192:195]
  v_mfma_f32_16x16x32_bf16 v[196:199], v[116:119], v[96:99], v[196:199]
  ds_read_b128 v[28:31], v216 offset:2176
  s_add_u32 m0, s38, 71840
  s_add_u32 s49, s42, 1769472
  s_mov_b32 exec_hi, 0xffffff
  buffer_load_dwordx4 v226, s[64:67], s49 offen offset:0 lds
  buffer_load_dwordx4 v227, s[64:67], s49 offen offset:896 lds
  s_mov_b32 exec_hi, -1
  v_mfma_f32_16x16x32_bf16 v[196:199], v[128:131], v[84:87], v[196:199]
  ds_read2_b32 v[60:61], v213 offset0:160 offset1:161
  v_mfma_f32_16x16x32_bf16 v[200:203], v[120:123], v[96:99], v[200:203]
  v_mfma_f32_16x16x32_bf16 v[200:203], v[128:131], v[88:91], v[200:203]
  ds_read2_b32 v[62:63], v213 offset0:162 offset1:163
  v_mfma_f32_16x16x32_bf16 v[204:207], v[124:127], v[96:99], v[204:207]
  ds_read_b128 v[32:35], v216 offset:1664
  v_mfma_f32_16x16x32_bf16 v[204:207], v[128:131], v[92:95], v[204:207]
  v_mfma_f32_16x16x32_bf16 v[196:199], v[112:115], v[100:103], v[196:199]
  ds_read2_b32 v[64:65], v214 offset0:32 offset1:33
  s_add_u32 m0, s38, 71840
  s_mov_b32 exec_hi, 0xffffff
  buffer_load_dwordx4 v228, s[64:67], s49 offen offset:1792 lds
  buffer_load_dwordx4 v229, s[64:67], s49 offen offset:2688 lds
  s_mov_b32 exec_hi, -1
  v_mfma_f32_16x16x32_bf16 v[196:199], v[132:135], v[80:83], v[196:199]
  ds_read2_b32 v[66:67], v214 offset0:34 offset1:35
  v_mfma_f32_16x16x32_bf16 v[200:203], v[116:119], v[100:103], v[200:203]
  v_mfma_f32_16x16x32_bf16 v[200:203], v[132:135], v[84:87], v[200:203]
  ds_read_b128 v[36:39], v216 offset:1152
  v_mfma_f32_16x16x32_bf16 v[204:207], v[120:123], v[100:103], v[204:207]
  ds_read2_b32 v[68:69], v214 offset0:160 offset1:161
  v_mfma_f32_16x16x32_bf16 v[204:207], v[132:135], v[88:91], v[204:207]
  ds_read2_b32 v[70:71], v214 offset0:162 offset1:163
  v_mfma_f32_16x16x32_bf16 v[200:203], v[112:115], v[104:107], v[200:203]
  ds_read_b128 v[40:43], v216 offset:640
  s_add_u32 m0, s38, 86208
  s_add_u32 s49, s42, 1880064
  s_mov_b32 exec_hi, 0xffffff
  buffer_load_dwordx4 v226, s[64:67], s49 offen offset:0 lds
  buffer_load_dwordx4 v227, s[64:67], s49 offen offset:896 lds
  s_mov_b32 exec_hi, -1
  v_mfma_f32_16x16x32_bf16 v[200:203], v[136:139], v[80:83], v[200:203]
  ds_read2_b32 v[72:73], v215 offset0:32 offset1:33
  v_mfma_f32_16x16x32_bf16 v[204:207], v[116:119], v[104:107], v[204:207]
  ds_read2_b32 v[74:75], v215 offset0:34 offset1:35
  v_mfma_f32_16x16x32_bf16 v[204:207], v[136:139], v[84:87], v[204:207]
  ds_read_b128 v[44:47], v216 offset:128
  v_mfma_f32_16x16x32_bf16 v[204:207], v[112:115], v[108:111], v[204:207]
  ds_read2_b32 v[76:77], v215 offset0:160 offset1:161
  v_mfma_f32_16x16x32_bf16 v[204:207], v[140:143], v[80:83], v[204:207]
  s_waitcnt lgkmcnt(15)
  ds_read2_b32 v[78:79], v215 offset0:162 offset1:163
  v_mfma_f32_16x16x32_bf16 v[176:179], v[48:51], v[16:19], v[176:179]
  s_add_u32 m0, s38, 86208
  s_mov_b32 exec_hi, 0xffffff
  buffer_load_dwordx4 v228, s[64:67], s49 offen offset:1792 lds
  buffer_load_dwordx4 v229, s[64:67], s49 offen offset:2688 lds
  s_mov_b32 exec_hi, -1
  v_mfma_f32_16x16x32_bf16 v[180:183], v[48:51], v[20:23], v[180:183]
  v_mfma_f32_16x16x32_bf16 v[180:183], v[52:55], v[16:19], v[180:183]
  v_mfma_f32_16x16x32_bf16 v[184:187], v[52:55], v[20:23], v[184:187]
  v_mfma_f32_16x16x32_bf16 v[184:187], v[48:51], v[24:27], v[184:187]
  s_waitcnt lgkmcnt(15)
  ds_read_b128 v[80:83], v216 offset:3776
  s_cmp_lg_u32 s3, 0
  s_cbranch_scc1 GS_l
  buffer_load_dwordx4 v[172:175], v222, s[60:63], s39 offen offset:0 sc1
GS_l:
  v_mfma_f32_16x16x32_bf16 v[184:187], v[56:59], v[16:19], v[184:187]
  s_waitcnt vmcnt(12)
  s_barrier
  v_mfma_f32_16x16x32_bf16 v[188:191], v[52:55], v[24:27], v[188:191]
  ds_read2_b32 v[112:113], v212 offset0:48 offset1:49
  v_add_u32 v230, 0xffff1f80, v230
  v_mfma_f32_16x16x32_bf16 v[188:191], v[56:59], v[20:23], v[188:191]
  ds_read2_b32 v[114:115], v212 offset0:50 offset1:51
  buffer_store_dwordx4 v[236:239], v5, s[60:63], s13 offen offset:0 sc1
  v_mfma_f32_16x16x32_bf16 v[192:195], v[56:59], v[24:27], v[192:195]
  s_waitcnt lgkmcnt(15)
  v_add_u32 v231, 0xffff1f80, v231
  v_add_u32 v232, 0xffff1f80, v232
  v_mfma_f32_16x16x32_bf16 v[188:191], v[48:51], v[28:31], v[188:191]
  ds_read_b128 v[84:87], v216 offset:3264
  v_add_u32 v233, 0xffff1f80, v233
  v_mfma_f32_16x16x32_bf16 v[188:191], v[60:63], v[16:19], v[188:191]
  ds_read2_b32 v[116:117], v212 offset0:176 offset1:177
  ds_read_b64_tr_b16 a[112:113], v230 offset:0
  v_mfma_f32_16x16x32_bf16 v[192:195], v[52:55], v[28:31], v[192:195]
  ds_read_b64_tr_b16 a[114:115], v230 offset:1792
  ds_read_b64_tr_b16 a[116:117], v230 offset:7184
  v_mfma_f32_16x16x32_bf16 v[192:195], v[60:63], v[20:23], v[192:195]
  ds_read2_b32 v[118:119], v212 offset0:178 offset1:179
  ds_read_b64_tr_b16 a[118:119], v230 offset:8976
  v_mfma_f32_16x16x32_bf16 v[196:199], v[56:59], v[28:31], v[196:199]
  ds_read_b128 v[88:91], v216 offset:2752
  buffer_store_dwordx4 v[236:239], v5, s[60:63], s13 offen offset:1024 sc1
  v_mfma_f32_16x16x32_bf16 v[196:199], v[60:63], v[24:27], v[196:199]
  ds_read_b64_tr_b16 a[120:121], v231 offset:0
  ds_read_b64_tr_b16 a[122:123], v231 offset:1792
  v_mfma_f32_16x16x32_bf16 v[200:203], v[60:63], v[28:31], v[200:203]
  s_waitcnt lgkmcnt(15)
  ds_read2_b32 v[120:121], v213 offset0:48 offset1:49
  ds_read_b64_tr_b16 a[124:125], v232 offset:0
  v_mfma_f32_16x16x32_bf16 v[192:195], v[48:51], v[32:35], v[192:195]
  ds_read2_b32 v[122:123], v213 offset0:50 offset1:51
  ds_read_b64_tr_b16 a[126:127], v233 offset:0
  v_mfma_f32_16x16x32_bf16 v[192:195], v[64:67], v[16:19], v[192:195]
  ds_read_b64_tr_b16 a[128:129], v230 offset:14368
  ds_read_b64_tr_b16 a[130:131], v230 offset:16160
  v_mfma_f32_16x16x32_bf16 v[196:199], v[52:55], v[32:35], v[196:199]
  ds_read_b128 v[92:95], v216 offset:2240
  ds_read_b64_tr_b16 a[132:133], v230 offset:21552
  v_mfma_f32_16x16x32_bf16 v[196:199], v[64:67], v[20:23], v[196:199]
  ds_read2_b32 v[124:125], v213 offset0:176 offset1:177
  buffer_store_dwordx4 v[236:239], v5, s[60:63], s13 offen offset:2048 sc1
  v_mfma_f32_16x16x32_bf16 v[200:203], v[56:59], v[32:35], v[200:203]
  ds_read_b64_tr_b16 a[134:135], v230 offset:23344
  ds_read_b64_tr_b16 a[136:137], v231 offset:14368
  v_mfma_f32_16x16x32_bf16 v[200:203], v[64:67], v[24:27], v[200:203]
  ds_read2_b32 v[126:127], v213 offset0:178 offset1:179
  ds_read_b64_tr_b16 a[138:139], v231 offset:16160
  v_mfma_f32_16x16x32_bf16 v[204:207], v[60:63], v[32:35], v[204:207]
  ds_read_b128 v[96:99], v216 offset:1728
  ds_read_b64_tr_b16 a[140:141], v232 offset:14368
  v_mfma_f32_16x16x32_bf16 v[204:207], v[64:67], v[28:31], v[204:207]
  ds_read_b64_tr_b16 a[142:143], v233 offset:14368
  ds_read_b64_tr_b16 a[144:145], v230 offset:28736
  v_mfma_f32_16x16x32_bf16 v[196:199], v[48:51], v[36:39], v[196:199]
  ds_read2_b32 v[128:129], v214 offset0:48 offset1:49
  ds_read_b64_tr_b16 a[146:147], v230 offset:30528
  v_mfma_f32_16x16x32_bf16 v[196:199], v[68:71], v[16:19], v[196:199]
  ds_read2_b32 v[130:131], v214 offset0:50 offset1:51
  buffer_store_dwordx4 v[236:239], v5, s[60:63], s13 offen offset:3072 sc1
  v_mfma_f32_16x16x32_bf16 v[200:203], v[52:55], v[36:39], v[200:203]
  ds_read_b64_tr_b16 a[148:149], v230 offset:35920
  ds_read_b64_tr_b16 a[150:151], v230 offset:37712
  v_mfma_f32_16x16x32_bf16 v[200:203], v[68:71], v[20:23], v[200:203]
  ds_read_b128 v[100:103], v216 offset:1216
  ds_read_b64_tr_b16 a[152:153], v231 offset:28736
  v_mfma_f32_16x16x32_bf16 v[204:207], v[56:59], v[36:39], v[204:207]
  ds_read2_b32 v[132:133], v214 offset0:176 offset1:177
  ds_read_b64_tr_b16 a[154:155], v231 offset:30528
  v_mfma_f32_16x16x32_bf16 v[204:207], v[68:71], v[24:27], v[204:207]
  ds_read2_b32 v[134:135], v214 offset0:178 offset1:179
  ds_read_b64_tr_b16 a[156:157], v232 offset:28736
  v_mfma_f32_16x16x32_bf16 v[200:203], v[48:51], v[40:43], v[200:203]
  ds_read_b128 v[104:107], v216 offset:704
  ds_read_b64_tr_b16 a[158:159], v233 offset:28736
  v_mfma_f32_16x16x32_bf16 v[200:203], v[72:75], v[16:19], v[200:203]
  ds_read2_b32 v[136:137], v215 offset0:48 offset1:49
  buffer_store_dword v236, v247, s[60:63], s28 offen sc1
  v_mfma_f32_16x16x32_bf16 v[204:207], v[52:55], v[40:43], v[204:207]
  ds_read2_b32 v[138:139], v215 offset0:50 offset1:51
  ds_read_b64_tr_b16 a[160:161], v230 offset:43104
  v_mfma_f32_16x16x32_bf16 v[204:207], v[72:75], v[20:23], v[204:207]
  ds_read_b128 v[108:111], v216 offset:192
  ds_read_b64_tr_b16 a[162:163], v230 offset:44896
  v_mfma_f32_16x16x32_bf16 v[204:207], v[48:51], v[44:47], v[204:207]
  s_waitcnt lgkmcnt(15)
  ds_read2_b32 v[140:141], v215 offset0:176 offset1:177
  ds_read_b64_tr_b16 a[164:165], v230 offset:50288
  v_mfma_f32_16x16x32_bf16 v[204:207], v[76:79], v[16:19], v[204:207]
  ds_read2_b32 v[142:143], v215 offset0:178 offset1:179
  ds_read_b64_tr_b16 a[166:167], v230 offset:52080
  v_mfma_f32_16x16x32_bf16 v[176:179], v[112:115], v[80:83], v[176:179]
  ds_read_b64_tr_b16 a[168:169], v231 offset:43104
  ds_read_b64_tr_b16 a[170:171], v231 offset:44896
  v_mfma_f32_16x16x32_bf16 v[180:183], v[112:115], v[84:87], v[180:183]
  ds_read_b64_tr_b16 a[172:173], v232 offset:43104
  ds_read_b64_tr_b16 a[174:175], v233 offset:43104
  v_mfma_f32_16x16x32_bf16 v[180:183], v[116:119], v[80:83], v[180:183]
  v_mfma_f32_16x16x32_bf16 v[184:187], v[116:119], v[84:87], v[184:187]
  v_mfma_f32_16x16x32_bf16 v[184:187], v[112:115], v[88:91], v[184:187]
  ds_read_b128 v[16:19], v216 offset:3840
  v_mfma_f32_16x16x32_bf16 v[184:187], v[120:123], v[80:83], v[184:187]
  v_mfma_f32_16x16x32_bf16 v[188:191], v[116:119], v[88:91], v[188:191]
  ds_read2_b32 v[48:49], v212 offset0:64 offset1:65
  v_mfma_f32_16x16x32_bf16 v[188:191], v[120:123], v[84:87], v[188:191]
  ds_read2_b32 v[50:51], v212 offset0:66 offset1:67
  v_mfma_f32_16x16x32_bf16 v[192:195], v[120:123], v[88:91], v[192:195]
  v_mfma_f32_16x16x32_bf16 v[188:191], v[112:115], v[92:95], v[188:191]
  ds_read_b128 v[20:23], v216 offset:3328
  v_mfma_f32_16x16x32_bf16 v[188:191], v[124:127], v[80:83], v[188:191]
  ds_read2_b32 v[52:53], v212 offset0:192 offset1:193
  v_mfma_f32_16x16x32_bf16 v[192:195], v[116:119], v[92:95], v[192:195]
  s_cmp_lg_u32 s3, 0
  s_cbranch_scc1 GS_c
  s_waitcnt vmcnt(5)
  v_cmp_ne_u64 s[68:69], s[100:101], v[174:175]
  v_cmp_ne_u64 vcc, s[100:101], v[172:173]
  s_nop 0
  s_or_b64 vcc, vcc, s[68:69]
  s_cbranch_vccz GS_ok
  s_waitcnt lgkmcnt(0)
  s_mov_b32 s11, 20000
  buffer_load_dwordx4 v[172:175], v222, s[60:63], s39 offen offset:0 sc1
GS_spin:
  s_waitcnt vmcnt(0)
  v_cmp_ne_u64 s[68:69], s[100:101], v[174:175]
  v_cmp_ne_u64 vcc, s[100:101], v[172:173]
  s_nop 0
  s_or_b64 vcc, vcc, s[68:69]
  s_cbranch_vccz GS_done
  buffer_load_dwordx4 v[172:175], v222, s[60:63], s39 offen offset:0 sc1
  s_sub_u32 s11, s11, 1
  s_cbranch_scc0 GS_spin
  s_waitcnt vmcnt(0)
GS_done:
GS_ok:
GS_c:
  v_mfma_f32_16x16x32_bf16 v[192:195], v[124:127], v[84:87], v[192:195]
  ds_read2_b32 v[54:55], v212 offset0:194 offset1:195
  v_mfma_f32_16x16x32_bf16 v[196:199], v[120:123], v[92:95], v[196:199]
  ds_read_b128 v[24:27], v216 offset:2816
  s_waitcnt vmcnt(5)
  s_waitcnt lgkmcnt(7)
  s_barrier
  v_mfma_f32_16x16x32_bf16 v[196:199], v[124:127], v[88:91], v[196:199]
  s_mov_b32 m0, s57
  s_nop 0
  buffer_load_dwordx4 v5, s[60:63], s56 offen lds
  v_add_u32 v230, 0xe080, v230
  v_mfma_f32_16x16x32_bf16 v[200:203], v[124:127], v[92:95], v[200:203]
  s_mov_b32 m0, s57
  ds_read2_b32 v[56:57], v213 offset0:64 offset1:65
  buffer_load_dwordx4 v5, s[60:63], s56 offen offset:1024 lds
  v_mfma_f32_16x16x32_bf16 v[192:195], v[112:115], v[96:99], v[192:195]
  ds_read2_b32 v[58:59], v213 offset0:66 offset1:67
  v_add_u32 v231, 0xe080, v231
  v_mfma_f32_16x16x32_bf16 v[192:195], v[128:131], v[80:83], v[192:195]
  buffer_load_dwordx2 v[208:209], v217, s[60:63], s12 offen offset:0 sc1
  v_add_u32 v232, 0xe080, v232
  v_mfma_f32_16x16x32_bf16 v[196:199], v[116:119], v[96:99], v[196:199]
  ds_read_b128 v[28:31], v216 offset:2304
  v_add_u32 v233, 0xe080, v233
  v_mfma_f32_16x16x32_bf16 v[196:199], v[128:131], v[84:87], v[196:199]
  ds_read2_b32 v[60:61], v213 offset0:192 offset1:193
  ds_read_b64_tr_b16 a[176:177], v230 offset:0
  v_mfma_f32_16x16x32_bf16 v[200:203], v[120:123], v[96:99], v[200:203]
  ds_read_b64_tr_b16 a[178:179], v230 offset:1792
  ds_read_b64_tr_b16 a[180:181], v230 offset:7184
  v_mfma_f32_16x16x32_bf16 v[200:203], v[128:131], v[88:91], v[200:203]
  ds_read2_b32 v[62:63], v213 offset0:194 offset1:195
  ds_read_b64_tr_b16 a[182:183], v230 offset:8976
  v_mfma_f32_16x16x32_bf16 v[204:207], v[124:127], v[96:99], v[204:207]
  ds_read_b128 v[32:35], v216 offset:1792
  ds_read_b64_tr_b16 a[184:185], v231 offset:0
  v_mfma_f32_16x16x32_bf16 v[204:207], v[128:131], v[92:95], v[204:207]
  buffer_load_dwordx2 v[210:211], v217, s[60:63], s12 offen offset:512 sc1
  ds_read_b64_tr_b16 a[186:187], v231 offset:1792
  v_mfma_f32_16x16x32_bf16 v[196:199], v[112:115], v[100:103], v[196:199]
  ds_read2_b32 v[64:65], v214 offset0:64 offset1:65
  ds_read_b64_tr_b16 a[188:189], v232 offset:0
  v_mfma_f32_16x16x32_bf16 v[196:199], v[132:135], v[80:83], v[196:199]
  ds_read2_b32 v[66:67], v214 offset0:66 offset1:67
  ds_read_b64_tr_b16 a[190:191], v233 offset:0
  v_mfma_f32_16x16x32_bf16 v[200:203], v[116:119], v[100:103], v[200:203]
  ds_read_b64_tr_b16 a[192:193], v230 offset:14368
  ds_read_b64_tr_b16 a[194:195], v230 offset:16160
  v_mfma_f32_16x16x32_bf16 v[200:203], v[132:135], v[84:87], v[200:203]
  ds_read_b128 v[36:39], v216 offset:1280
  ds_read_b64_tr_b16 a[196:197], v230 offset:21552
  v_mfma_f32_16x16x32_bf16 v[204:207], v[120:123], v[100:103], v[204:207]
  ds_read2_b32 v[68:69], v214 offset0:192 offset1:193
  ds_read_b64_tr_b16 a[198:199], v230 offset:23344
  v_mfma_f32_16x16x32_bf16 v[204:207], v[132:135], v[88:91], v[204:207]
  ds_read2_b32 v[70:71], v214 offset0:194 offset1:195
  buffer_load_dwordx2 v[224:225], v217, s[60:63], s12 offen offset:1024 sc1
  v_mfma_f32_16x16x32_bf16 v[200:203], v[112:115], v[104:107], v[200:203]
  ds_read_b128 v[40:43], v216 offset:768
  ds_read_b64_tr_b16 a[200:201], v231 offset:14368
  v_mfma_f32_16x16x32_bf16 v[200:203], v[136:139], v[80:83], v[200:203]
  ds_read2_b32 v[72:73], v215 offset0:64 offset1:65
  ds_read_b64_tr_b16 a[202:203], v231 offset:16160
  v_mfma_f32_16x16x32_bf16 v[204:207], v[116:119], v[104:107], v[204:207]
  ds_read2_b32 v[74:75], v215 offset0:66 offset1:67
  ds_read_b64_tr_b16 a[204:205], v232 offset:14368
  v_mfma_f32_16x16x32_bf16 v[204:207], v[136:139], v[84:87], v[204:207]
  ds_read_b128 v[44:47], v216 offset:256
  s_add_u32 m0, s38, 14368
  s_add_u32 s49, s42, 442368
  s_mov_b32 exec_hi, 0xffffff
  buffer_load_dwordx4 v226, s[64:67], s49 offen offset:0 lds
  buffer_load_dwordx4 v227, s[64:67], s49 offen offset:896 lds
  s_mov_b32 exec_hi, -1
  v_mfma_f32_16x16x32_bf16 v[204:207], v[112:115], v[108:111], v[204:207]
  ds_read2_b32 v[76:77], v215 offset0:192 offset1:193
  ds_read_b64_tr_b16 a[206:207], v233 offset:14368
  v_mfma_f32_16x16x32_bf16 v[204:207], v[140:143], v[80:83], v[204:207]
  s_waitcnt lgkmcnt(15)
  ds_read2_b32 v[78:79], v215 offset0:194 offset1:195
  buffer_load_dwordx2 v[234:235], v217, s[60:63], s12 offen offset:1536 sc1
  v_mfma_f32_16x16x32_bf16 v[176:179], v[48:51], v[16:19], v[176:179]
  ds_read_b64_tr_b16 a[208:209], v230 offset:28736
  ds_read_b64_tr_b16 a[210:211], v230 offset:30528
  v_mfma_f32_16x16x32_bf16 v[180:183], v[48:51], v[20:23], v[180:183]
  ds_read_b64_tr_b16 a[212:213], v230 offset:35920
  ds_read_b64_tr_b16 a[214:215], v230 offset:37712
  v_mfma_f32_16x16x32_bf16 v[180:183], v[52:55], v[16:19], v[180:183]
  ds_read_b64_tr_b16 a[216:217], v231 offset:28736
  ds_read_b64_tr_b16 a[218:219], v231 offset:30528
  v_mfma_f32_16x16x32_bf16 v[184:187], v[52:55], v[20:23], v[184:187]
  ds_read_b64_tr_b16 a[220:221], v232 offset:28736
  ds_read_b64_tr_b16 a[222:223], v233 offset:28736
  v_mfma_f32_16x16x32_bf16 v[184:187], v[48:51], v[24:27], v[184:187]
  ds_read_b128 v[80:83], v216 offset:3904
  v_add_u32 v230, 0xffff1f80, v230
  v_mfma_f32_16x16x32_bf16 v[184:187], v[56:59], v[16:19], v[184:187]
  buffer_load_dwordx2 v[240:241], v217, s[60:63], s12 offen offset:2048 sc1
  v_add_u32 v231, 0xffff1f80, v231
  v_mfma_f32_16x16x32_bf16 v[188:191], v[52:55], v[24:27], v[188:191]
  ds_read2_b32 v[112:113], v212 offset0:80 offset1:81
  v_add_u32 v232, 0xffff1f80, v232
  v_mfma_f32_16x16x32_bf16 v[188:191], v[56:59], v[20:23], v[188:191]
  ds_read2_b32 v[114:115], v212 offset0:82 offset1:83
  s_add_u32 m0, s38, 14368
  s_mov_b32 exec_hi, 0xffffff
  buffer_load_dwordx4 v228, s[64:67], s49 offen offset:1792 lds
  buffer_load_dwordx4 v229, s[64:67], s49 offen offset:2688 lds
  s_mov_b32 exec_hi, -1
  v_mfma_f32_16x16x32_bf16 v[192:195], v[56:59], v[24:27], v[192:195]
  v_add_u32 v233, 0xffff1f80, v233
  v_mfma_f32_16x16x32_bf16 v[188:191], v[48:51], v[28:31], v[188:191]
  ds_read_b128 v[84:87], v216 offset:3392
  v_mfma_f32_16x16x32_bf16 v[188:191], v[60:63], v[16:19], v[188:191]
  ds_read2_b32 v[116:117], v212 offset0:208 offset1:209
  v_mfma_f32_16x16x32_bf16 v[192:195], v[52:55], v[28:31], v[192:195]
  buffer_load_dwordx2 v[242:243], v217, s[60:63], s12 offen offset:2560 sc1
  v_mfma_f32_16x16x32_bf16 v[192:195], v[60:63], v[20:23], v[192:195]
  ds_read2_b32 v[118:119], v212 offset0:210 offset1:211
  v_mfma_f32_16x16x32_bf16 v[196:199], v[56:59], v[28:31], v[196:199]
  ds_read_b128 v[88:91], v216 offset:2880
  v_mfma_f32_16x16x32_bf16 v[196:199], v[60:63], v[24:27], v[196:199]
  v_mfma_f32_16x16x32_bf16 v[200:203], v[60:63], v[28:31], v[200:203]
  ds_read2_b32 v[120:121], v213 offset0:80 offset1:81
  v_mfma_f32_16x16x32_bf16 v[192:195], v[48:51], v[32:35], v[192:195]
  ds_read2_b32 v[122:123], v213 offset0:82 offset1:83
  v_mfma_f32_16x16x32_bf16 v[192:195], v[64:67], v[16:19], v[192:195]
  s_add_u32 m0, s38, 28736
  s_add_u32 s49, s42, 552960
  s_mov_b32 exec_hi, 0xffffff
  buffer_load_dwordx4 v226, s[64:67], s49 offen offset:0 lds
  buffer_load_dwordx4 v227, s[64:67], s49 offen offset:896 lds
  s_mov_b32 exec_hi, -1
  v_mfma_f32_16x16x32_bf16 v[196:199], v[52:55], v[32:35], v[196:199]
  ds_read_b128 v[92:95], v216 offset:2368
  s_waitcnt vmcnt(12)
  s_waitcnt lgkmcnt(10)
  s_barrier
  v_mfma_f32_16x16x32_bf16 v[196:199], v[64:67], v[20:23], v[196:199]
  ds_read2_b32 v[124:125], v213 offset0:208 offset1:209
  buffer_load_dwordx2 v[250:251], v217, s[60:63], s12 offen offset:3072 sc1
  v_mfma_f32_16x16x32_bf16 v[200:203], v[56:59], v[32:35], v[200:203]
  ds_read_b128 v[144:147], v221 offset:0
  v_mfma_f32_16x16x32_bf16 v[200:203], v[64:67], v[24:27], v[200:203]
  ds_read2_b32 v[126:127], v213 offset0:210 offset1:211
  v_mfma_f32_16x16x32_bf16 v[204:207], v[60:63], v[32:35], v[204:207]
  ds_read_b128 v[96:99], v216 offset:1856
  v_mfma_f32_16x16x32_bf16 v[204:207], v[64:67], v[28:31], v[204:207]
  buffer_load_dwordx2 v[252:253], v217, s[60:63], s12 offen offset:3584 sc1
  v_mfma_f32_16x16x32_bf16 v[196:199], v[48:51], v[36:39], v[196:199]
  ds_read2_b32 v[128:129], v214 offset0:80 offset1:81
  v_mfma_f32_16x16x32_bf16 v[196:199], v[68:71], v[16:19], v[196:199]
  ds_read2_b32 v[130:131], v214 offset0:82 offset1:83
  v_mfma_f32_16x16x32_bf16 v[200:203], v[52:55], v[36:39], v[200:203]
  s_waitcnt vmcnt(13)
  v_perm_b32 v6, v15, v208, s50
  v_perm_b32 v7, v15, v208, s52
  v_mfma_f32_16x16x32_bf16 v[200:203], v[68:71], v[20:23], v[200:203]
  ds_read_b128 v[100:103], v216 offset:1344
  s_add_u32 m0, s38, 28736
  s_mov_b32 exec_hi, 0xffffff
  buffer_load_dwordx4 v228, s[64:67], s49 offen offset:1792 lds
  buffer_load_dwordx4 v229, s[64:67], s49 offen offset:2688 lds
  s_mov_b32 exec_hi, -1
  v_mfma_f32_16x16x32_bf16 v[204:207], v[56:59], v[36:39], v[204:207]
  ds_read2_b32 v[132:133], v214 offset0:208 offset1:209
  v_perm_b32 v8, v15, v209, s50
  v_mfma_f32_16x16x32_bf16 v[204:207], v[68:71], v[24:27], v[204:207]
  ds_read2_b32 v[134:135], v214 offset0:210 offset1:211
  v_perm_b32 v9, v15, v209, s52
  v_mfma_f32_16x16x32_bf16 v[200:203], v[48:51], v[40:43], v[200:203]
  s_waitcnt lgkmcnt(7)
  ds_read_b128 v[104:107], v216 offset:832
  v_dot2_f32_bf16 v144, v6, v144, 0
  v_mfma_f32_16x16x32_bf16 v[200:203], v[72:75], v[16:19], v[200:203]
  ds_read2_b32 v[136:137], v215 offset0:80 offset1:81
  v_dot2_f32_bf16 v145, v7, v145, 0
  v_mfma_f32_16x16x32_bf16 v[204:207], v[52:55], v[40:43], v[204:207]
  ds_read2_b32 v[138:139], v215 offset0:82 offset1:83
  v_dot2_f32_bf16 v146, v8, v146, 0
  v_mfma_f32_16x16x32_bf16 v[204:207], v[72:75], v[20:23], v[204:207]
  ds_read_b128 v[108:111], v216 offset:320
  v_dot2_f32_bf16 v147, v9, v147, 0
  v_mfma_f32_16x16x32_bf16 v[204:207], v[48:51], v[44:47], v[204:207]
  ds_read2_b32 v[140:141], v215 offset0:208 offset1:209
  ds_read_b128 v[148:151], v221 offset:1024
  v_mfma_f32_16x16x32_bf16 v[204:207], v[76:79], v[16:19], v[204:207]
  s_waitcnt vmcnt(14)
  ds_read2_b32 v[142:143], v215 offset0:210 offset1:211
  v_perm_b32 v10, v15, v210, s50
  v_mfma_f32_16x16x32_bf16 v[176:179], v[112:115], v[80:83], v[176:179]
  v_perm_b32 v11, v15, v210, s52
  v_perm_b32 v13, v15, v211, s50
  v_mfma_f32_16x16x32_bf16 v[180:183], v[112:115], v[84:87], v[180:183]
  s_add_u32 m0, s38, 43104
  s_add_u32 s49, s42, 663552
  s_mov_b32 exec_hi, 0xffffff
  buffer_load_dwordx4 v226, s[64:67], s49 offen offset:0 lds
  buffer_load_dwordx4 v227, s[64:67], s49 offen offset:896 lds
  s_mov_b32 exec_hi, -1
  v_mfma_f32_16x16x32_bf16 v[180:183], v[116:119], v[80:83], v[180:183]
  s_waitcnt lgkmcnt(1)
  v_perm_b32 v14, v15, v211, s52
  v_dot2_f32_bf16 v148, v10, v148, 0
  v_mfma_f32_16x16x32_bf16 v[184:187], v[116:119], v[84:87], v[184:187]
  v_dot2_f32_bf16 v149, v11, v149, 0
  v_dot2_f32_bf16 v150, v13, v150, 0
  v_mfma_f32_16x16x32_bf16 v[184:187], v[112:115], v[88:91], v[184:187]
  ds_read_b128 v[16:19], v216 offset:3968
  v_dot2_f32_bf16 v151, v14, v151, 0
  v_mfma_f32_16x16x32_bf16 v[184:187], v[120:123], v[80:83], v[184:187]
  ds_read_b128 v[152:155], v221 offset:2048
  v_mfma_f32_16x16x32_bf16 v[188:191], v[116:119], v[88:91], v[188:191]
  s_waitcnt vmcnt(15)
  ds_read2_b32 v[48:49], v212 offset0:96 offset1:97
  v_perm_b32 v6, v15, v224, s50
  v_mfma_f32_16x16x32_bf16 v[188:191], v[120:123], v[84:87], v[188:191]
  ds_read2_b32 v[50:51], v212 offset0:98 offset1:99
  v_perm_b32 v7, v15, v224, s52
  v_mfma_f32_16x16x32_bf16 v[192:195], v[120:123], v[88:91], v[192:195]
  v_perm_b32 v8, v15, v225, s50
  v_perm_b32 v9, v15, v225, s52
  v_mfma_f32_16x16x32_bf16 v[188:191], v[112:115], v[92:95], v[188:191]
  s_waitcnt lgkmcnt(2)
  ds_read_b128 v[20:23], v216 offset:3456
  v_dot2_f32_bf16 v152, v6, v152, 0
  v_mfma_f32_16x16x32_bf16 v[188:191], v[124:127], v[80:83], v[188:191]
  ds_read2_b32 v[52:53], v212 offset0:224 offset1:225
  v_dot2_f32_bf16 v153, v7, v153, 0
  v_mfma_f32_16x16x32_bf16 v[192:195], v[116:119], v[92:95], v[192:195]
  s_add_u32 m0, s38, 43104
  s_mov_b32 exec_hi, 0xffffff
  buffer_load_dwordx4 v228, s[64:67], s49 offen offset:1792 lds
  buffer_load_dwordx4 v229, s[64:67], s49 offen offset:2688 lds
  s_mov_b32 exec_hi, -1
  v_mfma_f32_16x16x32_bf16 v[192:195], v[124:127], v[84:87], v[192:195]
  ds_read2_b32 v[54:55], v212 offset0:226 offset1:227
  v_dot2_f32_bf16 v154, v8, v154, 0
  v_mfma_f32_16x16x32_bf16 v[196:199], v[120:123], v[92:95], v[196:199]
  ds_read_b128 v[24:27], v216 offset:2944
  v_dot2_f32_bf16 v155, v9, v155, 0
  v_mfma_f32_16x16x32_bf16 v[196:199], v[124:127], v[88:91], v[196:199]
  s_waitcnt vmcnt(14)
  ds_read_b128 v[156:159], v221 offset:3072
  v_perm_b32 v10, v15, v234, s50
  v_mfma_f32_16x16x32_bf16 v[200:203], v[124:127], v[92:95], v[200:203]
  ds_read2_b32 v[56:57], v213 offset0:96 offset1:97
  v_perm_b32 v11, v15, v234, s52
  v_mfma_f32_16x16x32_bf16 v[192:195], v[112:115], v[96:99], v[192:195]
  ds_read2_b32 v[58:59], v213 offset0:98 offset1:99
  v_perm_b32 v13, v15, v235, s50
  v_mfma_f32_16x16x32_bf16 v[192:195], v[128:131], v[80:83], v[192:195]
  s_waitcnt lgkmcnt(2)
  v_perm_b32 v14, v15, v235, s52
  v_dot2_f32_bf16 v156, v10, v156, 0
  v_mfma_f32_16x16x32_bf16 v[196:199], v[116:119], v[96:99], v[196:199]
  ds_read_b128 v[28:31], v216 offset:2432
  v_dot2_f32_bf16 v157, v11, v157, 0
  v_mfma_f32_16x16x32_bf16 v[196:199], v[128:131], v[84:87], v[196:199]
  ds_read2_b32 v[60:61], v213 offset0:224 offset1:225
  v_dot2_f32_bf16 v158, v13, v158, 0
  v_mfma_f32_16x16x32_bf16 v[200:203], v[120:123], v[96:99], v[200:203]
  v_dot2_f32_bf16 v159, v14, v159, 0
  v_mfma_f32_16x16x32_bf16 v[200:203], v[128:131], v[88:91], v[200:203]
  ds_read2_b32 v[62:63], v213 offset0:226 offset1:227
  s_add_u32 m0, s38, 57472
  s_add_u32 s49, s42, 774144
  s_mov_b32 exec_hi, 0xffffff
  buffer_load_dwordx4 v226, s[64:67], s49 offen offset:0 lds
  buffer_load_dwordx4 v227, s[64:67], s49 offen offset:896 lds
  s_mov_b32 exec_hi, -1
  v_mfma_f32_16x16x32_bf16 v[204:207], v[124:127], v[96:99], v[204:207]
  ds_read_b128 v[32:35], v216 offset:1920
  ds_read_b128 v[160:163], v221 offset:4096
  v_mfma_f32_16x16x32_bf16 v[204:207], v[128:131], v[92:95], v[204:207]
  s_cmp_lg_u32 s3, 0
  s_cbranch_scc1 GD_l
  buffer_load_dwordx2 v[244:245], v223, s[60:63], s58 offen offset:0 sc1
GD_l:
  v_mfma_f32_16x16x32_bf16 v[196:199], v[112:115], v[100:103], v[196:199]
  s_waitcnt vmcnt(15)
  ds_read2_b32 v[64:65], v214 offset0:96 offset1:97
  v_perm_b32 v6, v15, v240, s50
  v_mfma_f32_16x16x32_bf16 v[196:199], v[132:135], v[80:83], v[196:199]
  ds_read2_b32 v[66:67], v214 offset0:98 offset1:99
  v_perm_b32 v7, v15, v240, s52
  v_mfma_f32_16x16x32_bf16 v[200:203], v[116:119], v[100:103], v[200:203]
  v_perm_b32 v8, v15, v241, s50
  v_perm_b32 v9, v15, v241, s52
  v_mfma_f32_16x16x32_bf16 v[200:203], v[132:135], v[84:87], v[200:203]
  s_waitcnt lgkmcnt(2)
  ds_read_b128 v[36:39], v216 offset:1408
  v_dot2_f32_bf16 v160, v6, v160, 0
  v_mfma_f32_16x16x32_bf16 v[204:207], v[120:123], v[100:103], v[204:207]
  ds_read2_b32 v[68:69], v214 offset0:224 offset1:225
  v_dot2_f32_bf16 v161, v7, v161, 0
  v_mfma_f32_16x16x32_bf16 v[204:207], v[132:135], v[88:91], v[204:207]
  ds_read2_b32 v[70:71], v214 offset0:226 offset1:227
  v_dot2_f32_bf16 v162, v8, v162, 0
  v_mfma_f32_16x16x32_bf16 v[200:203], v[112:115], v[104:107], v[200:203]
  ds_read_b128 v[40:43], v216 offset:896
  v_dot2_f32_bf16 v163, v9, v163, 0
  v_mfma_f32_16x16x32_bf16 v[200:203], v[136:139], v[80:83], v[200:203]
  ds_read2_b32 v[72:73], v215 offset0:96 offset1:97
  s_add_u32 m0, s38, 57472
  s_mov_b32 exec_hi, 0xffffff
  buffer_load_dwordx4 v228, s[64:67], s49 offen offset:1792 lds
  buffer_load_dwordx4 v229, s[64:67], s49 offen offset:2688 lds
  s_mov_b32 exec_hi, -1
  v_mfma_f32_16x16x32_bf16 v[204:207], v[116:119], v[104:107], v[204:207]
  ds_read2_b32 v[74:75], v215 offset0:98 offset1:99
  ds_read_b128 v[164:167], v221 offset:5120
  v_mfma_f32_16x16x32_bf16 v[204:207], v[136:139], v[84:87], v[204:207]
  s_waitcnt vmcnt(14)
  ds_read_b128 v[44:47], v216 offset:384
  v_perm_b32 v10, v15, v242, s50
  v_mfma_f32_16x16x32_bf16 v[204:207], v[112:115], v[108:111], v[204:207]
  ds_read2_b32 v[76:77], v215 offset0:224 offset1:225
  v_perm_b32 v11, v15, v242, s52
  v_mfma_f32_16x16x32_bf16 v[204:207], v[140:143], v[80:83], v[204:207]
  ds_read2_b32 v[78:79], v215 offset0:226 offset1:227
  v_perm_b32 v13, v15, v243, s50
  v_mfma_f32_16x16x32_bf16 v[176:179], v[48:51], v[16:19], v[176:179]
  s_waitcnt lgkmcnt(3)
  v_perm_b32 v14, v15, v243, s52
  v_dot2_f32_bf16 v164, v10, v164, 0
  v_mfma_f32_16x16x32_bf16 v[180:183], v[48:51], v[20:23], v[180:183]
  v_dot2_f32_bf16 v165, v11, v165, 0
  v_dot2_f32_bf16 v166, v13, v166, 0
  v_mfma_f32_16x16x32_bf16 v[180:183], v[52:55], v[16:19], v[180:183]
  s_waitcnt vmcnt(11)
  v_dot2_f32_bf16 v167, v14, v167, 0
  v_perm_b32 v6, v15, v250, s50
  v_mfma_f32_16x16x32_bf16 v[184:187], v[52:55], v[20:23], v[184:187]
  ds_read_b128 v[168:171], v221 offset:6144
  v_perm_b32 v7, v15, v250, s52
  v_mfma_f32_16x16x32_bf16 v[184:187], v[48:51], v[24:27], v[184:187]
  ds_read_b128 v[80:83], v216 offset:4032
  v_perm_b32 v8, v15, v251, s50
  v_mfma_f32_16x16x32_bf16 v[184:187], v[56:59], v[16:19], v[184:187]
  s_add_u32 m0, s38, 71840
  s_add_u32 s49, s42, 1990656
  s_mov_b32 exec_hi, 0xffffff
  buffer_load_dwordx4 v226, s[64:67], s49 offen offset:0 lds
  buffer_load_dwordx4 v227, s[64:67], s49 offen offset:896 lds
  s_mov_b32 exec_hi, -1
  v_mfma_f32_16x16x32_bf16 v[188:191], v[52:55], v[24:27], v[188:191]
  ds_read2_b32 v[112:113], v212 offset0:112 offset1:113
  v_perm_b32 v9, v15, v251, s52
  v_mfma_f32_16x16x32_bf16 v[188:191], v[56:59], v[20:23], v[188:191]
  s_waitcnt lgkmcnt(2)
  ds_read2_b32 v[114:115], v212 offset0:114 offset1:115
  v_dot2_f32_bf16 v168, v6, v168, 0
  v_mfma_f32_16x16x32_bf16 v[192:195], v[56:59], v[24:27], v[192:195]
  v_dot2_f32_bf16 v169, v7, v169, 0
  v_dot2_f32_bf16 v170, v8, v170, 0
  v_mfma_f32_16x16x32_bf16 v[188:191], v[48:51], v[28:31], v[188:191]
  ds_read_b128 v[84:87], v216 offset:3520
  v_dot2_f32_bf16 v171, v9, v171, 0
  v_mfma_f32_16x16x32_bf16 v[188:191], v[60:63], v[16:19], v[188:191]
  ds_read2_b32 v[116:117], v212 offset0:240 offset1:241
  ds_read_b128 v[172:175], v221 offset:7168
  v_mfma_f32_16x16x32_bf16 v[192:195], v[52:55], v[28:31], v[192:195]
  s_lshr_b32 s4, s2, 2
  s_lshl_b32 s4, s4, 7
  s_and_b32 s5, s2, 3
  s_lshl_b32 s5, s5, 2
  s_add_u32 s4, s4, s5
  s_mul_i32 s5, s3, 8192
  s_add_u32 s4, s4, s5
  s_add_u32 s4, s4, 0x1830000
  v_min_u32 v2, 0, v1
  v_mul_u32_u24 v2, 8192, v2
  s_mov_b64 exec, 1
  buffer_store_dword v255, v2, s[60:63], s4 offen sc1
  s_mov_b64 exec, -1
  v_mfma_f32_16x16x32_bf16 v[192:195], v[60:63], v[20:23], v[192:195]
  s_waitcnt vmcnt(13)
  ds_read2_b32 v[118:119], v212 offset0:242 offset1:243
  v_perm_b32 v10, v15, v252, s50
  v_mfma_f32_16x16x32_bf16 v[196:199], v[56:59], v[28:31], v[196:199]
  ds_read_b128 v[88:91], v216 offset:3008
  v_perm_b32 v11, v15, v252, s52
  v_mfma_f32_16x16x32_bf16 v[196:199], v[60:63], v[24:27], v[196:199]
  v_perm_b32 v13, v15, v253, s50
  v_perm_b32 v14, v15, v253, s52
  v_mfma_f32_16x16x32_bf16 v[200:203], v[60:63], v[28:31], v[200:203]
  ds_read2_b32 v[120:121], v213 offset0:112 offset1:113
  s_add_u32 m0, s38, 71840
  s_mov_b32 exec_hi, 0xffffff
  buffer_load_dwordx4 v228, s[64:67], s49 offen offset:1792 lds
  buffer_load_dwordx4 v229, s[64:67], s49 offen offset:2688 lds
  s_mov_b32 exec_hi, -1
  v_mfma_f32_16x16x32_bf16 v[192:195], v[48:51], v[32:35], v[192:195]
  s_waitcnt lgkmcnt(3)
  ds_read2_b32 v[122:123], v213 offset0:114 offset1:115
  v_dot2_f32_bf16 v172, v10, v172, 0
  v_mfma_f32_16x16x32_bf16 v[192:195], v[64:67], v[16:19], v[192:195]
  v_dot2_f32_bf16 v173, v11, v173, 0
  v_dot2_f32_bf16 v174, v13, v174, 0
  v_mfma_f32_16x16x32_bf16 v[196:199], v[52:55], v[32:35], v[196:199]
  ds_read_b128 v[92:95], v216 offset:2496
  v_dot2_f32_bf16 v175, v14, v175, 0
  v_mfma_f32_16x16x32_bf16 v[196:199], v[64:67], v[20:23], v[196:199]
  ds_read2_b32 v[124:125], v213 offset0:240 offset1:241
  v_mfma_f32_16x16x32_bf16 v[200:203], v[56:59], v[32:35], v[200:203]
  v_mfma_f32_16x16x32_bf16 v[200:203], v[64:67], v[24:27], v[200:203]
  ds_read2_b32 v[126:127], v213 offset0:242 offset1:243
  v_mfma_f32_16x16x32_bf16 v[204:207], v[60:63], v[32:35], v[204:207]
  ds_read_b128 v[96:99], v216 offset:1984
  v_mfma_f32_16x16x32_bf16 v[204:207], v[64:67], v[28:31], v[204:207]
  v_mfma_f32_16x16x32_bf16 v[196:199], v[48:51], v[36:39], v[196:199]
  ds_read2_b32 v[128:129], v214 offset0:112 offset1:113
  v_mfma_f32_16x16x32_bf16 v[196:199], v[68:71], v[16:19], v[196:199]
  ds_read2_b32 v[130:131], v214 offset0:114 offset1:115
  s_add_u32 m0, s38, 86208
  s_add_u32 s49, s42, 2101248
  s_mov_b32 exec_hi, 0xffffff
  buffer_load_dwordx4 v226, s[64:67], s49 offen offset:0 lds
  buffer_load_dwordx4 v227, s[64:67], s49 offen offset:896 lds
  s_mov_b32 exec_hi, -1
  v_mfma_f32_16x16x32_bf16 v[200:203], v[52:55], v[36:39], v[200:203]
  v_mfma_f32_16x16x32_bf16 v[200:203], v[68:71], v[20:23], v[200:203]
  ds_read_b128 v[100:103], v216 offset:1472
  v_mfma_f32_16x16x32_bf16 v[204:207], v[56:59], v[36:39], v[204:207]
  ds_read2_b32 v[132:133], v214 offset0:240 offset1:241
  v_mfma_f32_16x16x32_bf16 v[204:207], v[68:71], v[24:27], v[204:207]
  ds_read2_b32 v[134:135], v214 offset0:242 offset1:243
  v_mfma_f32_16x16x32_bf16 v[200:203], v[48:51], v[40:43], v[200:203]
  ds_read_b128 v[104:107], v216 offset:960
  v_mfma_f32_16x16x32_bf16 v[200:203], v[72:75], v[16:19], v[200:203]
  ds_read2_b32 v[136:137], v215 offset0:112 offset1:113
  v_mfma_f32_16x16x32_bf16 v[204:207], v[52:55], v[40:43], v[204:207]
  ds_read2_b32 v[138:139], v215 offset0:114 offset1:115
  v_mfma_f32_16x16x32_bf16 v[204:207], v[72:75], v[20:23], v[204:207]
  ds_read_b128 v[108:111], v216 offset:448
  v_mfma_f32_16x16x32_bf16 v[204:207], v[48:51], v[44:47], v[204:207]
  ds_read2_b32 v[140:141], v215 offset0:240 offset1:241
  v_mfma_f32_16x16x32_bf16 v[204:207], v[76:79], v[16:19], v[204:207]
  ds_read2_b32 v[142:143], v215 offset0:242 offset1:243
  s_add_u32 m0, s38, 86208
  s_mov_b32 exec_hi, 0xffffff
  buffer_load_dwordx4 v228, s[64:67], s49 offen offset:1792 lds
  buffer_load_dwordx4 v229, s[64:67], s49 offen offset:2688 lds
  s_mov_b32 exec_hi, -1
  v_mfma_f32_16x16x32_bf16 v[180:183], v[112:115], v[84:87], v[180:183]
  v_mfma_f32_16x16x32_bf16 v[176:179], v[112:115], v[80:83], v[176:179]
  s_waitcnt lgkmcnt(15)
  v_mfma_f32_16x16x32_bf16 v[180:183], v[116:119], v[80:83], v[180:183]
  s_waitcnt lgkmcnt(14)
  v_lshlrev_b32 v16, 16, v208
  v_and_b32 v17, 0xffff0000, v208
  v_mfma_f32_16x16x32_bf16 v[188:191], v[112:115], v[92:95], v[188:191]
  v_lshlrev_b32 v18, 16, v209
  v_and_b32 v19, 0xffff0000, v209
  v_mfma_f32_16x16x32_bf16 v[184:187], v[112:115], v[88:91], v[184:187]
  v_lshlrev_b32 v20, 16, v210
  v_and_b32 v21, 0xffff0000, v210
  v_mfma_f32_16x16x32_bf16 v[188:191], v[116:119], v[88:91], v[188:191]
  v_lshlrev_b32 v22, 16, v211
  v_and_b32 v23, 0xffff0000, v211
  v_mfma_f32_16x16x32_bf16 v[184:187], v[116:119], v[84:87], v[184:187]
  v_lshlrev_b32 v24, 16, v224
  v_and_b32 v25, 0xffff0000, v224
  v_mfma_f32_16x16x32_bf16 v[188:191], v[120:123], v[84:87], v[188:191]
  v_lshlrev_b32 v26, 16, v225
  v_and_b32 v27, 0xffff0000, v225
  v_mfma_f32_16x16x32_bf16 v[184:187], v[120:123], v[80:83], v[184:187]
  s_waitcnt lgkmcnt(12)
  v_lshlrev_b32 v28, 16, v234
  v_and_b32 v29, 0xffff0000, v234
  v_mfma_f32_16x16x32_bf16 v[188:191], v[124:127], v[80:83], v[188:191]
  s_waitcnt lgkmcnt(8)
  v_lshlrev_b32 v30, 16, v235
  v_and_b32 v31, 0xffff0000, v235
  v_mfma_f32_16x16x32_bf16 v[196:199], v[112:115], v[100:103], v[196:199]
  v_lshlrev_b32 v32, 16, v240
  v_and_b32 v33, 0xffff0000, v240
  v_mfma_f32_16x16x32_bf16 v[192:195], v[112:115], v[96:99], v[192:195]
  v_lshlrev_b32 v34, 16, v241
  v_and_b32 v35, 0xffff0000, v241
  v_mfma_f32_16x16x32_bf16 v[196:199], v[116:119], v[96:99], v[196:199]
  v_lshlrev_b32 v36, 16, v242
  v_and_b32 v37, 0xffff0000, v242
  v_mfma_f32_16x16x32_bf16 v[192:195], v[116:119], v[92:95], v[192:195]
  v_lshlrev_b32 v38, 16, v243
  v_and_b32 v39, 0xffff0000, v243
  v_mfma_f32_16x16x32_bf16 v[196:199], v[120:123], v[92:95], v[196:199]
  v_lshlrev_b32 v40, 16, v250
  v_and_b32 v41, 0xffff0000, v250
  v_mfma_f32_16x16x32_bf16 v[192:195], v[120:123], v[88:91], v[192:195]
  v_lshlrev_b32 v42, 16, v251
  v_and_b32 v43, 0xffff0000, v251
  v_mfma_f32_16x16x32_bf16 v[196:199], v[124:127], v[88:91], v[196:199]
  v_lshlrev_b32 v44, 16, v252
  v_and_b32 v45, 0xffff0000, v252
  v_mfma_f32_16x16x32_bf16 v[192:195], v[124:127], v[84:87], v[192:195]
  v_lshlrev_b32 v46, 16, v253
  v_and_b32 v47, 0xffff0000, v253
  v_mfma_f32_16x16x32_bf16 v[196:199], v[128:131], v[84:87], v[196:199]
  v_fmac_f32 v16, v144, v176
  v_fmac_f32 v17, v145, v177
  v_mfma_f32_16x16x32_bf16 v[192:195], v[128:131], v[80:83], v[192:195]
  s_waitcnt lgkmcnt(6)
  v_fmac_f32 v18, v146, v178
  v_fmac_f32 v19, v147, v179
  v_mfma_f32_16x16x32_bf16 v[196:199], v[132:135], v[80:83], v[196:199]
  s_waitcnt lgkmcnt(2)
  v_fmac_f32 v20, v148, v180
  v_fmac_f32 v21, v149, v181
  v_mfma_f32_16x16x32_bf16 v[204:207], v[112:115], v[108:111], v[204:207]
  v_fmac_f32 v22, v150, v182
  v_fmac_f32 v23, v151, v183
  v_mfma_f32_16x16x32_bf16 v[200:203], v[112:115], v[104:107], v[200:203]
  v_cvt_pk_bf16_f32 v144, v16, v17
  v_cvt_pk_bf16_f32 v145, v18, v19
  v_mfma_f32_16x16x32_bf16 v[204:207], v[116:119], v[104:107], v[204:207]
  v_cvt_pk_bf16_f32 v146, v20, v21
  v_cvt_pk_bf16_f32 v147, v22, v23
  v_mfma_f32_16x16x32_bf16 v[200:203], v[116:119], v[100:103], v[200:203]
  v_permlane16_swap_b32 v144, v146
  v_mfma_f32_16x16x32_bf16 v[204:207], v[120:123], v[100:103], v[204:207]
  v_permlane16_swap_b32 v145, v147
  v_mfma_f32_16x16x32_bf16 v[200:203], v[120:123], v[96:99], v[200:203]
  buffer_store_dwordx4 v[144:147], v218, s[60:63], s13 offen offset:0 sc1
  v_fmac_f32 v24, v152, v184
  v_mfma_f32_16x16x32_bf16 v[204:207], v[124:127], v[96:99], v[204:207]
  v_fmac_f32 v25, v153, v185
  v_fmac_f32 v26, v154, v186
  v_mfma_f32_16x16x32_bf16 v[200:203], v[124:127], v[92:95], v[200:203]
  v_fmac_f32 v27, v155, v187
  v_fmac_f32 v28, v156, v188
  v_mfma_f32_16x16x32_bf16 v[204:207], v[128:131], v[92:95], v[204:207]
  v_fmac_f32 v29, v157, v189
  v_fmac_f32 v30, v158, v190
  v_mfma_f32_16x16x32_bf16 v[200:203], v[128:131], v[88:91], v[200:203]
  v_fmac_f32 v31, v159, v191
  v_cvt_pk_bf16_f32 v152, v24, v25
  v_mfma_f32_16x16x32_bf16 v[204:207], v[132:135], v[88:91], v[204:207]
  v_cvt_pk_bf16_f32 v153, v26, v27
  v_cvt_pk_bf16_f32 v154, v28, v29
  v_mfma_f32_16x16x32_bf16 v[200:203], v[132:135], v[84:87], v[200:203]
  v_cvt_pk_bf16_f32 v155, v30, v31
  v_fmac_f32 v32, v160, v192
  v_mfma_f32_16x16x32_bf16 v[204:207], v[136:139], v[84:87], v[204:207]
  v_permlane16_swap_b32 v152, v154
  v_mfma_f32_16x16x32_bf16 v[200:203], v[136:139], v[80:83], v[200:203]
  s_waitcnt lgkmcnt(0)
  v_permlane16_swap_b32 v153, v155
  v_mfma_f32_16x16x32_bf16 v[204:207], v[140:143], v[80:83], v[204:207]
  buffer_store_dwordx4 v[152:155], v218, s[60:63], s13 offen offset:1024 sc1
  v_fmac_f32 v33, v161, v193
  v_fmac_f32 v34, v162, v194
  v_fmac_f32 v35, v163, v195
  v_fmac_f32 v36, v164, v196
  v_fmac_f32 v37, v165, v197
  v_fmac_f32 v38, v166, v198
  v_fmac_f32 v39, v167, v199
  v_cvt_pk_bf16_f32 v160, v32, v33
  v_cvt_pk_bf16_f32 v161, v34, v35
  v_cvt_pk_bf16_f32 v162, v36, v37
  v_cvt_pk_bf16_f32 v163, v38, v39
  s_nop 0
  v_permlane16_swap_b32 v160, v162
  v_permlane16_swap_b32 v161, v163
  buffer_store_dwordx4 v[160:163], v218, s[60:63], s13 offen offset:2048 sc1
  v_fmac_f32 v40, v168, v200
  v_fmac_f32 v41, v169, v201
  v_fmac_f32 v42, v170, v202
  v_fmac_f32 v43, v171, v203
  v_fmac_f32 v44, v172, v204
  v_fmac_f32 v45, v173, v205
  v_fmac_f32 v46, v174, v206
  v_fmac_f32 v47, v175, v207
  v_cvt_pk_bf16_f32 v168, v40, v41
  v_cvt_pk_bf16_f32 v169, v42, v43
  v_cvt_pk_bf16_f32 v170, v44, v45
  v_cvt_pk_bf16_f32 v171, v46, v47
  s_nop 0
  v_permlane16_swap_b32 v168, v170
  v_permlane16_swap_b32 v169, v171
  buffer_store_dwordx4 v[168:171], v218, s[60:63], s13 offen offset:3072 sc1
  s_cmp_lg_u32 s3, 0
  s_cbranch_scc1 GD_c
  s_waitcnt vmcnt(15)
  v_cmp_ne_u64 vcc, s[100:101], v[244:245]
  s_cbranch_vccz GD_ok
  s_mov_b32 s11, 20000
  buffer_load_dwordx2 v[244:245], v223, s[60:63], s58 offen offset:0 sc1
GD_spin:
  s_waitcnt vmcnt(0)
  v_cmp_ne_u64 vcc, s[100:101], v[244:245]
  s_cbranch_vccz GD_done
  buffer_load_dwordx2 v[244:245], v223, s[60:63], s58 offen offset:0 sc1
  s_sub_u32 s11, s11, 1
  s_cbranch_scc0 GD_spin
  s_waitcnt vmcnt(0)
GD_done:
GD_ok:
GD_c:
  s_mov_b32 s56, s36
  s_and_b32 s57, s37, 0xffff
  s_mov_b32 s58, 0x280000
  s_mov_b32 s59, 0x20000
  s_mul_i32 s4, s17, 896
  s_add_u32 s4, s4, 0x790000
  s_lshl_b32 s32, s18, 6
  s_add_u32 s32, s32, s4
  s_lshl_b32 s33, s31, 6
  s_add_u32 s33, s33, s4
  s_lshl_b32 s19, s3, 15
  s_lshl_b32 s4, s16, 8
  s_add_u32 s19, s19, s4
  s_add_u32 s19, s19, 0x500000
  s_lshl_b32 s20, s3, 11
  s_mov_b32 s36, s19
  s_lshl_b32 s40, s16, 9
  s_add_u32 s40, s40, 0x1818000
  s_lshr_b32 s5, s17, 2
  s_lshl_b32 s5, s5, 7
  s_add_u32 s41, s40, s5
  s_and_b32 s5, s17, 3
  s_lshl_b32 s5, s5, 2
  s_add_u32 s41, s41, s5
  s_and_b32 s5, s17, 3
  s_lshl_b32 s5, s5, 2
  s_add_u32 s5, s5, s3
  s_lshl_b32 s5, s5, 17
  s_add_u32 s5, s5, s4
  s_add_u32 s37, s5, 0x580000
  v_bfe_u32 v2, v1, 4, 2
  v_lshl_add_u32 v2, v2, 2, v5
  v_add_u32 v253, s20, v2
  v_lshrrev_b32 v2, 1, v1
  v_and_b32 v3, 1, v1
  v_lshlrev_b32 v3, 7, v3
  v_lshl_add_u32 v132, v2, 12, v3
  s_lshl_b32 s4, s16, 3
  s_lshl_b32 s5, s3, 1
  s_add_u32 s5, s5, s4
  s_mul_i32 s39, s5, 57344
  s_mul_i32 s5, s17, 3584
  s_add_u32 s39, s39, s5
  s_add_u32 s39, s39, 0x1000000
  s_bfe_u32 s13, s17, 65538
  s_lshr_b32 s14, s17, 3
  s_lshl_b32 s14, s14, 2
  s_and_b32 s4, s17, 3
  s_add_u32 s14, s14, s4
  s_and_b32 s4, s3, 1
  s_lshl_b32 s28, s4, 1
  s_lshr_b32 s5, s3, 1
  s_or_b32 s28, s28, s5
  s_lshl_b32 s15, s5, 2
  s_add_u32 s15, s15, s4
  s_lshl_b32 s4, s13, 1
  s_add_u32 s15, s15, s4
  s_mul_i32 s4, s14, 286720
  s_mul_i32 s5, s3, 14336
  s_add_u32 s4, s4, s5
  s_add_u32 s44, s4, 0xd00000
  s_add_u32 s45, s4, 0xd0e000
  s_add_u32 s46, s4, 0xd1c000
  s_add_u32 s47, s4, 0xd2a000
  s_add_u32 s48, s4, 0xd38000
  s_lshl_b32 s4, s16, 3
  s_lshl_b32 s6, s13, 1
  s_add_u32 s6, s6, s4
  s_mul_i32 s6, s6, 57344
  s_add_u32 s6, s6, s5
  s_add_u32 s24, s6, 0x1000000
  s_add_u32 s25, s6, 0x100e000
  s_add_u32 s26, s6, 0x1038000
  s_add_u32 s27, s6, 0x1046000
  s_and_b32 s5, s28, 2
  s_mul_i32 s6, s17, 3584
  s_add_u32 s6, s6, 0x1000000
  s_add_u32 s8, s4, s5
  s_mul_i32 s8, s8, 57344
  s_add_u32 s8, s8, s6
  s_xor_b32 s5, s5, 2
  s_add_u32 s9, s4, s5
  s_mul_i32 s9, s9, 57344
  s_add_u32 s9, s9, s6
  s_add_u32 s5, s4, s15
  s_mul_i32 s22, s5, 20480
  s_mul_i32 s6, s14, 160
  s_add_u32 s22, s22, s6
  s_lshl_b32 s29, s5, 9
  s_add_u32 s29, s29, 0x780000
  s_add_u32 s5, s4, s14
  s_lshl_b32 s30, s5, 9
  s_lshl_b32 s5, s13, 2
  s_add_u32 s5, s5, s3
  s_lshl_b32 s5, s5, 2
  s_add_u32 s30, s30, s5
  s_add_u32 s30, s30, 0x780000
  s_mov_b32 s21, 0
  s_lshl_b32 s23, s17, 7
  s_add_u32 s23, s23, 0x1814000
  s_mov_b32 s10, s44
  s_mul_i32 s7, s3, 15360
  s_add_u32 s7, s7, 2048
  v_add_u32 v128, 0x3820, v230
  v_add_u32 v129, 0x3820, v231
  v_add_u32 v130, 0x3820, v232
  v_add_u32 v131, 0x3820, v233
  s_add_u32 s12, s21, 1024
  s_cmp_ge_u32 s3, 2
  s_cselect_b32 s35, 0xffff0000, 0
  s_mov_b32 s34, 0
  v_lshrrev_b32 v208, 4, v1
  v_bfe_u32 v209, v1, 2, 2
  v_and_b32 v210, 15, v1
  s_and_b32 s5, s3, 1
  s_lshl_b32 s5, s5, 2
  v_or_b32 v2, s5, v208
  v_bfe_u32 v3, v1, 1, 3
  v_xor_b32 v2, v2, v3
  v_lshlrev_b32 v2, 5, v2
  v_and_b32 v3, 1, v1
  v_lshl_add_u32 v2, v3, 4, v2
  v_lshl_add_u32 v6, v208, 12, v2
  v_add_u32 v13, 15360, v6
  v_and_b32 v2, 1, v208
  v_lshl_or_b32 v2, v2, 2, v209
  v_lshl_add_u32 v3, v208, 3, v209
  v_lshlrev_b32 v3, 8, v3
  v_and_b32 v4, 3, v1
  v_lshl_add_u32 v3, v4, 3, v3
  v_xor_b32 v211, s14, v2
  v_lshl_add_u32 v250, v211, 5, v3
  s_lshl_b32 s4, s3, 14
  s_add_u32 s4, s4, 90112
  s_mul_i32 s5, s3, 24576
  s_cmp_eq_u32 s13, 0
  s_cselect_b32 s4, s5, s4
  v_add_u32 v250, s4, v250
  v_xor_b32 v2, s28, v2
  v_xor_b32 v240, 0, v2
  v_lshl_add_u32 v240, v240, 5, v3
  v_xor_b32 v241, 1, v2
  v_lshl_add_u32 v241, v241, 5, v3
  v_xor_b32 v242, 2, v2
  v_lshl_add_u32 v242, v242, 5, v3
  v_xor_b32 v243, 3, v2
  v_lshl_add_u32 v243, v243, 5, v3
  s_waitcnt vmcnt(15)
  v_xor_b32 v244, 4, v2
  v_lshl_add_u32 v244, v244, 5, v3
  v_xor_b32 v245, 5, v2
  v_lshl_add_u32 v245, v245, 5, v3
  v_xor_b32 v246, 6, v2
  v_lshl_add_u32 v246, v246, 5, v3
  v_xor_b32 v247, 7, v2
  v_lshl_add_u32 v247, v247, 5, v3
  v_cmp_eq_u32 s[50:51], 1, v4
  v_cmp_eq_u32 s[52:53], 2, v4
  v_cmp_eq_u32 s[54:55], 3, v4
  v_lshlrev_b32 v2, 5, v210
  v_cmp_eq_u32 vcc, v209, v208
  v_mov_b32 v3, 0x7f000000
  s_nop 0
  v_cndmask_b32 v251, v3, v2, vcc
  v_lshrrev_b32 v2, 1, v208
  v_lshl_or_b32 v2, v2, 2, v209
  v_xor_b32 v2, s15, v2
  v_lshlrev_b32 v2, 5, v2
  v_lshl_add_u32 v2, v4, 3, v2
  v_lshl_add_u32 v3, v208, 2, v209
  v_lshl_add_u32 v2, v3, 8, v2
  s_mul_i32 s6, s14, 20480
  v_add_u32 v11, s6, v2
  s_lshl_b32 s4, s28, 2
  s_add_u32 s4, s4, s21
  v_lshl_add_u32 v10, v210, 5, s4
  s_and_b32 s4, s28, 1
  v_and_b32 v2, 1, v208
  v_lshrrev_b32 v4, 1, v208
  v_xor_b32 v211, s4, v2
  v_mul_u32_u24 v211, 57344, v211
  v_lshl_add_u32 v211, v210, 4, v211
  v_add_u32 v3, s18, v4
  v_lshl_add_u32 v7, v3, 8, v211
  s_add_u32 s5, s18, 2
  s_sub_u32 s6, s31, s5
  v_mul_lo_u32 v3, s6, v4
  v_add_u32 v3, s5, v3
  v_lshl_add_u32 v8, v3, 8, v211
  v_xor_b32 v211, s4, v4
  v_mul_u32_u24 v211, 57344, v211
  v_lshl_add_u32 v211, v210, 4, v211
  v_lshl_add_u32 v211, v2, 3, v211
  s_lshl_b32 s5, s5, 8
  v_add_u32 v9, s5, v211
  v_mul_u32_u24 v3, 1280, v210
  v_lshl_add_u32 v3, v2, 5, v3
  v_lshl_add_u32 v248, v4, 4, v3
  v_and_b32 v3, 3, v1
  v_lshlrev_b32 v249, 2, v3
  s_barrier
  s_lshr_b32 s6, s2, 3
  s_lshl_b32 s6, s6, 2
  s_add_u32 s6, s6, s3
  s_mul_i32 s68, s6, 8960
  s_bfe_u32 s5, s2, 65537
  s_mul_i32 s5, s5, 1146880
  s_add_u32 s68, s68, s5
  s_add_u32 s68, s68, 0xd0007c
  v_min_u32 v134, 34, v1
  v_lshlrev_b32 v134, 8, v134
  buffer_load_dwordx2 v[136:137], v134, s[60:63], s68 offen
  s_branch K_gemm
K_helper:
  s_sub_u32 s7, s2, 160
  s_cmp_ge_u32 s7, 64
  s_cbranch_scc1 H_nx1
  s_waitcnt lgkmcnt(0)
  s_mov_b32 s44, s16
  s_and_b32 s45, s17, 0xffff
  s_mov_b32 s46, 0x280000
  s_mov_b32 s47, 0x20000
  s_lshl_b32 s4, s7, 2
  s_add_u32 s4, s4, s3
  s_mul_i32 s4, s4, 10240
  s_add_u32 s5, s4, 2560
  v_lshrrev_b32 v2, 5, v1
  v_mul_u32_u24 v16, 5120, v2
  v_and_b32 v3, 31, v1
  v_lshl_add_u32 v16, v3, 3, v16
  s_mov_b32 s48, s4
  s_mov_b32 s50, s5
  buffer_load_dwordx2 v[48:49], v16, s[44:47], s48 offen offset:0 nt
  buffer_load_dwordx2 v[50:51], v16, s[44:47], s48 offen offset:256 nt
  buffer_load_dwordx2 v[52:53], v16, s[44:47], s48 offen offset:512 nt
  buffer_load_dwordx2 v[54:55], v16, s[44:47], s48 offen offset:768 nt
  buffer_load_dwordx2 v[56:57], v16, s[44:47], s48 offen offset:1024 nt
  buffer_load_dwordx2 v[58:59], v16, s[44:47], s48 offen offset:1280 nt
  buffer_load_dwordx2 v[60:61], v16, s[44:47], s48 offen offset:1536 nt
  buffer_load_dwordx2 v[62:63], v16, s[44:47], s48 offen offset:1792 nt
  buffer_load_dwordx2 v[64:65], v16, s[44:47], s48 offen offset:2048 nt
  buffer_load_dwordx2 v[66:67], v16, s[44:47], s48 offen offset:2304 nt
  buffer_load_dwordx2 v[68:69], v16, s[44:47], s50 offen offset:0 nt
  buffer_load_dwordx2 v[70:71], v16, s[44:47], s50 offen offset:256 nt
  buffer_load_dwordx2 v[72:73], v16, s[44:47], s50 offen offset:512 nt
  buffer_load_dwordx2 v[74:75], v16, s[44:47], s50 offen offset:768 nt
  buffer_load_dwordx2 v[76:77], v16, s[44:47], s50 offen offset:1024 nt
  buffer_load_dwordx2 v[78:79], v16, s[44:47], s50 offen offset:1280 nt
  buffer_load_dwordx2 v[80:81], v16, s[44:47], s50 offen offset:1536 nt
  buffer_load_dwordx2 v[82:83], v16, s[44:47], s50 offen offset:1792 nt
  buffer_load_dwordx2 v[84:85], v16, s[44:47], s50 offen offset:2048 nt
  buffer_load_dwordx2 v[86:87], v16, s[44:47], s50 offen offset:2304 nt
  s_cmp_ge_u32 s3, 2
  s_cselect_b32 s64, s32, s30
  s_cselect_b32 s65, s33, s31
  s_and_b32 s65, s65, 0xffff
  s_mov_b32 s66, 0x21c000
  s_mov_b32 s67, 0x20000
  s_and_b32 s4, s2, 3
  s_mul_i32 s4, s4, 27
  s_lshr_b32 s4, s4, 2
  v_and_b32 v2, 7, v1
  v_add_u32 v2, s4, v2
  v_min_u32 v2, 26, v2
  v_lshrrev_b32 v3, 3, v1
  v_mul_u32_u24 v3, 3456, v3
  v_lshl_add_u32 v91, v2, 7, v3
  s_bfe_u32 s15, s7, 196611
  s_lshl_b32 s15, s15, 1
  s_and_b32 s4, s3, 1
  s_add_u32 s15, s15, s4
  s_mul_i32 s15, s15, 27648
  s_mov_b32 s60, s40
  s_and_b32 s61, s41, 0xffff
  s_mov_b32 s62, 0x1e00000
  s_mov_b32 s63, 0x20000
  s_mov_b32 s43, 0x1820000
  s_load_dword s43, s[40:41], s43
  s_mov_b32 s52, s34
  s_and_b32 s53, s35, 0xffff
  s_mov_b32 s54, 0x21c000
  s_mov_b32 s55, 0x20000
  s_bfe_u32 s16, s2, 65538
  s_lshl_b32 s16, s16, 3
  s_lshr_b32 s5, s2, 5
  s_add_u32 s16, s16, s5
  s_and_b32 s17, s2, 3
  s_lshl_b32 s17, s17, 2
  s_bfe_u32 s5, s2, 131075
  s_add_u32 s17, s17, s5
  s_mul_i32 s18, s3, 13
  s_add_u32 s18, s18, 3
  s_lshr_b32 s18, s18, 2
  s_lshr_b32 s31, s3, 1
  s_mul_i32 s31, s31, 10
  s_add_u32 s31, s31, 3
  s_and_b32 s6, s17, 1
  s_lshl_b32 s6, s6, 3
  s_mul_i32 s42, s17, 216
  s_sub_u32 s42, s42, s6
  s_lshr_b32 s4, s3, 1
  s_mul_i32 s38, s4, 7184
  s_and_b32 s4, s3, 1
  s_mul_i32 s5, s4, 3584
  s_add_u32 s38, s38, s5
  s_add_u32 s38, s38, 53248
  s_mul_i32 s4, s4, 55296
  v_mul_u32_u24 v2, 37, v1
  v_lshrrev_b32 v2, 9, v2
  v_mul_u32_u24 v2, 3232, v2
  v_add3_u32 v226, v2, v5, s4
  v_add_u32 v227, 26752, v226
  v_add_u32 v228, 12032, v226
  v_add_u32 v229, 38784, v226
  v_lshrrev_b32 v2, 5, v1
  v_bfe_u32 v3, v1, 2, 3
  v_lshl_add_u32 v2, v2, 4, v3
  v_mul_u32_u24 v2, 224, v2
  s_add_u32 s6, s6, 53248
  v_add_u32 v2, s6, v2
  s_lshl_b32 s4, s18, 4
  v_and_b32 v3, 3, v1
  v_lshl_add_u32 v3, v3, 3, v2
  v_add_u32 v230, s4, v3
  v_and_b32 v3, 1, v1
  v_lshl_add_u32 v2, v3, 3, v2
  v_bfe_u32 v4, v1, 1, 1
  v_mul_u32_u24 v233, 7184, v4
  v_add_u32 v2, v2, v233
  s_add_u32 s4, s4, 32
  v_add_u32 v231, s4, v2
  s_lshl_b32 s4, s31, 4
  v_add_u32 v232, s4, v2
  v_add_u32 v233, 1792, v232
  v_lshlrev_b32 v4, 3, v4
  v_add_u32 v4, 60416, v4
  s_lshr_b32 s4, s3, 1
  v_and_b32 v3, s4, v3
  v_cmp_ne_u32 vcc, 0, v3
  s_nop 1
  v_cndmask_b32 v232, v232, v4, vcc
  v_cndmask_b32 v233, v233, v4, vcc
  s_waitcnt lgkmcnt(0)
  s_mul_i32 s100, s43, 0x9e3779b1
  s_add_u32 s100, s100, 0x7f4a7c15
  s_mov_b32 s101, s100
  v_mov_b32 v255, s100
  s_sub_u32 s9, s7, 16
  s_lshr_b32 s4, s7, 3
  s_lshl_b32 s4, s4, 2
  s_and_b32 s5, s7, 3
  s_add_u32 s4, s4, s5
  s_cmp_lt_u32 s7, 32
  s_cselect_b32 s9, s4, s9
  s_mul_i32 s14, s9, 205
  s_lshr_b32 s14, s14, 11
  s_mul_i32 s4, s14, 10
  s_sub_u32 s13, s9, s4
  s_lshl_b32 s4, s16, 3
  s_lshr_b32 s5, s17, 3
  s_lshl_b32 s5, s5, 2
  s_add_u32 s4, s4, s5
  s_and_b32 s5, s17, 3
  s_add_u32 s4, s4, s5
  s_lshl_b32 s28, s4, 9
  s_and_b32 s5, s17, 4
  s_add_u32 s5, s5, s3
  s_lshl_b32 s5, s5, 2
  s_add_u32 s28, s28, s5
  s_add_u32 s28, s28, 0x780000
  v_lshrrev_b32 v2, 4, v1
  v_bfe_u32 v3, v1, 2, 2
  v_cmp_eq_u32 vcc, v2, v3
  v_and_b32 v2, 15, v1
  v_lshlrev_b32 v2, 5, v2
  v_mov_b32 v3, 0x7f000000
  v_cndmask_b32 v247, v3, v2, vcc
  v_mov_b32 v93, -1
  buffer_store_dword v93, v247, s[60:63], s28 offen sc1
  s_mov_b32 s50, 0x05040100
  s_mov_b32 s51, 0x07060302
  v_lshrrev_b32 v2, 5, v1
  v_and_b32 v4, 3, v1
  v_xor_b32 v3, s3, v4
  v_lshlrev_b32 v3, 4, v3
  v_lshl_add_u32 v3, v2, 3, v3
  v_and_b32 v17, 31, v1
  v_lshl_add_u32 v17, v17, 8, v3
  v_lshrrev_b32 v3, 2, v1
  v_lshlrev_b32 v19, 12, v3
  v_lshl_add_u32 v19, v4, 4, v19
  v_lshrrev_b32 v2, 4, v1
  v_xor_b32 v2, v2, v4
  v_lshlrev_b32 v3, 6, v3
  v_lshl_add_u32 v20, v2, 4, v3
  v_add_u32 v20, 28672, v20
  s_waitcnt vmcnt(15)
  v_perm_b32 v96, v58, v48, s50
  s_waitcnt vmcnt(5)
  v_perm_b32 v97, v78, v68, s50
  v_perm_b32 v98, v58, v48, s51
  v_perm_b32 v99, v78, v68, s51
  v_perm_b32 v100, v59, v49, s50
  v_perm_b32 v101, v79, v69, s50
  v_perm_b32 v102, v59, v49, s51
  v_perm_b32 v103, v79, v69, s51
  ds_write_b64 v17, v[96:97] offset:28672
  ds_write_b64 v17, v[98:99] offset:28736
  ds_write_b64 v17, v[100:101] offset:28800
  ds_write_b64 v17, v[102:103] offset:28864
  v_perm_b32 v104, v60, v50, s50
  s_waitcnt vmcnt(4)
  v_perm_b32 v105, v80, v70, s50
  v_perm_b32 v106, v60, v50, s51
  v_perm_b32 v107, v80, v70, s51
  v_perm_b32 v108, v61, v51, s50
  v_perm_b32 v109, v81, v71, s50
  v_perm_b32 v110, v61, v51, s51
  v_perm_b32 v111, v81, v71, s51
  ds_write_b64 v17, v[104:105] offset:36864
  ds_write_b64 v17, v[106:107] offset:36928
  ds_write_b64 v17, v[108:109] offset:36992
  ds_write_b64 v17, v[110:111] offset:37056
  v_perm_b32 v96, v62, v52, s50
  s_waitcnt vmcnt(3)
  v_perm_b32 v97, v82, v72, s50
  v_perm_b32 v98, v62, v52, s51
  v_perm_b32 v99, v82, v72, s51
  v_perm_b32 v100, v63, v53, s50
  v_perm_b32 v101, v83, v73, s50
  v_perm_b32 v102, v63, v53, s51
  v_perm_b32 v103, v83, v73, s51
  ds_write_b64 v17, v[96:97] offset:45056
  ds_write_b64 v17, v[98:99] offset:45120
  ds_write_b64 v17, v[100:101] offset:45184
  ds_write_b64 v17, v[102:103] offset:45248
  v_perm_b32 v104, v64, v54, s50
  s_waitcnt vmcnt(2)
  v_perm_b32 v105, v84, v74, s50
  v_perm_b32 v106, v64, v54, s51
  v_perm_b32 v107, v84, v74, s51
  v_perm_b32 v108, v65, v55, s50
  v_perm_b32 v109, v85, v75, s50
  v_perm_b32 v110, v65, v55, s51
  v_perm_b32 v111, v85, v75, s51
  ds_write_b64 v17, v[104:105] offset:53248
  ds_write_b64 v17, v[106:107] offset:53312
  ds_write_b64 v17, v[108:109] offset:53376
  ds_write_b64 v17, v[110:111] offset:53440
  v_perm_b32 v96, v66, v56, s50
  s_waitcnt vmcnt(1)
  v_perm_b32 v97, v86, v76, s50
  v_perm_b32 v98, v66, v56, s51
  v_perm_b32 v99, v86, v76, s51
  v_perm_b32 v100, v67, v57, s50
  v_perm_b32 v101, v87, v77, s50
  v_perm_b32 v102, v67, v57, s51
  v_perm_b32 v103, v87, v77, s51
  ds_write_b64 v17, v[96:97] offset:61440
  ds_write_b64 v17, v[98:99] offset:61504
  ds_write_b64 v17, v[100:101] offset:61568
  ds_write_b64 v17, v[102:103] offset:61632
  s_mov_b32 s12, 0x3f803f80
  s_lshl_b32 s6, s7, 6
  s_add_u32 s6, s6, 0x280000
  s_waitcnt lgkmcnt(0)
  s_barrier
  s_cmp_lg_u32 s3, 0
  s_cbranch_scc1 X_nst
  ds_read_b128 v[112:115], v20 offset:0
  ds_read_b128 v[116:119], v20 offset:1024
  ds_read_b128 v[120:123], v20 offset:2048
  ds_read_b128 v[124:127], v20 offset:3072
  ds_read_b128 v[128:131], v20 offset:4096
  ds_read_b128 v[132:135], v20 offset:5120
  ds_read_b128 v[136:139], v20 offset:6144
  ds_read_b128 v[140:143], v20 offset:7168
  ds_read_b128 v[144:147], v20 offset:8192
  ds_read_b128 v[148:151], v20 offset:9216
  ds_read_b128 v[152:155], v20 offset:10240
  ds_read_b128 v[156:159], v20 offset:11264
  ds_read_b128 v[160:163], v20 offset:12288
  ds_read_b128 v[164:167], v20 offset:13312
  ds_read_b128 v[168:171], v20 offset:14336
  ds_read_b128 v[172:175], v20 offset:15360
  ds_read_b128 v[176:179], v20 offset:16384
  ds_read_b128 v[180:183], v20 offset:17408
  ds_read_b128 v[184:187], v20 offset:18432
  ds_read_b128 v[188:191], v20 offset:19456
  s_waitcnt lgkmcnt(15)
  buffer_store_dwordx4 v[112:115], v19, s[60:63], s6 offen sc1
  s_add_u32 s6, s6, 65536
  buffer_store_dwordx4 v[116:119], v19, s[60:63], s6 offen sc1
  s_add_u32 s6, s6, 65536
  buffer_store_dwordx4 v[120:123], v19, s[60:63], s6 offen sc1
  s_add_u32 s6, s6, 65536
  buffer_store_dwordx4 v[124:127], v19, s[60:63], s6 offen sc1
  s_add_u32 s6, s6, 65536
  buffer_store_dwordx4 v[128:131], v19, s[60:63], s6 offen sc1
  ds_read_b128 v[112:115], v20 offset:20480
  s_add_u32 s6, s6, 65536
  s_waitcnt lgkmcnt(15)
  buffer_store_dwordx4 v[132:135], v19, s[60:63], s6 offen sc1
  ds_read_b128 v[116:119], v20 offset:21504
  s_add_u32 s6, s6, 65536
  s_waitcnt lgkmcnt(15)
  buffer_store_dwordx4 v[136:139], v19, s[60:63], s6 offen sc1
  ds_read_b128 v[120:123], v20 offset:22528
  s_add_u32 s6, s6, 65536
  s_waitcnt lgkmcnt(15)
  buffer_store_dwordx4 v[140:143], v19, s[60:63], s6 offen sc1
  ds_read_b128 v[124:127], v20 offset:23552
  s_add_u32 s6, s6, 65536
  s_waitcnt lgkmcnt(15)
  buffer_store_dwordx4 v[144:147], v19, s[60:63], s6 offen sc1
  ds_read_b128 v[128:131], v20 offset:24576
  s_add_u32 s6, s6, 65536
  s_waitcnt lgkmcnt(15)
  buffer_store_dwordx4 v[148:151], v19, s[60:63], s6 offen sc1
  ds_read_b128 v[132:135], v20 offset:25600
  s_add_u32 s6, s6, 65536
  s_waitcnt lgkmcnt(15)
  buffer_store_dwordx4 v[152:155], v19, s[60:63], s6 offen sc1
  ds_read_b128 v[136:139], v20 offset:26624
  s_add_u32 s6, s6, 65536
  s_waitcnt lgkmcnt(15)
  buffer_store_dwordx4 v[156:159], v19, s[60:63], s6 offen sc1
  ds_read_b128 v[140:143], v20 offset:27648
  s_add_u32 s6, s6, 65536
  s_waitcnt lgkmcnt(15)
  buffer_store_dwordx4 v[160:163], v19, s[60:63], s6 offen sc1
  ds_read_b128 v[144:147], v20 offset:28672
  s_add_u32 s6, s6, 65536
  s_waitcnt lgkmcnt(15)
  buffer_store_dwordx4 v[164:167], v19, s[60:63], s6 offen sc1
  ds_read_b128 v[148:151], v20 offset:29696
  s_add_u32 s6, s6, 65536
  s_waitcnt lgkmcnt(15)
  buffer_store_dwordx4 v[168:171], v19, s[60:63], s6 offen sc1
  ds_read_b128 v[152:155], v20 offset:30720
  s_add_u32 s6, s6, 65536
  s_waitcnt lgkmcnt(15)
  buffer_store_dwordx4 v[172:175], v19, s[60:63], s6 offen sc1
  ds_read_b128 v[156:159], v20 offset:31744
  s_add_u32 s6, s6, 65536
  s_waitcnt lgkmcnt(15)
  buffer_store_dwordx4 v[176:179], v19, s[60:63], s6 offen sc1
  ds_read_b128 v[160:163], v20 offset:32768
  s_add_u32 s6, s6, 65536
  s_waitcnt lgkmcnt(15)
  buffer_store_dwordx4 v[180:183], v19, s[60:63], s6 offen sc1
  ds_read_b128 v[164:167], v20 offset:33792
  s_add_u32 s6, s6, 65536
  s_waitcnt lgkmcnt(15)
  buffer_store_dwordx4 v[184:187], v19, s[60:63], s6 offen sc1
  ds_read_b128 v[168:171], v20 offset:34816
  s_add_u32 s6, s6, 65536
  s_waitcnt lgkmcnt(15)
  buffer_store_dwordx4 v[188:191], v19, s[60:63], s6 offen sc1
  ds_read_b128 v[172:175], v20 offset:35840
  s_add_u32 s6, s6, 65536
  s_waitcnt lgkmcnt(15)
  buffer_store_dwordx4 v[112:115], v19, s[60:63], s6 offen sc1
  ds_read_b128 v[176:179], v20 offset:36864
  s_add_u32 s6, s6, 65536
  s_waitcnt lgkmcnt(15)
  buffer_store_dwordx4 v[116:119], v19, s[60:63], s6 offen sc1
  ds_read_b128 v[180:183], v20 offset:37888
  s_add_u32 s6, s6, 65536
  s_waitcnt lgkmcnt(15)
  buffer_store_dwordx4 v[120:123], v19, s[60:63], s6 offen sc1
  ds_read_b128 v[184:187], v20 offset:38912
  s_add_u32 s6, s6, 65536
  s_waitcnt lgkmcnt(15)
  buffer_store_dwordx4 v[124:127], v19, s[60:63], s6 offen sc1
  ds_read_b128 v[188:191], v20 offset:39936
  s_add_u32 s6, s6, 65536
  s_waitcnt lgkmcnt(15)
  buffer_store_dwordx4 v[128:131], v19, s[60:63], s6 offen sc1
  s_add_u32 s6, s6, 65536
  s_waitcnt lgkmcnt(14)
  buffer_store_dwordx4 v[132:135], v19, s[60:63], s6 offen sc1
  s_add_u32 s6, s6, 65536
  s_waitcnt lgkmcnt(13)
  buffer_store_dwordx4 v[136:139], v19, s[60:63], s6 offen sc1
  s_add_u32 s6, s6, 65536
  s_waitcnt lgkmcnt(12)
  buffer_store_dwordx4 v[140:143], v19, s[60:63], s6 offen sc1
  s_add_u32 s6, s6, 65536
  s_waitcnt lgkmcnt(11)
  buffer_store_dwordx4 v[144:147], v19, s[60:63], s6 offen sc1
  s_add_u32 s6, s6, 65536
  s_waitcnt lgkmcnt(10)
  buffer_store_dwordx4 v[148:151], v19, s[60:63], s6 offen sc1
  s_add_u32 s6, s6, 65536
  s_waitcnt lgkmcnt(9)
  buffer_store_dwordx4 v[152:155], v19, s[60:63], s6 offen sc1
  s_add_u32 s6, s6, 65536
  s_waitcnt lgkmcnt(8)
  buffer_store_dwordx4 v[156:159], v19, s[60:63], s6 offen sc1
  s_add_u32 s6, s6, 65536
  s_waitcnt lgkmcnt(7)
  buffer_store_dwordx4 v[160:163], v19, s[60:63], s6 offen sc1
  s_add_u32 s6, s6, 65536
  s_waitcnt lgkmcnt(6)
  buffer_store_dwordx4 v[164:167], v19, s[60:63], s6 offen sc1
  s_add_u32 s6, s6, 65536
  s_waitcnt lgkmcnt(5)
  buffer_store_dwordx4 v[168:171], v19, s[60:63], s6 offen sc1
  s_add_u32 s6, s6, 65536
  s_waitcnt lgkmcnt(4)
  buffer_store_dwordx4 v[172:175], v19, s[60:63], s6 offen sc1
  s_add_u32 s6, s6, 65536
  s_waitcnt lgkmcnt(3)
  buffer_store_dwordx4 v[176:179], v19, s[60:63], s6 offen sc1
  s_add_u32 s6, s6, 65536
  s_waitcnt lgkmcnt(2)
  buffer_store_dwordx4 v[180:183], v19, s[60:63], s6 offen sc1
  s_add_u32 s6, s6, 65536
  s_waitcnt lgkmcnt(1)
  buffer_store_dwordx4 v[184:187], v19, s[60:63], s6 offen sc1
  s_add_u32 s6, s6, 65536
  s_waitcnt lgkmcnt(0)
  buffer_store_dwordx4 v[188:191], v19, s[60:63], s6 offen sc1
X_nst:
  v_dot2_f32_bf16 v24, v48, s12, 0
  v_dot2_f32_bf16 v28, v48, v48, 0
  v_dot2_f32_bf16 v25, v58, s12, 0
  v_dot2_f32_bf16 v29, v58, v58, 0
  v_dot2_f32_bf16 v26, v68, s12, 0
  v_dot2_f32_bf16 v30, v68, v68, 0
  v_dot2_f32_bf16 v27, v78, s12, 0
  v_dot2_f32_bf16 v31, v78, v78, 0
  v_dot2_f32_bf16 v24, v49, s12, v24
  v_dot2_f32_bf16 v28, v49, v49, v28
  v_dot2_f32_bf16 v25, v59, s12, v25
  v_dot2_f32_bf16 v29, v59, v59, v29
  v_dot2_f32_bf16 v26, v69, s12, v26
  v_dot2_f32_bf16 v30, v69, v69, v30
  v_dot2_f32_bf16 v27, v79, s12, v27
  v_dot2_f32_bf16 v31, v79, v79, v31
  v_dot2_f32_bf16 v24, v50, s12, v24
  v_dot2_f32_bf16 v28, v50, v50, v28
  v_dot2_f32_bf16 v25, v60, s12, v25
  v_dot2_f32_bf16 v29, v60, v60, v29
  v_dot2_f32_bf16 v26, v70, s12, v26
  v_dot2_f32_bf16 v30, v70, v70, v30
  v_dot2_f32_bf16 v27, v80, s12, v27
  v_dot2_f32_bf16 v31, v80, v80, v31
  v_dot2_f32_bf16 v24, v51, s12, v24
  v_dot2_f32_bf16 v28, v51, v51, v28
  v_dot2_f32_bf16 v25, v61, s12, v25
  v_dot2_f32_bf16 v29, v61, v61, v29
  v_dot2_f32_bf16 v26, v71, s12, v26
  v_dot2_f32_bf16 v30, v71, v71, v30
  v_dot2_f32_bf16 v27, v81, s12, v27
  v_dot2_f32_bf16 v31, v81, v81, v31
  v_dot2_f32_bf16 v24, v52, s12, v24
  v_dot2_f32_bf16 v28, v52, v52, v28
  v_dot2_f32_bf16 v25, v62, s12, v25
  v_dot2_f32_bf16 v29, v62, v62, v29
  v_dot2_f32_bf16 v26, v72, s12, v26
  v_dot2_f32_bf16 v30, v72, v72, v30
  v_dot2_f32_bf16 v27, v82, s12, v27
  v_dot2_f32_bf16 v31, v82, v82, v31
  v_dot2_f32_bf16 v24, v53, s12, v24
  v_dot2_f32_bf16 v28, v53, v53, v28
  v_dot2_f32_bf16 v25, v63, s12, v25
  v_dot2_f32_bf16 v29, v63, v63, v29
  v_dot2_f32_bf16 v26, v73, s12, v26
  v_dot2_f32_bf16 v30, v73, v73, v30
  v_dot2_f32_bf16 v27, v83, s12, v27
  v_dot2_f32_bf16 v31, v83, v83, v31
  v_dot2_f32_bf16 v24, v54, s12, v24
  v_dot2_f32_bf16 v28, v54, v54, v28
  v_dot2_f32_bf16 v25, v64, s12, v25
  v_dot2_f32_bf16 v29, v64, v64, v29
  v_dot2_f32_bf16 v26, v74, s12, v26
  v_dot2_f32_bf16 v30, v74, v74, v30
  v_dot2_f32_bf16 v27, v84, s12, v27
  v_dot2_f32_bf16 v31, v84, v84, v31
  v_dot2_f32_bf16 v24, v55, s12, v24
  v_dot2_f32_bf16 v28, v55, v55, v28
  v_dot2_f32_bf16 v25, v65, s12, v25
  v_dot2_f32_bf16 v29, v65, v65, v29
  v_dot2_f32_bf16 v26, v75, s12, v26
  v_dot2_f32_bf16 v30, v75, v75, v30
  v_dot2_f32_bf16 v27, v85, s12, v27
  v_dot2_f32_bf16 v31, v85, v85, v31
  v_dot2_f32_bf16 v24, v56, s12, v24
  v_dot2_f32_bf16 v28, v56, v56, v28
  v_dot2_f32_bf16 v25, v66, s12, v25
  v_dot2_f32_bf16 v29, v66, v66, v29
  v_dot2_f32_bf16 v26, v76, s12, v26
  v_dot2_f32_bf16 v30, v76, v76, v30
  v_dot2_f32_bf16 v27, v86, s12, v27
  v_dot2_f32_bf16 v31, v86, v86, v31
  v_dot2_f32_bf16 v24, v57, s12, v24
  v_dot2_f32_bf16 v28, v57, v57, v28
  v_dot2_f32_bf16 v25, v67, s12, v25
  v_dot2_f32_bf16 v29, v67, v67, v29
  v_dot2_f32_bf16 v26, v77, s12, v26
  v_dot2_f32_bf16 v30, v77, v77, v30
  v_dot2_f32_bf16 v27, v87, s12, v27
  v_dot2_f32_bf16 v31, v87, v87, v31
  v_permlane16_swap_b32 v24, v25
  s_nop 0
  v_permlane16_swap_b32 v26, v27
  v_permlane16_swap_b32 v28, v29
  v_permlane16_swap_b32 v30, v31
  v_add_f32 v24, v24, v25
  v_add_f32 v26, v26, v27
  v_add_f32 v28, v28, v29
  v_add_f32 v30, v30, v31
  v_add_f32 v24, v24, v24 row_ror:8 row_mask:0xf bank_mask:0xf
  v_add_f32 v28, v28, v28 row_ror:8 row_mask:0xf bank_mask:0xf
  v_add_f32 v26, v26, v26 row_ror:8 row_mask:0xf bank_mask:0xf
  v_add_f32 v30, v30, v30 row_ror:8 row_mask:0xf bank_mask:0xf
  v_add_f32 v24, v24, v24 row_ror:4 row_mask:0xf bank_mask:0xf
  v_add_f32 v28, v28, v28 row_ror:4 row_mask:0xf bank_mask:0xf
  v_add_f32 v26, v26, v26 row_ror:4 row_mask:0xf bank_mask:0xf
  v_add_f32 v30, v30, v30 row_ror:4 row_mask:0xf bank_mask:0xf
  v_add_f32 v24, v24, v24 row_ror:2 row_mask:0xf bank_mask:0xf
  v_add_f32 v28, v28, v28 row_ror:2 row_mask:0xf bank_mask:0xf
  v_add_f32 v26, v26, v26 row_ror:2 row_mask:0xf bank_mask:0xf
  v_add_f32 v30, v30, v30 row_ror:2 row_mask:0xf bank_mask:0xf
  v_add_f32 v24, v24, v24 row_ror:1 row_mask:0xf bank_mask:0xf
  v_add_f32 v28, v28, v28 row_ror:1 row_mask:0xf bank_mask:0xf
  v_add_f32 v26, v26, v26 row_ror:1 row_mask:0xf bank_mask:0xf
  v_add_f32 v30, v30, v30 row_ror:1 row_mask:0xf bank_mask:0xf
  v_and_b32 v3, 1, v1
  v_cmp_ne_u32 vcc, 0, v3
  s_nop 1
  v_cndmask_b32 v24, v24, v26, vcc
  v_cndmask_b32 v28, v28, v30, vcc
  v_mul_f32 v24, 0x3acccccd, v24
  v_mul_f32 v4, v24, v24
  v_mul_f32 v28, 0x3acccccd, v28
  v_sub_f32 v28, v28, v4
  v_max_f32 v28, 0, v28
  v_cvt_pk_bf16_f32 v24, v24, v24
  v_and_b32 v24, 0xffff0000, v24
  v_cvt_pk_bf16_f32 v28, v28, v28
  v_and_b32 v28, 0xffff0000, v28
  v_add_f32 v28, 0x3727c5ac, v28
  v_cvt_pk_bf16_f32 v28, v28, v28
  v_and_b32 v28, 0xffff0000, v28
  v_sqrt_f32 v28, v28
  s_nop 0
  v_cvt_pk_bf16_f32 v28, v28, v28
  v_and_b32 v28, 0xffff0000, v28
  v_rcp_f32 v28, v28
  s_nop 0
  v_mul_f32 v24, -v24, v28
  v_cvt_pk_bf16_f32 v28, v28, v24
  v_bfe_u32 v2, v1, 4, 1
  v_lshl_or_b32 v3, v3, 1, v2
  v_lshrrev_b32 v2, 5, v1
  v_lshl_or_b32 v3, v2, 2, v3
  s_lshl_b32 s4, s3, 5
  s_add_u32 s4, s4, 153824
  v_lshl_add_u32 v3, v3, 2, s4
  ds_write_b32 v3, v28
  s_waitcnt lgkmcnt(0)
  s_barrier
  s_cmp_lg_u32 s3, 0
  s_cbranch_scc1 H_w123
  v_and_b32 v2, 31, v1
  v_lshlrev_b32 v2, 2, v2
  v_add_u32 v3, 153824, v2
  ds_read_b32 v4, v3
  s_lshl_b32 s4, s7, 7
  s_add_u32 s4, s4, 0x7a0000
  s_waitcnt lgkmcnt(0)
  buffer_store_dword v4, v2, s[60:63], s4 offen sc1
  s_waitcnt vmcnt(0)
  s_cmp_lg_u32 s3, 0
  s_cbranch_scc1 X_pub
  s_lshr_b32 s4, s7, 2
  s_lshl_b32 s4, s4, 7
  s_and_b32 s5, s7, 3
  s_lshl_b32 s5, s5, 2
  s_add_u32 s4, s4, s5
  s_add_u32 s4, s4, 0x1810000
  v_mul_u32_u24 v2, 3072, v1
  s_mov_b64 exec, 15
  buffer_store_dword v255, v2, s[60:63], s4 offen sc1
  s_mov_b64 exec, -1
X_pub:
  s_branch H_xj
H_w123:
  s_cmp_eq_u32 s16, 5
  s_cbranch_scc1 H_a
  v_lshrrev_b32 v2, 3, v1
  v_mul_u32_u24 v2, 1280, v2
  v_and_b32 v3, 1, v1
  v_lshl_add_u32 v2, v3, 4, v2
  v_bfe_u32 v3, v1, 1, 2
  v_bfe_u32 v4, v1, 4, 1
  v_xor_b32 v3, v3, v4
  s_and_b32 s4, s3, 1
  s_lshl_b32 s4, s4, 1
  v_xor_b32 v3, s4, v3
  v_lshl_add_u32 v88, v3, 5, v2
  v_xor_b32 v3, 2, v3
  v_lshl_add_u32 v89, v3, 5, v2
  s_mul_i32 s10, s14, 276480
  s_lshl_b32 s4, s13, 7
  s_add_u32 s10, s10, s4
  s_mul_i32 s4, s3, 71680
  s_add_u32 s10, s10, s4
  s_lshr_b32 s4, s3, 1
  s_mul_i32 s4, s4, 5120
  s_sub_u32 s10, s10, s4
  s_mul_i32 s12, s3, 7168
  s_cmp_lg_u32 s3, 2
  s_cbranch_scc1 H_d0
  s_sub_u32 s10, s10, 138240
  s_sub_u32 s12, s12, 14336
  s_add_u32 m0, s12, 0
  s_add_u32 s4, s10, 0
  buffer_load_dwordx4 v88, s[52:55], s4 offen nt lds
  s_add_u32 m0, s12, 1024
  s_add_u32 s4, s10, 10240
  buffer_load_dwordx4 v89, s[52:55], s4 offen nt lds
  s_add_u32 m0, s12, 2048
  s_add_u32 s4, s10, 20480
  buffer_load_dwordx4 v88, s[52:55], s4 offen nt lds
  s_add_u32 m0, s12, 3072
  s_add_u32 s4, s10, 30720
  buffer_load_dwordx4 v89, s[52:55], s4 offen nt lds
  s_add_u32 m0, s12, 4096
  s_add_u32 s4, s10, 40960
  buffer_load_dwordx4 v88, s[52:55], s4 offen nt lds
  s_add_u32 m0, s12, 5120
  s_add_u32 s4, s10, 51200
  buffer_load_dwordx4 v89, s[52:55], s4 offen nt lds
  s_add_u32 m0, s12, 6144
  s_add_u32 s4, s10, 61440
  buffer_load_dwordx4 v88, s[52:55], s4 offen nt lds
  s_add_u32 s10, s10, 138240
  s_add_u32 s12, s12, 14336
H_d0:
  s_add_u32 m0, s12, 0
  s_add_u32 s4, s10, 0
  buffer_load_dwordx4 v88, s[52:55], s4 offen nt lds
  s_add_u32 m0, s12, 1024
  s_add_u32 s4, s10, 10240
  buffer_load_dwordx4 v89, s[52:55], s4 offen nt lds
  s_add_u32 m0, s12, 2048
  s_add_u32 s4, s10, 20480
  buffer_load_dwordx4 v88, s[52:55], s4 offen nt lds
  s_add_u32 m0, s12, 3072
  s_add_u32 s4, s10, 30720
  buffer_load_dwordx4 v89, s[52:55], s4 offen nt lds
  s_add_u32 m0, s12, 4096
  s_add_u32 s4, s10, 40960
  buffer_load_dwordx4 v88, s[52:55], s4 offen nt lds
  s_add_u32 m0, s12, 5120
  s_add_u32 s4, s10, 51200
  buffer_load_dwordx4 v89, s[52:55], s4 offen nt lds
  s_add_u32 m0, s12, 6144
  s_add_u32 s4, s10, 61440
  buffer_load_dwordx4 v88, s[52:55], s4 offen nt lds
H_a:
  s_add_u32 s4, s15, 1327104
  buffer_load_dword v92, v91, s[64:67], s4 offen
  s_cmp_lg_u32 s3, 1
  s_cbranch_scc1 H_t47
  s_add_u32 s4, s15, 1299456
  buffer_load_dword v92, v91, s[64:67], s4 offen
H_t47:
  v_mov_b32 v236, 0
  v_mov_b32 v237, 0
  v_mov_b32 v238, 0x3f803f80
  v_mov_b32 v239, 0x3f803f80
  v_min_u32 v2, 6, v1
  v_mul_u32_u24 v2, 14368, v2
  ds_write_b128 v2, v[236:239] offset:60416
  s_cmp_lg_u32 s3, 1
  s_cbranch_scc1 H_rx
  s_mov_b32 exec_hi, 0xffffff
  s_add_u32 m0, s38, 0
  s_add_u32 s49, s42, 0
  buffer_load_dwordx4 v226, s[64:67], s49 offen offset:0 lds
  buffer_load_dwordx4 v227, s[64:67], s49 offen offset:896 lds
  buffer_load_dwordx4 v228, s[64:67], s49 offen offset:1792 lds
  buffer_load_dwordx4 v229, s[64:67], s49 offen offset:2688 lds
  s_add_u32 m0, s38, 14368
  s_add_u32 s49, s42, 110592
  buffer_load_dwordx4 v226, s[64:67], s49 offen offset:0 lds
  buffer_load_dwordx4 v227, s[64:67], s49 offen offset:896 lds
  buffer_load_dwordx4 v228, s[64:67], s49 offen offset:1792 lds
  buffer_load_dwordx4 v229, s[64:67], s49 offen offset:2688 lds
  s_add_u32 m0, s38, 28736
  s_add_u32 s49, s42, 221184
  buffer_load_dwordx4 v226, s[64:67], s49 offen offset:0 lds
  buffer_load_dwordx4 v227, s[64:67], s49 offen offset:896 lds
  buffer_load_dwordx4 v228, s[64:67], s49 offen offset:1792 lds
  buffer_load_dwordx4 v229, s[64:67], s49 offen offset:2688 lds
  s_add_u32 m0, s38, 43104
  s_add_u32 s49, s42, 331776
  buffer_load_dwordx4 v226, s[64:67], s49 offen offset:0 lds
  buffer_load_dwordx4 v227, s[64:67], s49 offen offset:896 lds
  buffer_load_dwordx4 v228, s[64:67], s49 offen offset:1792 lds
  buffer_load_dwordx4 v229, s[64:67], s49 offen offset:2688 lds
  s_mov_b32 exec_hi, -1
  s_sub_u32 s38, s38, 3584
  v_subrev_u32 v226, 55296, v226
  v_subrev_u32 v227, 55296, v227
  v_subrev_u32 v228, 55296, v228
  v_subrev_u32 v229, 55296, v229
  s_mov_b32 exec_hi, 0xffffff
  s_add_u32 m0, s38, 0
  s_add_u32 s49, s42, 0
  buffer_load_dwordx4 v226, s[64:67], s49 offen offset:0 lds
  buffer_load_dwordx4 v227, s[64:67], s49 offen offset:896 lds
  buffer_load_dwordx4 v228, s[64:67], s49 offen offset:1792 lds
  buffer_load_dwordx4 v229, s[64:67], s49 offen offset:2688 lds
  s_add_u32 m0, s38, 14368
  s_add_u32 s49, s42, 110592
  buffer_load_dwordx4 v226, s[64:67], s49 offen offset:0 lds
  buffer_load_dwordx4 v227, s[64:67], s49 offen offset:896 lds
  buffer_load_dwordx4 v228, s[64:67], s49 offen offset:1792 lds
  buffer_load_dwordx4 v229, s[64:67], s49 offen offset:2688 lds
  s_add_u32 m0, s38, 28736
  s_add_u32 s49, s42, 221184
  buffer_load_dwordx4 v226, s[64:67], s49 offen offset:0 lds
  buffer_load_dwordx4 v227, s[64:67], s49 offen offset:896 lds
  buffer_load_dwordx4 v228, s[64:67], s49 offen offset:1792 lds
  buffer_load_dwordx4 v229, s[64:67], s49 offen offset:2688 lds
  s_add_u32 m0, s38, 43104
  s_add_u32 s49, s42, 331776
  buffer_load_dwordx4 v226, s[64:67], s49 offen offset:0 lds
  buffer_load_dwordx4 v227, s[64:67], s49 offen offset:896 lds
  buffer_load_dwordx4 v228, s[64:67], s49 offen offset:1792 lds
  buffer_load_dwordx4 v229, s[64:67], s49 offen offset:2688 lds
  s_mov_b32 exec_hi, -1
  s_add_u32 s38, s38, 3584
  v_add_u32 v226, 55296, v226
  v_add_u32 v227, 55296, v227
  v_add_u32 v228, 55296, v228
  v_add_u32 v229, 55296, v229
  s_waitcnt vmcnt(32)
H_rx:
  s_cmp_lt_u32 s3, 2
  s_cbranch_scc1 H_ry
  s_mov_b32 exec_hi, 0xffffff
  s_add_u32 m0, s38, 0
  s_add_u32 s49, s42, 0
  buffer_load_dwordx4 v226, s[64:67], s49 offen offset:0 lds
  buffer_load_dwordx4 v227, s[64:67], s49 offen offset:896 lds
  buffer_load_dwordx4 v228, s[64:67], s49 offen offset:1792 lds
  buffer_load_dwordx4 v229, s[64:67], s49 offen offset:2688 lds
  s_add_u32 m0, s38, 14368
  s_add_u32 s49, s42, 110592
  buffer_load_dwordx4 v226, s[64:67], s49 offen offset:0 lds
  buffer_load_dwordx4 v227, s[64:67], s49 offen offset:896 lds
  buffer_load_dwordx4 v228, s[64:67], s49 offen offset:1792 lds
  buffer_load_dwordx4 v229, s[64:67], s49 offen offset:2688 lds
  s_add_u32 m0, s38, 28736
  s_add_u32 s49, s42, 221184
  buffer_load_dwordx4 v226, s[64:67], s49 offen offset:0 lds
  buffer_load_dwordx4 v227, s[64:67], s49 offen offset:896 lds
  buffer_load_dwordx4 v228, s[64:67], s49 offen offset:1792 lds
  buffer_load_dwordx4 v229, s[64:67], s49 offen offset:2688 lds
  s_add_u32 m0, s38, 43104
  s_add_u32 s49, s42, 331776
  buffer_load_dwordx4 v226, s[64:67], s49 offen offset:0 lds
  buffer_load_dwordx4 v227, s[64:67], s49 offen offset:896 lds
  buffer_load_dwordx4 v228, s[64:67], s49 offen offset:1792 lds
  buffer_load_dwordx4 v229, s[64:67], s49 offen offset:2688 lds
  s_mov_b32 exec_hi, -1
  s_waitcnt vmcnt(16)
H_ry:
H_xj:
  s_mov_b32 s8, 1
  s_cmp_lg_u32 s16, 5
  s_cbranch_scc1 H_nx2
  s_mov_b32 exec_hi, 0xffffff
  s_add_u32 m0, s38, 57472
  s_add_u32 s49, s42, 884736
  buffer_load_dwordx4 v226, s[64:67], s49 offen offset:0 lds
  buffer_load_dwordx4 v227, s[64:67], s49 offen offset:896 lds
  buffer_load_dwordx4 v228, s[64:67], s49 offen offset:1792 lds
  buffer_load_dwordx4 v229, s[64:67], s49 offen offset:2688 lds
  s_add_u32 m0, s38, 71840
  s_add_u32 s49, s42, 995328
  buffer_load_dwordx4 v226, s[64:67], s49 offen offset:0 lds
  buffer_load_dwordx4 v227, s[64:67], s49 offen offset:896 lds
  buffer_load_dwordx4 v228, s[64:67], s49 offen offset:1792 lds
  buffer_load_dwordx4 v229, s[64:67], s49 offen offset:2688 lds
  s_add_u32 m0, s38, 86208
  s_add_u32 s49, s42, 1105920
  buffer_load_dwordx4 v226, s[64:67], s49 offen offset:0 lds
  buffer_load_dwordx4 v227, s[64:67], s49 offen offset:896 lds
  buffer_load_dwordx4 v228, s[64:67], s49 offen offset:1792 lds
  buffer_load_dwordx4 v229, s[64:67], s49 offen offset:2688 lds
  s_mov_b32 exec_hi, -1
  s_lshr_b32 s4, s7, 3
  s_lshl_b32 s4, s4, 1
  s_and_b32 s5, s3, 1
  s_add_u32 s4, s4, s5
  s_cmp_lt_u32 s4, 16
  s_cselect_b32 s5, 16, 56
  s_add_u32 s4, s4, s5
  s_mul_i32 s4, s4, 27648
  buffer_load_dword v92, v91, s[64:67], s4 offen
  s_waitcnt vmcnt(13)
  s_branch H_nd2
H_nx1:
  s_cmp_ge_u32 s3, 2
  s_waitcnt lgkmcnt(0)
  s_cselect_b32 s64, s32, s30
  s_cselect_b32 s65, s33, s31
  s_and_b32 s65, s65, 0xffff
  s_mov_b32 s66, 0x21c000
  s_mov_b32 s67, 0x20000
  s_and_b32 s4, s2, 3
  s_mul_i32 s4, s4, 27
  s_lshr_b32 s4, s4, 2
  v_and_b32 v2, 7, v1
  v_add_u32 v2, s4, v2
  v_min_u32 v2, 26, v2
  v_lshrrev_b32 v3, 3, v1
  v_mul_u32_u24 v3, 3456, v3
  v_lshl_add_u32 v91, v2, 7, v3
  s_bfe_u32 s15, s7, 196611
  s_lshl_b32 s15, s15, 1
  s_and_b32 s4, s3, 1
  s_add_u32 s15, s15, s4
  s_mul_i32 s15, s15, 27648
  s_add_u32 s4, s15, 0
  buffer_load_dword v92, v91, s[64:67], s4 offen
  s_add_u32 s4, s15, 221184
  buffer_load_dword v92, v91, s[64:67], s4 offen
  s_add_u32 s4, s15, 1105920
  buffer_load_dword v92, v91, s[64:67], s4 offen
  s_add_u32 s4, s15, 1769472
  buffer_load_dword v92, v91, s[64:67], s4 offen
  s_mov_b32 s60, s40
  s_and_b32 s61, s41, 0xffff
  s_mov_b32 s62, 0x1e00000
  s_mov_b32 s63, 0x20000
  s_mov_b32 s43, 0x1820000
  s_load_dword s43, s[40:41], s43
  s_mov_b32 s52, s34
  s_and_b32 s53, s35, 0xffff
  s_mov_b32 s54, 0x21c000
  s_mov_b32 s55, 0x20000
  s_bfe_u32 s16, s2, 65538
  s_lshl_b32 s16, s16, 3
  s_lshr_b32 s5, s2, 5
  s_add_u32 s16, s16, s5
  s_and_b32 s17, s2, 3
  s_lshl_b32 s17, s17, 2
  s_bfe_u32 s5, s2, 131075
  s_add_u32 s17, s17, s5
  s_mul_i32 s18, s3, 13
  s_add_u32 s18, s18, 3
  s_lshr_b32 s18, s18, 2
  s_lshr_b32 s31, s3, 1
  s_mul_i32 s31, s31, 10
  s_add_u32 s31, s31, 3
  s_and_b32 s6, s17, 1
  s_lshl_b32 s6, s6, 3
  s_mul_i32 s42, s17, 216
  s_sub_u32 s42, s42, s6
  s_lshr_b32 s4, s3, 1
  s_mul_i32 s38, s4, 7184
  s_and_b32 s4, s3, 1
  s_mul_i32 s5, s4, 3584
  s_add_u32 s38, s38, s5
  s_add_u32 s38, s38, 53248
  s_mul_i32 s4, s4, 55296
  v_mul_u32_u24 v2, 37, v1
  v_lshrrev_b32 v2, 9, v2
  v_mul_u32_u24 v2, 3232, v2
  v_add3_u32 v226, v2, v5, s4
  v_add_u32 v227, 26752, v226
  v_add_u32 v228, 12032, v226
  v_add_u32 v229, 38784, v226
  v_lshrrev_b32 v2, 5, v1
  v_bfe_u32 v3, v1, 2, 3
  v_lshl_add_u32 v2, v2, 4, v3
  v_mul_u32_u24 v2, 224, v2
  s_add_u32 s6, s6, 53248
  v_add_u32 v2, s6, v2
  s_lshl_b32 s4, s18, 4
  v_and_b32 v3, 3, v1
  v_lshl_add_u32 v3, v3, 3, v2
  v_add_u32 v230, s4, v3
  v_and_b32 v3, 1, v1
  v_lshl_add_u32 v2, v3, 3, v2
  v_bfe_u32 v4, v1, 1, 1
  v_mul_u32_u24 v233, 7184, v4
  v_add_u32 v2, v2, v233
  s_add_u32 s4, s4, 32
  v_add_u32 v231, s4, v2
  s_lshl_b32 s4, s31, 4
  v_add_u32 v232, s4, v2
  v_add_u32 v233, 1792, v232
  v_lshlrev_b32 v4, 3, v4
  v_add_u32 v4, 60416, v4
  s_lshr_b32 s4, s3, 1
  v_and_b32 v3, s4, v3
  v_cmp_ne_u32 vcc, 0, v3
  s_nop 1
  v_cndmask_b32 v232, v232, v4, vcc
  v_cndmask_b32 v233, v233, v4, vcc
  s_waitcnt lgkmcnt(0)
  s_mul_i32 s100, s43, 0x9e3779b1
  s_add_u32 s100, s100, 0x7f4a7c15
  s_mov_b32 s101, s100
  v_mov_b32 v255, s100
  s_sub_u32 s9, s7, 16
  s_lshr_b32 s4, s7, 3
  s_lshl_b32 s4, s4, 2
  s_and_b32 s5, s7, 3
  s_add_u32 s4, s4, s5
  s_cmp_lt_u32 s7, 32
  s_cselect_b32 s9, s4, s9
  s_mul_i32 s14, s9, 205
  s_lshr_b32 s14, s14, 11
  s_mul_i32 s4, s14, 10
  s_sub_u32 s13, s9, s4
  s_lshl_b32 s4, s16, 3
  s_lshr_b32 s5, s17, 3
  s_lshl_b32 s5, s5, 2
  s_add_u32 s4, s4, s5
  s_and_b32 s5, s17, 3
  s_add_u32 s4, s4, s5
  s_lshl_b32 s28, s4, 9
  s_and_b32 s5, s17, 4
  s_add_u32 s5, s5, s3
  s_lshl_b32 s5, s5, 2
  s_add_u32 s28, s28, s5
  s_add_u32 s28, s28, 0x780000
  v_lshrrev_b32 v2, 4, v1
  v_bfe_u32 v3, v1, 2, 2
  v_cmp_eq_u32 vcc, v2, v3
  v_and_b32 v2, 15, v1
  v_lshlrev_b32 v2, 5, v2
  v_mov_b32 v3, 0x7f000000
  v_cndmask_b32 v247, v3, v2, vcc
  v_lshrrev_b32 v2, 3, v1
  v_mul_u32_u24 v2, 1280, v2
  v_and_b32 v3, 1, v1
  v_lshl_add_u32 v2, v3, 4, v2
  v_bfe_u32 v3, v1, 1, 2
  v_bfe_u32 v4, v1, 4, 1
  v_xor_b32 v3, v3, v4
  s_and_b32 s4, s3, 1
  s_lshl_b32 s4, s4, 1
  v_xor_b32 v3, s4, v3
  v_lshl_add_u32 v88, v3, 5, v2
  v_xor_b32 v3, 2, v3
  v_lshl_add_u32 v89, v3, 5, v2
  s_mul_i32 s10, s14, 276480
  s_lshl_b32 s4, s13, 7
  s_add_u32 s10, s10, s4
  s_mul_i32 s4, s3, 71680
  s_add_u32 s10, s10, s4
  s_lshr_b32 s4, s3, 1
  s_mul_i32 s4, s4, 5120
  s_sub_u32 s10, s10, s4
  s_mul_i32 s12, s3, 7168
  s_add_u32 m0, s12, 0
  s_add_u32 s4, s10, 0
  buffer_load_dwordx4 v88, s[52:55], s4 offen nt lds
  s_add_u32 m0, s12, 1024
  s_add_u32 s4, s10, 10240
  buffer_load_dwordx4 v89, s[52:55], s4 offen nt lds
  s_add_u32 m0, s12, 2048
  s_add_u32 s4, s10, 20480
  buffer_load_dwordx4 v88, s[52:55], s4 offen nt lds
  s_add_u32 m0, s12, 3072
  s_add_u32 s4, s10, 30720
  buffer_load_dwordx4 v89, s[52:55], s4 offen nt lds
  s_add_u32 m0, s12, 4096
  s_add_u32 s4, s10, 40960
  buffer_load_dwordx4 v88, s[52:55], s4 offen nt lds
  s_add_u32 m0, s12, 5120
  s_add_u32 s4, s10, 51200
  buffer_load_dwordx4 v89, s[52:55], s4 offen nt lds
  s_add_u32 m0, s12, 6144
  s_add_u32 s4, s10, 61440
  buffer_load_dwordx4 v88, s[52:55], s4 offen nt lds
  v_mov_b32 v236, 0
  v_mov_b32 v237, 0
  v_mov_b32 v238, 0x3f803f80
  v_mov_b32 v239, 0x3f803f80
  v_min_u32 v2, 6, v1
  v_mul_u32_u24 v2, 14368, v2
  ds_write_b128 v2, v[236:239] offset:60416
  s_mov_b32 exec_hi, 0xffffff
  s_add_u32 m0, s38, 0
  s_add_u32 s49, s42, 0
  buffer_load_dwordx4 v226, s[64:67], s49 offen offset:0 lds
  buffer_load_dwordx4 v227, s[64:67], s49 offen offset:896 lds
  buffer_load_dwordx4 v228, s[64:67], s49 offen offset:1792 lds
  buffer_load_dwordx4 v229, s[64:67], s49 offen offset:2688 lds
  s_add_u32 m0, s38, 14368
  s_add_u32 s49, s42, 110592
  buffer_load_dwordx4 v226, s[64:67], s49 offen offset:0 lds
  buffer_load_dwordx4 v227, s[64:67], s49 offen offset:896 lds
  buffer_load_dwordx4 v228, s[64:67], s49 offen offset:1792 lds
  buffer_load_dwordx4 v229, s[64:67], s49 offen offset:2688 lds
  s_add_u32 m0, s38, 28736
  s_add_u32 s49, s42, 221184
  buffer_load_dwordx4 v226, s[64:67], s49 offen offset:0 lds
  buffer_load_dwordx4 v227, s[64:67], s49 offen offset:896 lds
  buffer_load_dwordx4 v228, s[64:67], s49 offen offset:1792 lds
  buffer_load_dwordx4 v229, s[64:67], s49 offen offset:2688 lds
  s_add_u32 m0, s38, 43104
  s_add_u32 s49, s42, 331776
  buffer_load_dwordx4 v226, s[64:67], s49 offen offset:0 lds
  buffer_load_dwordx4 v227, s[64:67], s49 offen offset:896 lds
  buffer_load_dwordx4 v228, s[64:67], s49 offen offset:1792 lds
  buffer_load_dwordx4 v229, s[64:67], s49 offen offset:2688 lds
  s_mov_b32 exec_hi, -1
  v_mov_b32 v93, -1
  buffer_store_dword v93, v247, s[60:63], s28 offen sc1
  s_waitcnt vmcnt(17)
  s_mov_b32 s8, 0
H_nx2:
  s_barrier
  v_lshrrev_b32 v2, 4, v1
  v_bfe_u32 v3, v1, 2, 2
  v_lshl_add_u32 v4, v2, 3, v3
  v_lshlrev_b32 v4, 7, v4
  v_and_b32 v2, 1, v2
  v_lshrrev_b32 v3, 1, v3
  v_lshl_or_b32 v2, v2, 1, v3
  v_xor_b32 v2, s3, v2
  v_lshl_add_u32 v4, v2, 5, v4
  v_and_b32 v2, 3, v1
  v_lshl_add_u32 v4, v2, 3, v4
  v_add_u32 v90, 0, v4
  s_lshl_b32 s4, s13, 2
  s_add_u32 s4, s4, s3
  s_mul_i32 s10, s4, 57344
  s_mul_i32 s5, s14, 7168
  s_add_u32 s10, s10, s5
  s_add_u32 s10, s10, 0xd00000
  s_add_u32 s12, s10, 4096
  s_mov_b32 s68, 0xffff0000
  s_mov_b32 s69, 0
  s_mov_b32 s50, 0
  s_mov_b32 s51, 0xffff0000
  ds_read_b64_tr_b16 v[176:177], v90 offset:0
  ds_read_b64_tr_b16 v[178:179], v90 offset:512
  ds_read_b64_tr_b16 v[180:181], v90 offset:4096
  ds_read_b64_tr_b16 v[182:183], v90 offset:4608
  ds_read_b64_tr_b16 v[184:185], v90 offset:8192
  ds_read_b64_tr_b16 v[186:187], v90 offset:8704
  ds_read_b64_tr_b16 v[188:189], v90 offset:12288
  ds_read_b64_tr_b16 v[190:191], v90 offset:12800
  ds_read_b64_tr_b16 v[192:193], v90 offset:16384
  ds_read_b64_tr_b16 v[194:195], v90 offset:16896
  ds_read_b64_tr_b16 v[196:197], v90 offset:20480
  ds_read_b64_tr_b16 v[198:199], v90 offset:20992
  ds_read_b64_tr_b16 v[200:201], v90 offset:24576
  ds_read_b64_tr_b16 v[202:203], v90 offset:25088
  s_waitcnt lgkmcnt(12)
  buffer_store_dwordx4 v[176:179], v5, s[60:63], s10 offen offset:0 sc1
  s_waitcnt lgkmcnt(10)
  buffer_store_dwordx4 v[180:183], v5, s[60:63], s10 offen offset:1024 sc1
  s_waitcnt lgkmcnt(8)
  buffer_store_dwordx4 v[184:187], v5, s[60:63], s10 offen offset:2048 sc1
  s_waitcnt lgkmcnt(6)
  v_cndmask_b32 v190, v190, 0, s[68:69]
  v_cndmask_b32 v191, v191, 0, s[68:69]
  buffer_store_dwordx4 v[188:191], v5, s[60:63], s10 offen offset:3072 sc1
  s_waitcnt lgkmcnt(4)
  buffer_store_dwordx4 v[192:195], v5, s[60:63], s12 offen offset:0 sc1
  s_waitcnt lgkmcnt(2)
  buffer_store_dwordx4 v[196:199], v5, s[60:63], s12 offen offset:1024 sc1
  s_waitcnt lgkmcnt(0)
  v_cndmask_b32 v202, v202, 0, s[50:51]
  v_cndmask_b32 v203, v203, 0, s[50:51]
  buffer_store_dwordx4 v[200:203], v5, s[60:63], s12 offen offset:2048 sc1
  s_mov_b32 exec_hi, 0xffffff
  s_add_u32 m0, s38, 57472
  s_add_u32 s49, s42, 884736
  buffer_load_dwordx4 v226, s[64:67], s49 offen offset:0 lds
  buffer_load_dwordx4 v227, s[64:67], s49 offen offset:896 lds
  buffer_load_dwordx4 v228, s[64:67], s49 offen offset:1792 lds
  buffer_load_dwordx4 v229, s[64:67], s49 offen offset:2688 lds
  s_add_u32 m0, s38, 71840
  s_add_u32 s49, s42, 995328
  buffer_load_dwordx4 v226, s[64:67], s49 offen offset:0 lds
  buffer_load_dwordx4 v227, s[64:67], s49 offen offset:896 lds
  buffer_load_dwordx4 v228, s[64:67], s49 offen offset:1792 lds
  buffer_load_dwordx4 v229, s[64:67], s49 offen offset:2688 lds
  s_add_u32 m0, s38, 86208
  s_add_u32 s49, s42, 1105920
  buffer_load_dwordx4 v226, s[64:67], s49 offen offset:0 lds
  buffer_load_dwordx4 v227, s[64:67], s49 offen offset:896 lds
  buffer_load_dwordx4 v228, s[64:67], s49 offen offset:1792 lds
  buffer_load_dwordx4 v229, s[64:67], s49 offen offset:2688 lds
  s_mov_b32 exec_hi, -1
  s_lshr_b32 s4, s7, 3
  s_lshl_b32 s4, s4, 1
  s_and_b32 s5, s3, 1
  s_add_u32 s4, s4, s5
  s_cmp_lt_u32 s4, 16
  s_cselect_b32 s5, 16, 56
  s_add_u32 s4, s4, s5
  s_mul_i32 s4, s4, 27648
  buffer_load_dword v92, v91, s[64:67], s4 offen
  s_waitcnt vmcnt(13)
  s_barrier
  s_lshr_b32 s4, s9, 2
  s_lshl_b32 s4, s4, 7
  s_and_b32 s5, s9, 3
  s_lshl_b32 s5, s5, 2
  s_add_u32 s4, s4, s5
  s_mul_i32 s5, s3, 3072
  s_add_u32 s4, s4, s5
  s_add_u32 s4, s4, 0x1805000
  s_mov_b64 exec, 1
  buffer_store_dword v255, off, s[60:63], s4 sc1
  s_mov_b64 exec, -1
H_nd2:
  s_waitcnt lgkmcnt(0)
  s_barrier
  ds_read_b64_tr_b16 a[0:1], v230 offset:0
  ds_read_b64_tr_b16 a[2:3], v230 offset:1792
  ds_read_b64_tr_b16 a[4:5], v230 offset:7184
  ds_read_b64_tr_b16 a[6:7], v230 offset:8976
  ds_read_b64_tr_b16 a[8:9], v231 offset:0
  ds_read_b64_tr_b16 a[10:11], v231 offset:1792
  ds_read_b64_tr_b16 a[12:13], v232 offset:0
  ds_read_b64_tr_b16 a[14:15], v233 offset:0
  ds_read_b64_tr_b16 a[16:17], v230 offset:14368
  ds_read_b64_tr_b16 a[18:19], v230 offset:16160
  ds_read_b64_tr_b16 a[20:21], v230 offset:21552
  ds_read_b64_tr_b16 a[22:23], v230 offset:23344
  ds_read_b64_tr_b16 a[24:25], v231 offset:14368
  ds_read_b64_tr_b16 a[26:27], v231 offset:16160
  ds_read_b64_tr_b16 a[28:29], v232 offset:14368
  ds_read_b64_tr_b16 a[30:31], v233 offset:14368
  ds_read_b64_tr_b16 a[32:33], v230 offset:28736
  ds_read_b64_tr_b16 a[34:35], v230 offset:30528
  ds_read_b64_tr_b16 a[36:37], v230 offset:35920
  ds_read_b64_tr_b16 a[38:39], v230 offset:37712
  ds_read_b64_tr_b16 a[40:41], v231 offset:28736
  ds_read_b64_tr_b16 a[42:43], v231 offset:30528
  ds_read_b64_tr_b16 a[44:45], v232 offset:28736
  ds_read_b64_tr_b16 a[46:47], v233 offset:28736
  ds_read_b64_tr_b16 a[48:49], v230 offset:43104
  ds_read_b64_tr_b16 a[50:51], v230 offset:44896
  ds_read_b64_tr_b16 a[52:53], v230 offset:50288
  ds_read_b64_tr_b16 a[54:55], v230 offset:52080
  ds_read_b64_tr_b16 a[56:57], v231 offset:43104
  ds_read_b64_tr_b16 a[58:59], v231 offset:44896
  ds_read_b64_tr_b16 a[60:61], v232 offset:43104
  ds_read_b64_tr_b16 a[62:63], v233 offset:43104
  s_waitcnt lgkmcnt(0)
  s_barrier
  s_mov_b32 exec_hi, 0xffffff
  s_add_u32 m0, s38, 0
  s_add_u32 s49, s42, 1216512
  buffer_load_dwordx4 v226, s[64:67], s49 offen offset:0 lds
  buffer_load_dwordx4 v227, s[64:67], s49 offen offset:896 lds
  buffer_load_dwordx4 v228, s[64:67], s49 offen offset:1792 lds
  buffer_load_dwordx4 v229, s[64:67], s49 offen offset:2688 lds
  s_add_u32 m0, s38, 14368
  s_add_u32 s49, s42, 1327104
  buffer_load_dwordx4 v226, s[64:67], s49 offen offset:0 lds
  buffer_load_dwordx4 v227, s[64:67], s49 offen offset:896 lds
  buffer_load_dwordx4 v228, s[64:67], s49 offen offset:1792 lds
  buffer_load_dwordx4 v229, s[64:67], s49 offen offset:2688 lds
  s_add_u32 m0, s38, 28736
  s_add_u32 s49, s42, 1437696
  buffer_load_dwordx4 v226, s[64:67], s49 offen offset:0 lds
  buffer_load_dwordx4 v227, s[64:67], s49 offen offset:896 lds
  buffer_load_dwordx4 v228, s[64:67], s49 offen offset:1792 lds
  buffer_load_dwordx4 v229, s[64:67], s49 offen offset:2688 lds
  s_add_u32 m0, s38, 43104
  s_add_u32 s49, s42, 1548288
  buffer_load_dwordx4 v226, s[64:67], s49 offen offset:0 lds
  buffer_load_dwordx4 v227, s[64:67], s49 offen offset:896 lds
  buffer_load_dwordx4 v228, s[64:67], s49 offen offset:1792 lds
  buffer_load_dwordx4 v229, s[64:67], s49 offen offset:2688 lds
  s_mov_b32 exec_hi, -1
  s_waitcnt vmcnt(16)
  s_barrier
  v_add_u32 v230, 0xe080, v230
  v_add_u32 v231, 0xe080, v231
  v_add_u32 v232, 0xe080, v232
  v_add_u32 v233, 0xe080, v233
  ds_read_b64_tr_b16 a[64:65], v230 offset:0
  ds_read_b64_tr_b16 a[66:67], v230 offset:1792
  ds_read_b64_tr_b16 a[68:69], v230 offset:7184
  ds_read_b64_tr_b16 a[70:71], v230 offset:8976
  ds_read_b64_tr_b16 a[72:73], v231 offset:0
  ds_read_b64_tr_b16 a[74:75], v231 offset:1792
  ds_read_b64_tr_b16 a[76:77], v232 offset:0
  ds_read_b64_tr_b16 a[78:79], v233 offset:0
  ds_read_b64_tr_b16 a[80:81], v230 offset:14368
  ds_read_b64_tr_b16 a[82:83], v230 offset:16160
  ds_read_b64_tr_b16 a[84:85], v230 offset:21552
  ds_read_b64_tr_b16 a[86:87], v230 offset:23344
  ds_read_b64_tr_b16 a[88:89], v231 offset:14368
  ds_read_b64_tr_b16 a[90:91], v231 offset:16160
  ds_read_b64_tr_b16 a[92:93], v232 offset:14368
  ds_read_b64_tr_b16 a[94:95], v233 offset:14368
  ds_read_b64_tr_b16 a[96:97], v230 offset:28736
  ds_read_b64_tr_b16 a[98:99], v230 offset:30528
  ds_read_b64_tr_b16 a[100:101], v230 offset:35920
  ds_read_b64_tr_b16 a[102:103], v230 offset:37712
  ds_read_b64_tr_b16 a[104:105], v231 offset:28736
  ds_read_b64_tr_b16 a[106:107], v231 offset:30528
  ds_read_b64_tr_b16 a[108:109], v232 offset:28736
  ds_read_b64_tr_b16 a[110:111], v233 offset:28736
  s_waitcnt lgkmcnt(0)
  s_barrier
  s_mov_b32 exec_hi, 0xffffff
  s_add_u32 m0, s38, 57472
  s_add_u32 s49, s42, 1658880
  buffer_load_dwordx4 v226, s[64:67], s49 offen offset:0 lds
  buffer_load_dwordx4 v227, s[64:67], s49 offen offset:896 lds
  buffer_load_dwordx4 v228, s[64:67], s49 offen offset:1792 lds
  buffer_load_dwordx4 v229, s[64:67], s49 offen offset:2688 lds
  s_add_u32 m0, s38, 71840
  s_add_u32 s49, s42, 1769472
  buffer_load_dwordx4 v226, s[64:67], s49 offen offset:0 lds
  buffer_load_dwordx4 v227, s[64:67], s49 offen offset:896 lds
  buffer_load_dwordx4 v228, s[64:67], s49 offen offset:1792 lds
  buffer_load_dwordx4 v229, s[64:67], s49 offen offset:2688 lds
  s_add_u32 m0, s38, 86208
  s_add_u32 s49, s42, 1880064
  buffer_load_dwordx4 v226, s[64:67], s49 offen offset:0 lds
  buffer_load_dwordx4 v227, s[64:67], s49 offen offset:896 lds
  buffer_load_dwordx4 v228, s[64:67], s49 offen offset:1792 lds
  buffer_load_dwordx4 v229, s[64:67], s49 offen offset:2688 lds
  s_mov_b32 exec_hi, -1
  s_waitcnt vmcnt(12)
  s_barrier
  v_add_u32 v230, 0xffff1f80, v230
  v_add_u32 v231, 0xffff1f80, v231
  v_add_u32 v232, 0xffff1f80, v232
  v_add_u32 v233, 0xffff1f80, v233
  ds_read_b64_tr_b16 a[112:113], v230 offset:0
  ds_read_b64_tr_b16 a[114:115], v230 offset:1792
  ds_read_b64_tr_b16 a[116:117], v230 offset:7184
  ds_read_b64_tr_b16 a[118:119], v230 offset:8976
  ds_read_b64_tr_b16 a[120:121], v231 offset:0
  ds_read_b64_tr_b16 a[122:123], v231 offset:1792
  ds_read_b64_tr_b16 a[124:125], v232 offset:0
  ds_read_b64_tr_b16 a[126:127], v233 offset:0
  ds_read_b64_tr_b16 a[128:129], v230 offset:14368
  ds_read_b64_tr_b16 a[130:131], v230 offset:16160
  ds_read_b64_tr_b16 a[132:133], v230 offset:21552
  ds_read_b64_tr_b16 a[134:135], v230 offset:23344
  ds_read_b64_tr_b16 a[136:137], v231 offset:14368
  ds_read_b64_tr_b16 a[138:139], v231 offset:16160
  ds_read_b64_tr_b16 a[140:141], v232 offset:14368
  ds_read_b64_tr_b16 a[142:143], v233 offset:14368
  ds_read_b64_tr_b16 a[144:145], v230 offset:28736
  ds_read_b64_tr_b16 a[146:147], v230 offset:30528
  ds_read_b64_tr_b16 a[148:149], v230 offset:35920
  ds_read_b64_tr_b16 a[150:151], v230 offset:37712
  ds_read_b64_tr_b16 a[152:153], v231 offset:28736
  ds_read_b64_tr_b16 a[154:155], v231 offset:30528
  ds_read_b64_tr_b16 a[156:157], v232 offset:28736
  ds_read_b64_tr_b16 a[158:159], v233 offset:28736
  ds_read_b64_tr_b16 a[160:161], v230 offset:43104
  ds_read_b64_tr_b16 a[162:163], v230 offset:44896
  ds_read_b64_tr_b16 a[164:165], v230 offset:50288
  ds_read_b64_tr_b16 a[166:167], v230 offset:52080
  ds_read_b64_tr_b16 a[168:169], v231 offset:43104
  ds_read_b64_tr_b16 a[170:171], v231 offset:44896
  ds_read_b64_tr_b16 a[172:173], v232 offset:43104
  ds_read_b64_tr_b16 a[174:175], v233 offset:43104
  s_and_b32 s58, s2, 3
  s_mul_i32 s58, s58, 3072
  s_add_u32 s58, s58, 0x1805000
  v_min_u32 v96, 39, v1
  v_lshrrev_b32 v2, 1, v96
  v_and_b32 v96, 1, v96
  v_lshlrev_b32 v96, 3, v96
  v_lshl_add_u32 v96, v2, 7, v96
  s_waitcnt lgkmcnt(0)
  s_barrier
  s_mov_b32 exec_hi, 0xffffff
  s_add_u32 m0, s38, 14368
  s_add_u32 s49, s42, 442368
  buffer_load_dwordx4 v226, s[64:67], s49 offen offset:0 lds
  buffer_load_dwordx4 v227, s[64:67], s49 offen offset:896 lds
  buffer_load_dwordx4 v228, s[64:67], s49 offen offset:1792 lds
  buffer_load_dwordx4 v229, s[64:67], s49 offen offset:2688 lds
  s_add_u32 m0, s38, 28736
  s_add_u32 s49, s42, 552960
  buffer_load_dwordx4 v226, s[64:67], s49 offen offset:0 lds
  buffer_load_dwordx4 v227, s[64:67], s49 offen offset:896 lds
  buffer_load_dwordx4 v228, s[64:67], s49 offen offset:1792 lds
  buffer_load_dwordx4 v229, s[64:67], s49 offen offset:2688 lds
  s_add_u32 m0, s38, 43104
  s_add_u32 s49, s42, 663552
  buffer_load_dwordx4 v226, s[64:67], s49 offen offset:0 lds
  buffer_load_dwordx4 v227, s[64:67], s49 offen offset:896 lds
  buffer_load_dwordx4 v228, s[64:67], s49 offen offset:1792 lds
  buffer_load_dwordx4 v229, s[64:67], s49 offen offset:2688 lds
  s_mov_b32 exec_hi, -1
  buffer_load_dwordx2 v[94:95], v96, s[60:63], s58 offen offset:0 sc1
  s_waitcnt vmcnt(13)
  s_barrier
  v_add_u32 v230, 0xe080, v230
  v_add_u32 v231, 0xe080, v231
  v_add_u32 v232, 0xe080, v232
  v_add_u32 v233, 0xe080, v233
  ds_read_b64_tr_b16 a[176:177], v230 offset:0
  ds_read_b64_tr_b16 a[178:179], v230 offset:1792
  ds_read_b64_tr_b16 a[180:181], v230 offset:7184
  ds_read_b64_tr_b16 a[182:183], v230 offset:8976
  ds_read_b64_tr_b16 a[184:185], v231 offset:0
  ds_read_b64_tr_b16 a[186:187], v231 offset:1792
  ds_read_b64_tr_b16 a[188:189], v232 offset:0
  ds_read_b64_tr_b16 a[190:191], v233 offset:0
  ds_read_b64_tr_b16 a[192:193], v230 offset:14368
  ds_read_b64_tr_b16 a[194:195], v230 offset:16160
  ds_read_b64_tr_b16 a[196:197], v230 offset:21552
  ds_read_b64_tr_b16 a[198:199], v230 offset:23344
  ds_read_b64_tr_b16 a[200:201], v231 offset:14368
  ds_read_b64_tr_b16 a[202:203], v231 offset:16160
  ds_read_b64_tr_b16 a[204:205], v232 offset:14368
  ds_read_b64_tr_b16 a[206:207], v233 offset:14368
  ds_read_b64_tr_b16 a[208:209], v230 offset:28736
  ds_read_b64_tr_b16 a[210:211], v230 offset:30528
  ds_read_b64_tr_b16 a[212:213], v230 offset:35920
  ds_read_b64_tr_b16 a[214:215], v230 offset:37712
  ds_read_b64_tr_b16 a[216:217], v231 offset:28736
  ds_read_b64_tr_b16 a[218:219], v231 offset:30528
  ds_read_b64_tr_b16 a[220:221], v232 offset:28736
  ds_read_b64_tr_b16 a[222:223], v233 offset:28736
  v_add_u32 v230, 0xffff1f80, v230
  v_add_u32 v231, 0xffff1f80, v231
  v_add_u32 v232, 0xffff1f80, v232
  v_add_u32 v233, 0xffff1f80, v233
  s_waitcnt lgkmcnt(0)
  s_barrier
  s_mov_b32 exec_hi, 0xffffff
  s_add_u32 m0, s38, 57472
  s_add_u32 s49, s42, 774144
  buffer_load_dwordx4 v226, s[64:67], s49 offen offset:0 lds
  buffer_load_dwordx4 v227, s[64:67], s49 offen offset:896 lds
  buffer_load_dwordx4 v228, s[64:67], s49 offen offset:1792 lds
  buffer_load_dwordx4 v229, s[64:67], s49 offen offset:2688 lds
  s_add_u32 m0, s38, 71840
  s_add_u32 s49, s42, 1990656
  buffer_load_dwordx4 v226, s[64:67], s49 offen offset:0 lds
  buffer_load_dwordx4 v227, s[64:67], s49 offen offset:896 lds
  buffer_load_dwordx4 v228, s[64:67], s49 offen offset:1792 lds
  buffer_load_dwordx4 v229, s[64:67], s49 offen offset:2688 lds
  s_add_u32 m0, s38, 86208
  s_add_u32 s49, s42, 2101248
  buffer_load_dwordx4 v226, s[64:67], s49 offen offset:0 lds
  buffer_load_dwordx4 v227, s[64:67], s49 offen offset:896 lds
  buffer_load_dwordx4 v228, s[64:67], s49 offen offset:1792 lds
  buffer_load_dwordx4 v229, s[64:67], s49 offen offset:2688 lds
  s_mov_b32 exec_hi, -1
  s_waitcnt vmcnt(12)
  v_cmp_ne_u64 vcc, s[100:101], v[94:95]
  s_cbranch_vccz HD_ok
  s_mov_b32 s11, 20000
  buffer_load_dwordx2 v[94:95], v96, s[60:63], s58 offen offset:0 sc1
HD_spin:
  s_waitcnt vmcnt(0)
  v_cmp_ne_u64 vcc, s[100:101], v[94:95]
  s_cbranch_vccz HD_done
  buffer_load_dwordx2 v[94:95], v96, s[60:63], s58 offen offset:0 sc1
  s_sub_u32 s11, s11, 1
  s_cbranch_scc0 HD_spin
  s_waitcnt vmcnt(0)
HD_done:
HD_ok:
  s_lshr_b32 s6, s2, 3
  s_lshl_b32 s6, s6, 2
  s_add_u32 s6, s6, s3
  s_mul_i32 s68, s6, 8960
  s_bfe_u32 s5, s2, 65537
  s_mul_i32 s5, s5, 1146880
  s_add_u32 s68, s68, s5
  s_add_u32 s68, s68, 0xd0007c
  v_min_u32 v134, 34, v1
  v_lshlrev_b32 v134, 8, v134
  buffer_load_dwordx2 v[136:137], v134, s[60:63], s68 offen
  s_cmp_lg_u32 s16, 5
  s_cbranch_scc1 H_end
  v_mov_b32 v208, 0x3f803f80
  v_mov_b32 v209, 0x3f803f80
  v_mov_b32 v210, 0x3f803f80
  v_mov_b32 v211, 0x3f803f80
  s_nop 1
  v_mfma_f32_16x16x32_bf16 v[212:215], a[0:3], v[208:211], 0
  v_mfma_f32_16x16x32_bf16 v[216:219], a[4:7], v[208:211], 0
  v_mfma_f32_16x16x32_bf16 v[220:223], a[8:11], v[208:211], 0
  v_mfma_f32_16x16x32_bf16 v[236:239], a[12:15], v[208:211], 0
  v_mfma_f32_16x16x32_bf16 v[212:215], a[16:19], v[208:211], v[212:215]
  v_mfma_f32_16x16x32_bf16 v[216:219], a[20:23], v[208:211], v[216:219]
  v_mfma_f32_16x16x32_bf16 v[220:223], a[24:27], v[208:211], v[220:223]
  v_mfma_f32_16x16x32_bf16 v[236:239], a[28:31], v[208:211], v[236:239]
  v_mfma_f32_16x16x32_bf16 v[212:215], a[32:35], v[208:211], v[212:215]
  v_mfma_f32_16x16x32_bf16 v[216:219], a[36:39], v[208:211], v[216:219]
  v_mfma_f32_16x16x32_bf16 v[220:223], a[40:43], v[208:211], v[220:223]
  v_mfma_f32_16x16x32_bf16 v[236:239], a[44:47], v[208:211], v[236:239]
  v_mfma_f32_16x16x32_bf16 v[212:215], a[48:51], v[208:211], v[212:215]
  v_mfma_f32_16x16x32_bf16 v[216:219], a[52:55], v[208:211], v[216:219]
  v_mfma_f32_16x16x32_bf16 v[220:223], a[56:59], v[208:211], v[220:223]
  v_mfma_f32_16x16x32_bf16 v[236:239], a[60:63], v[208:211], v[236:239]
  v_mfma_f32_16x16x32_bf16 v[212:215], a[64:67], v[208:211], v[212:215]
  v_mfma_f32_16x16x32_bf16 v[216:219], a[68:71], v[208:211], v[216:219]
  v_mfma_f32_16x16x32_bf16 v[220:223], a[72:75], v[208:211], v[220:223]
  v_mfma_f32_16x16x32_bf16 v[236:239], a[76:79], v[208:211], v[236:239]
  v_mfma_f32_16x16x32_bf16 v[212:215], a[80:83], v[208:211], v[212:215]
  v_mfma_f32_16x16x32_bf16 v[216:219], a[84:87], v[208:211], v[216:219]
  v_mfma_f32_16x16x32_bf16 v[220:223], a[88:91], v[208:211], v[220:223]
  v_mfma_f32_16x16x32_bf16 v[236:239], a[92:95], v[208:211], v[236:239]
  v_mfma_f32_16x16x32_bf16 v[212:215], a[96:99], v[208:211], v[212:215]
  v_mfma_f32_16x16x32_bf16 v[216:219], a[100:103], v[208:211], v[216:219]
  v_mfma_f32_16x16x32_bf16 v[220:223], a[104:107], v[208:211], v[220:223]
  v_mfma_f32_16x16x32_bf16 v[236:239], a[108:111], v[208:211], v[236:239]
  v_mfma_f32_16x16x32_bf16 v[212:215], a[112:115], v[208:211], v[212:215]
  v_mfma_f32_16x16x32_bf16 v[216:219], a[116:119], v[208:211], v[216:219]
  v_mfma_f32_16x16x32_bf16 v[220:223], a[120:123], v[208:211], v[220:223]
  v_mfma_f32_16x16x32_bf16 v[236:239], a[124:127], v[208:211], v[236:239]
  v_mfma_f32_16x16x32_bf16 v[212:215], a[128:131], v[208:211], v[212:215]
  v_mfma_f32_16x16x32_bf16 v[216:219], a[132:135], v[208:211], v[216:219]
  v_mfma_f32_16x16x32_bf16 v[220:223], a[136:139], v[208:211], v[220:223]
  v_mfma_f32_16x16x32_bf16 v[236:239], a[140:143], v[208:211], v[236:239]
  v_mfma_f32_16x16x32_bf16 v[212:215], a[144:147], v[208:211], v[212:215]
  v_mfma_f32_16x16x32_bf16 v[216:219], a[148:151], v[208:211], v[216:219]
  v_mfma_f32_16x16x32_bf16 v[220:223], a[152:155], v[208:211], v[220:223]
  v_mfma_f32_16x16x32_bf16 v[236:239], a[156:159], v[208:211], v[236:239]
  v_mfma_f32_16x16x32_bf16 v[212:215], a[160:163], v[208:211], v[212:215]
  v_mfma_f32_16x16x32_bf16 v[216:219], a[164:167], v[208:211], v[216:219]
  v_mfma_f32_16x16x32_bf16 v[220:223], a[168:171], v[208:211], v[220:223]
  v_mfma_f32_16x16x32_bf16 v[236:239], a[172:175], v[208:211], v[236:239]
  v_mfma_f32_16x16x32_bf16 v[212:215], a[176:179], v[208:211], v[212:215]
  v_mfma_f32_16x16x32_bf16 v[216:219], a[180:183], v[208:211], v[216:219]
  v_mfma_f32_16x16x32_bf16 v[220:223], a[184:187], v[208:211], v[220:223]
  v_mfma_f32_16x16x32_bf16 v[236:239], a[188:191], v[208:211], v[236:239]
  v_mfma_f32_16x16x32_bf16 v[212:215], a[192:195], v[208:211], v[212:215]
  v_mfma_f32_16x16x32_bf16 v[216:219], a[196:199], v[208:211], v[216:219]
  v_mfma_f32_16x16x32_bf16 v[220:223], a[200:203], v[208:211], v[220:223]
  v_mfma_f32_16x16x32_bf16 v[236:239], a[204:207], v[208:211], v[236:239]
  v_mfma_f32_16x16x32_bf16 v[212:215], a[208:211], v[208:211], v[212:215]
  v_mfma_f32_16x16x32_bf16 v[216:219], a[212:215], v[208:211], v[216:219]
  v_mfma_f32_16x16x32_bf16 v[220:223], a[216:219], v[208:211], v[220:223]
  v_mfma_f32_16x16x32_bf16 v[236:239], a[220:223], v[208:211], v[236:239]
  s_waitcnt vmcnt(1)
  s_barrier
  v_add_u32 v16, 0x3820, v230
  v_add_u32 v17, 0x3820, v231
  v_add_u32 v18, 0x3820, v232
  v_add_u32 v19, 0x3820, v233
  ds_read_b64_tr_b16 v[144:145], v16 offset:0
  ds_read_b64_tr_b16 v[146:147], v16 offset:1792
  ds_read_b64_tr_b16 v[148:149], v16 offset:7184
  ds_read_b64_tr_b16 v[150:151], v16 offset:8976
  ds_read_b64_tr_b16 v[152:153], v17 offset:0
  ds_read_b64_tr_b16 v[154:155], v17 offset:1792
  ds_read_b64_tr_b16 v[156:157], v18 offset:0
  ds_read_b64_tr_b16 v[158:159], v19 offset:0
  ds_read_b64_tr_b16 v[160:161], v16 offset:14368
  ds_read_b64_tr_b16 v[162:163], v16 offset:16160
  ds_read_b64_tr_b16 v[164:165], v16 offset:21552
  ds_read_b64_tr_b16 v[166:167], v16 offset:23344
  ds_read_b64_tr_b16 v[168:169], v17 offset:14368
  ds_read_b64_tr_b16 v[170:171], v17 offset:16160
  ds_read_b64_tr_b16 v[172:173], v18 offset:14368
  ds_read_b64_tr_b16 v[174:175], v19 offset:14368
  ds_read_b64_tr_b16 v[176:177], v16 offset:28736
  ds_read_b64_tr_b16 v[178:179], v16 offset:30528
  ds_read_b64_tr_b16 v[180:181], v16 offset:35920
  ds_read_b64_tr_b16 v[182:183], v16 offset:37712
  ds_read_b64_tr_b16 v[184:185], v17 offset:28736
  ds_read_b64_tr_b16 v[186:187], v17 offset:30528
  ds_read_b64_tr_b16 v[188:189], v18 offset:28736
  ds_read_b64_tr_b16 v[190:191], v19 offset:28736
  ds_read_b64_tr_b16 v[192:193], v16 offset:43104
  ds_read_b64_tr_b16 v[194:195], v16 offset:44896
  ds_read_b64_tr_b16 v[196:197], v16 offset:50288
  ds_read_b64_tr_b16 v[198:199], v16 offset:52080
  ds_read_b64_tr_b16 v[200:201], v17 offset:43104
  ds_read_b64_tr_b16 v[202:203], v17 offset:44896
  ds_read_b64_tr_b16 v[204:205], v18 offset:43104
  ds_read_b64_tr_b16 v[206:207], v19 offset:43104
  v_add_u32 v16, 0xe080, v16
  v_add_u32 v17, 0xe080, v17
  v_add_u32 v18, 0xe080, v18
  v_add_u32 v19, 0xe080, v19
  ds_read_b64_tr_b16 a[224:225], v16 offset:0
  ds_read_b64_tr_b16 a[226:227], v16 offset:1792
  ds_read_b64_tr_b16 a[228:229], v16 offset:7184
  ds_read_b64_tr_b16 a[230:231], v16 offset:8976
  ds_read_b64_tr_b16 a[232:233], v17 offset:0
  ds_read_b64_tr_b16 a[234:235], v17 offset:1792
  ds_read_b64_tr_b16 a[236:237], v18 offset:0
  ds_read_b64_tr_b16 a[238:239], v19 offset:0
  ds_read_b64_tr_b16 a[240:241], v16 offset:14368
  ds_read_b64_tr_b16 a[242:243], v16 offset:16160
  ds_read_b64_tr_b16 a[244:245], v16 offset:21552
  ds_read_b64_tr_b16 a[246:247], v16 offset:23344
  ds_read_b64_tr_b16 a[248:249], v17 offset:14368
  ds_read_b64_tr_b16 a[250:251], v17 offset:16160
  ds_read_b64_tr_b16 a[252:253], v18 offset:14368
  ds_read_b64_tr_b16 a[254:255], v19 offset:14368
  s_mul_i32 s4, s17, 896
  s_add_u32 s4, s4, 0x790000
  s_lshl_b32 s32, s18, 6
  s_add_u32 s32, s32, s4
  s_lshl_b32 s33, s31, 6
  s_add_u32 s33, s33, s4
  s_waitcnt lgkmcnt(15)
  v_mfma_f32_16x16x32_bf16 v[212:215], v[144:147], v[208:211], v[212:215]
  v_mfma_f32_16x16x32_bf16 v[216:219], v[148:151], v[208:211], v[216:219]
  v_mfma_f32_16x16x32_bf16 v[220:223], v[152:155], v[208:211], v[220:223]
  v_mfma_f32_16x16x32_bf16 v[236:239], v[156:159], v[208:211], v[236:239]
  v_mfma_f32_16x16x32_bf16 v[212:215], v[160:163], v[208:211], v[212:215]
  v_mfma_f32_16x16x32_bf16 v[216:219], v[164:167], v[208:211], v[216:219]
  v_mfma_f32_16x16x32_bf16 v[220:223], v[168:171], v[208:211], v[220:223]
  v_mfma_f32_16x16x32_bf16 v[236:239], v[172:175], v[208:211], v[236:239]
  v_mfma_f32_16x16x32_bf16 v[212:215], v[176:179], v[208:211], v[212:215]
  v_mfma_f32_16x16x32_bf16 v[216:219], v[180:183], v[208:211], v[216:219]
  v_mfma_f32_16x16x32_bf16 v[220:223], v[184:187], v[208:211], v[220:223]
  v_mfma_f32_16x16x32_bf16 v[236:239], v[188:191], v[208:211], v[236:239]
  v_mfma_f32_16x16x32_bf16 v[212:215], v[192:195], v[208:211], v[212:215]
  v_mfma_f32_16x16x32_bf16 v[216:219], v[196:199], v[208:211], v[216:219]
  v_mfma_f32_16x16x32_bf16 v[220:223], v[200:203], v[208:211], v[220:223]
  v_mfma_f32_16x16x32_bf16 v[236:239], v[204:207], v[208:211], v[236:239]
  s_waitcnt lgkmcnt(14)
  v_mfma_f32_16x16x32_bf16 v[212:215], a[224:227], v[208:211], v[212:215]
  s_waitcnt lgkmcnt(12)
  v_mfma_f32_16x16x32_bf16 v[216:219], a[228:231], v[208:211], v[216:219]
  s_waitcnt lgkmcnt(10)
  v_mfma_f32_16x16x32_bf16 v[220:223], a[232:235], v[208:211], v[220:223]
  s_waitcnt lgkmcnt(8)
  v_mfma_f32_16x16x32_bf16 v[236:239], a[236:239], v[208:211], v[236:239]
  s_waitcnt lgkmcnt(6)
  v_mfma_f32_16x16x32_bf16 v[212:215], a[240:243], v[208:211], v[212:215]
  s_waitcnt lgkmcnt(4)
  v_mfma_f32_16x16x32_bf16 v[216:219], a[244:247], v[208:211], v[216:219]
  s_waitcnt lgkmcnt(2)
  v_mfma_f32_16x16x32_bf16 v[220:223], a[248:251], v[208:211], v[220:223]
  s_waitcnt lgkmcnt(0)
  v_mfma_f32_16x16x32_bf16 v[236:239], a[252:255], v[208:211], v[236:239]
  v_and_b32 v2, 15, v1
  v_cmp_eq_u32 vcc, 0, v2
  s_nop 0
  s_and_saveexec_b64 s[68:69], vcc
  buffer_store_dwordx4 v[212:215], v12, s[60:63], s32 offen offset:0 sc1
  buffer_store_dwordx4 v[216:219], v12, s[60:63], s32 offen offset:64 sc1
  buffer_store_dwordx4 v[220:223], v12, s[60:63], s32 offen offset:128 sc1
  s_nop 0
  buffer_store_dwordx4 v[236:239], v12, s[60:63], s33 offen offset:0 sc1
  s_mov_b64 exec, -1
H_end:
  s_mov_b32 s56, s36
  s_and_b32 s57, s37, 0xffff
  s_mov_b32 s58, 0x280000
  s_mov_b32 s59, 0x20000
  s_mul_i32 s4, s17, 896
  s_add_u32 s4, s4, 0x790000
  s_lshl_b32 s32, s18, 6
  s_add_u32 s32, s32, s4
  s_lshl_b32 s33, s31, 6
  s_add_u32 s33, s33, s4
  s_lshl_b32 s19, s3, 15
  s_lshl_b32 s4, s16, 8
  s_add_u32 s19, s19, s4
  s_add_u32 s19, s19, 0x500000
  s_lshl_b32 s20, s3, 11
  s_mov_b32 s36, s19
  s_lshl_b32 s40, s16, 9
  s_add_u32 s40, s40, 0x1818000
  s_lshr_b32 s5, s17, 2
  s_lshl_b32 s5, s5, 7
  s_add_u32 s41, s40, s5
  s_and_b32 s5, s17, 3
  s_lshl_b32 s5, s5, 2
  s_add_u32 s41, s41, s5
  s_and_b32 s5, s17, 3
  s_lshl_b32 s5, s5, 2
  s_add_u32 s5, s5, s3
  s_lshl_b32 s5, s5, 17
  s_add_u32 s5, s5, s4
  s_add_u32 s37, s5, 0x580000
  v_bfe_u32 v2, v1, 4, 2
  v_lshl_add_u32 v2, v2, 2, v5
  v_add_u32 v253, s20, v2
  v_lshrrev_b32 v2, 1, v1
  v_and_b32 v3, 1, v1
  v_lshlrev_b32 v3, 7, v3
  v_lshl_add_u32 v132, v2, 12, v3
  s_lshl_b32 s4, s16, 3
  s_lshl_b32 s5, s3, 1
  s_add_u32 s5, s5, s4
  s_mul_i32 s39, s5, 57344
  s_mul_i32 s5, s17, 3584
  s_add_u32 s39, s39, s5
  s_add_u32 s39, s39, 0x1000000
  s_bfe_u32 s13, s17, 65538
  s_lshr_b32 s14, s17, 3
  s_lshl_b32 s14, s14, 2
  s_and_b32 s4, s17, 3
  s_add_u32 s14, s14, s4
  s_and_b32 s4, s3, 1
  s_lshl_b32 s28, s4, 1
  s_lshr_b32 s5, s3, 1
  s_or_b32 s28, s28, s5
  s_lshl_b32 s15, s5, 2
  s_add_u32 s15, s15, s4
  s_lshl_b32 s4, s13, 1
  s_add_u32 s15, s15, s4
  s_mul_i32 s4, s14, 286720
  s_mul_i32 s5, s3, 14336
  s_add_u32 s4, s4, s5
  s_add_u32 s44, s4, 0xd00000
  s_add_u32 s45, s4, 0xd0e000
  s_add_u32 s46, s4, 0xd1c000
  s_add_u32 s47, s4, 0xd2a000
  s_add_u32 s48, s4, 0xd38000
  s_lshl_b32 s4, s16, 3
  s_lshl_b32 s6, s13, 1
  s_add_u32 s6, s6, s4
  s_mul_i32 s6, s6, 57344
  s_add_u32 s6, s6, s5
  s_add_u32 s24, s6, 0x1000000
  s_add_u32 s25, s6, 0x100e000
  s_add_u32 s26, s6, 0x1038000
  s_add_u32 s27, s6, 0x1046000
  s_and_b32 s5, s28, 2
  s_mul_i32 s6, s17, 3584
  s_add_u32 s6, s6, 0x1000000
  s_add_u32 s8, s4, s5
  s_mul_i32 s8, s8, 57344
  s_add_u32 s8, s8, s6
  s_xor_b32 s5, s5, 2
  s_add_u32 s9, s4, s5
  s_mul_i32 s9, s9, 57344
  s_add_u32 s9, s9, s6
  s_add_u32 s5, s4, s15
  s_mul_i32 s22, s5, 20480
  s_mul_i32 s6, s14, 160
  s_add_u32 s22, s22, s6
  s_lshl_b32 s29, s5, 9
  s_add_u32 s29, s29, 0x780000
  s_add_u32 s5, s4, s14
  s_lshl_b32 s30, s5, 9
  s_lshl_b32 s5, s13, 2
  s_add_u32 s5, s5, s3
  s_lshl_b32 s5, s5, 2
  s_add_u32 s30, s30, s5
  s_add_u32 s30, s30, 0x780000
  s_mov_b32 s21, 0
  s_lshl_b32 s23, s17, 7
  s_add_u32 s23, s23, 0x1814000
  s_mov_b32 s10, s44
  s_mul_i32 s7, s3, 15360
  s_add_u32 s7, s7, 2048
  v_add_u32 v128, 0x3820, v230
  v_add_u32 v129, 0x3820, v231
  v_add_u32 v130, 0x3820, v232
  v_add_u32 v131, 0x3820, v233
  s_add_u32 s12, s21, 1024
  s_cmp_ge_u32 s3, 2
  s_cselect_b32 s35, 0xffff0000, 0
  s_mov_b32 s34, 0
  v_lshrrev_b32 v208, 4, v1
  v_bfe_u32 v209, v1, 2, 2
  v_and_b32 v210, 15, v1
  s_and_b32 s5, s3, 1
  s_lshl_b32 s5, s5, 2
  v_or_b32 v2, s5, v208
  v_bfe_u32 v3, v1, 1, 3
  v_xor_b32 v2, v2, v3
  v_lshlrev_b32 v2, 5, v2
  v_and_b32 v3, 1, v1
  v_lshl_add_u32 v2, v3, 4, v2
  v_lshl_add_u32 v6, v208, 12, v2
  v_add_u32 v13, 15360, v6
  v_and_b32 v2, 1, v208
  v_lshl_or_b32 v2, v2, 2, v209
  v_lshl_add_u32 v3, v208, 3, v209
  v_lshlrev_b32 v3, 8, v3
  v_and_b32 v4, 3, v1
  v_lshl_add_u32 v3, v4, 3, v3
  v_xor_b32 v211, s14, v2
  v_lshl_add_u32 v250, v211, 5, v3
  s_lshl_b32 s4, s3, 14
  s_add_u32 s4, s4, 90112
  s_mul_i32 s5, s3, 24576
  s_cmp_eq_u32 s13, 0
  s_cselect_b32 s4, s5, s4
  v_add_u32 v250, s4, v250
  v_xor_b32 v2, s28, v2
  v_xor_b32 v240, 0, v2
  v_lshl_add_u32 v240, v240, 5, v3
  v_xor_b32 v241, 1, v2
  v_lshl_add_u32 v241, v241, 5, v3
  v_xor_b32 v242, 2, v2
  v_lshl_add_u32 v242, v242, 5, v3
  v_xor_b32 v243, 3, v2
  v_lshl_add_u32 v243, v243, 5, v3
  v_xor_b32 v244, 4, v2
  v_lshl_add_u32 v244, v244, 5, v3
  v_xor_b32 v245, 5, v2
  v_lshl_add_u32 v245, v245, 5, v3
  v_xor_b32 v246, 6, v2
  v_lshl_add_u32 v246, v246, 5, v3
  v_xor_b32 v247, 7, v2
  v_lshl_add_u32 v247, v247, 5, v3
  v_cmp_eq_u32 s[50:51], 1, v4
  v_cmp_eq_u32 s[52:53], 2, v4
  v_cmp_eq_u32 s[54:55], 3, v4
  v_lshlrev_b32 v2, 5, v210
  v_cmp_eq_u32 vcc, v209, v208
  v_mov_b32 v3, 0x7f000000
  s_nop 0
  v_cndmask_b32 v251, v3, v2, vcc
  v_lshrrev_b32 v2, 1, v208
  v_lshl_or_b32 v2, v2, 2, v209
  v_xor_b32 v2, s15, v2
  v_lshlrev_b32 v2, 5, v2
  v_lshl_add_u32 v2, v4, 3, v2
  v_lshl_add_u32 v3, v208, 2, v209
  v_lshl_add_u32 v2, v3, 8, v2
  s_mul_i32 s6, s14, 20480
  v_add_u32 v11, s6, v2
  s_lshl_b32 s4, s28, 2
  s_add_u32 s4, s4, s21
  v_lshl_add_u32 v10, v210, 5, s4
  s_and_b32 s4, s28, 1
  v_and_b32 v2, 1, v208
  v_lshrrev_b32 v4, 1, v208
  v_xor_b32 v211, s4, v2
  v_mul_u32_u24 v211, 57344, v211
  v_lshl_add_u32 v211, v210, 4, v211
  v_add_u32 v3, s18, v4
  v_lshl_add_u32 v7, v3, 8, v211
  s_add_u32 s5, s18, 2
  s_sub_u32 s6, s31, s5
  v_mul_lo_u32 v3, s6, v4
  v_add_u32 v3, s5, v3
  v_lshl_add_u32 v8, v3, 8, v211
  v_xor_b32 v211, s4, v4
  v_mul_u32_u24 v211, 57344, v211
  v_lshl_add_u32 v211, v210, 4, v211
  v_lshl_add_u32 v211, v2, 3, v211
  s_lshl_b32 s5, s5, 8
  v_add_u32 v9, s5, v211
  v_mul_u32_u24 v3, 1280, v210
  v_lshl_add_u32 v3, v2, 5, v3
  v_lshl_add_u32 v248, v4, 4, v3
  v_and_b32 v3, 3, v1
  v_lshlrev_b32 v249, 2, v3
K_gemm:
  s_cmp_lg_u32 s3, 0
  s_cbranch_scc1 C2_skip
  s_and_b32 s6, s2, 3
  s_mul_i32 s6, s6, 8192
  s_add_u32 s6, s6, 0x1830000
  v_min_u32 v3, 39, v1
  v_lshrrev_b32 v4, 0, v3
  v_lshlrev_b32 v4, 7, v4
  v_and_b32 v3, 0, v3
  v_lshl_add_u32 v4, v3, 4, v4
  s_mov_b32 s11, 20000
  buffer_load_dwordx4 v[216:219], v4, s[60:63], s6 offen offset:0 sc1
C2_spin:
  s_waitcnt vmcnt(0)
  v_cmp_ne_u64 s[68:69], s[100:101], v[218:219]
  v_cmp_ne_u64 vcc, s[100:101], v[216:217]
  s_nop 0
  s_or_b64 vcc, vcc, s[68:69]
  s_cbranch_vccz C2_done
  buffer_load_dwordx4 v[216:219], v4, s[60:63], s6 offen offset:0 sc1
  s_sub_u32 s11, s11, 1
  s_cbranch_scc0 C2_spin
  s_waitcnt vmcnt(0)
C2_done:
C2_skip:
  s_cmp_lg_u32 s16, 5
  s_cbranch_scc1 CS_done
  s_lshl_b32 s4, s17, 7
  s_lshl_b32 s5, s3, 2
  s_add_u32 s4, s4, s5
  s_add_u32 s4, s4, 0x1814000
  s_waitcnt vmcnt(0)
  buffer_store_dword v255, off, s[60:63], s4 offset:0 sc1
CS_done:
  s_barrier
  s_add_u32 m0, s20, 0
  s_nop 0
  buffer_load_dwordx4 v6, s[60:63], s19 offen lds
  buffer_load_dwordx4 v13, s[60:63], s19 offen offset:1024 lds
  s_add_u32 s19, s19, 131072
  s_add_u32 m0, s20, 8192
  s_nop 0
  buffer_load_dwordx4 v6, s[60:63], s19 offen lds
  buffer_load_dwordx4 v13, s[60:63], s19 offen offset:1024 lds
  s_add_u32 s19, s19, 131072
  s_add_u32 m0, s20, 16384
  s_nop 0
  buffer_load_dwordx4 v6, s[60:63], s19 offen lds
  buffer_load_dwordx4 v13, s[60:63], s19 offen offset:1024 lds
  s_add_u32 s19, s19, 131072
  s_add_u32 m0, s20, 24576
  s_nop 0
  buffer_load_dwordx4 v6, s[60:63], s19 offen lds
  buffer_load_dwordx4 v13, s[60:63], s19 offen offset:1024 lds
  s_add_u32 s19, s19, 131072
  buffer_load_dword v133, v132, s[60:63], s37 offen
  s_cmp_lg_u32 s2, 0
  s_cbranch_scc1 EP_skip
  s_add_u32 s43, s43, 1
  v_mov_b32 v2, s43
  s_mov_b32 s4, 0x1820000
  s_mov_b64 exec, 1
  buffer_store_dword v2, off, s[60:63], s4 sc1
  s_mov_b64 exec, -1
EP_skip:
  s_waitcnt vmcnt(5)
  ds_read2st64_b32 v[138:139], v253 offset0:0 offset1:4
  ds_read2st64_b32 v[140:141], v253 offset0:32 offset1:36
  s_waitcnt lgkmcnt(1)
  v_max_u32 v252, v138, v139
  s_waitcnt lgkmcnt(0)
  v_max3_u32 v252, v252, v140, v141
  v_cmp_eq_u32 vcc, -1, v252
  s_cbranch_vccnz HV0_slow
HV0_back:
  s_barrier
  ds_read_b64_tr_b16 v[208:209], v240 offset:0
  ds_read_b64_tr_b16 v[210:211], v240 offset:1024
  ds_read_b64_tr_b16 v[212:213], v241 offset:0
  ds_read_b64_tr_b16 v[214:215], v241 offset:1024
  ds_read_b64_tr_b16 v[216:217], v242 offset:0
  ds_read_b64_tr_b16 v[218:219], v242 offset:1024
  ds_read_b64_tr_b16 v[220:221], v243 offset:0
  ds_read_b64_tr_b16 v[222:223], v243 offset:1024
  ds_read_b64_tr_b16 v[224:225], v244 offset:0
  ds_read_b64_tr_b16 v[226:227], v244 offset:1024
  ds_read_b64_tr_b16 v[228:229], v245 offset:0
  ds_read_b64_tr_b16 v[230:231], v245 offset:1024
  ds_read_b64_tr_b16 v[232:233], v246 offset:0
  ds_read_b64_tr_b16 v[234:235], v246 offset:1024
  ds_read_b64_tr_b16 v[236:237], v247 offset:0
  ds_read_b64_tr_b16 v[238:239], v247 offset:1024
  s_waitcnt lgkmcnt(14)
  v_mfma_f32_16x16x32_bf16 v[16:19], a[0:3], v[208:211], 0
  ds_read_b64_tr_b16 v[144:145], v128 offset:0
  ds_read_b64_tr_b16 v[146:147], v128 offset:1792
  v_mfma_f32_16x16x32_bf16 v[48:51], a[4:7], v[208:211], 0
  ds_read_b64_tr_b16 v[148:149], v128 offset:7184
  ds_read_b64_tr_b16 v[150:151], v128 offset:8976
  v_mfma_f32_16x16x32_bf16 v[80:83], a[8:11], v[208:211], 0
  ds_read_b64_tr_b16 v[152:153], v129 offset:0
  ds_read_b64_tr_b16 v[154:155], v129 offset:1792
  v_mfma_f32_16x16x32_bf16 v[112:115], a[12:15], v[208:211], 0
  s_waitcnt lgkmcnt(15)
  ds_read_b64_tr_b16 v[156:157], v130 offset:0
  ds_read_b64_tr_b16 v[158:159], v131 offset:0
  v_mfma_f32_16x16x32_bf16 v[20:23], a[0:3], v[212:215], 0
  ds_read_b64_tr_b16 v[208:209], v240 offset:8192
  ds_read_b64_tr_b16 v[160:161], v128 offset:14368
  v_mfma_f32_16x16x32_bf16 v[52:55], a[4:7], v[212:215], 0
  ds_read_b64_tr_b16 v[210:211], v240 offset:9216
  ds_read_b64_tr_b16 v[162:163], v128 offset:16160
  v_mfma_f32_16x16x32_bf16 v[84:87], a[8:11], v[212:215], 0
  ds_read_b64_tr_b16 v[164:165], v128 offset:21552
  ds_read_b64_tr_b16 v[166:167], v128 offset:23344
  v_mfma_f32_16x16x32_bf16 v[116:119], a[12:15], v[212:215], 0
  ds_read_b64_tr_b16 v[168:169], v129 offset:14368
  ds_read_b64_tr_b16 v[170:171], v129 offset:16160
  v_mfma_f32_16x16x32_bf16 v[24:27], a[0:3], v[216:219], 0
  ds_read_b64_tr_b16 v[212:213], v241 offset:8192
  ds_read_b64_tr_b16 v[172:173], v130 offset:14368
  v_mfma_f32_16x16x32_bf16 v[56:59], a[4:7], v[216:219], 0
  ds_read_b64_tr_b16 v[214:215], v241 offset:9216
  ds_read_b64_tr_b16 v[174:175], v131 offset:14368
  v_mfma_f32_16x16x32_bf16 v[88:91], a[8:11], v[216:219], 0
  s_waitcnt lgkmcnt(15)
  v_mfma_f32_16x16x32_bf16 v[28:31], a[0:3], v[220:223], 0
  ds_read_b64_tr_b16 v[216:217], v242 offset:8192
  v_mfma_f32_16x16x32_bf16 v[60:63], a[4:7], v[220:223], 0
  ds_read_b64_tr_b16 v[218:219], v242 offset:9216
  v_mfma_f32_16x16x32_bf16 v[92:95], a[8:11], v[220:223], 0
  v_mfma_f32_16x16x32_bf16 v[32:35], a[0:3], v[224:227], 0
  ds_read_b64_tr_b16 v[220:221], v243 offset:8192
  v_add_u32 v253, 16384, v253
  v_mfma_f32_16x16x32_bf16 v[64:67], a[4:7], v[224:227], 0
  ds_read_b64_tr_b16 v[222:223], v243 offset:9216
  v_mfma_f32_16x16x32_bf16 v[96:99], a[8:11], v[224:227], 0
  s_waitcnt vmcnt(3)
  ds_read2st64_b32 v[142:143], v253 offset0:0 offset1:4
  v_mfma_f32_16x16x32_bf16 v[120:123], a[12:15], v[224:227], 0
  v_mfma_f32_16x16x32_bf16 v[36:39], a[0:3], v[228:231], 0
  ds_read_b64_tr_b16 v[224:225], v244 offset:8192
  v_mfma_f32_16x16x32_bf16 v[68:71], a[4:7], v[228:231], 0
  s_waitcnt vmcnt(1)
  ds_read_b64_tr_b16 v[226:227], v244 offset:9216
  ds_read2st64_b32 v[138:139], v253 offset0:32 offset1:36
  v_mfma_f32_16x16x32_bf16 v[100:103], a[8:11], v[228:231], 0
  v_mfma_f32_16x16x32_bf16 v[124:127], a[12:15], v[228:231], 0
  v_mfma_f32_16x16x32_bf16 v[40:43], a[0:3], v[232:235], 0
  ds_read_b64_tr_b16 v[228:229], v245 offset:8192
  v_mfma_f32_16x16x32_bf16 v[72:75], a[4:7], v[232:235], 0
  s_waitcnt lgkmcnt(4)
  ds_read_b64_tr_b16 v[230:231], v245 offset:9216
  v_max_u32 v252, v142, v143
  v_mfma_f32_16x16x32_bf16 v[104:107], a[8:11], v[232:235], 0
  v_mfma_f32_16x16x32_bf16 v[44:47], a[0:3], v[236:239], 0
  ds_read_b64_tr_b16 v[232:233], v246 offset:8192
  v_mfma_f32_16x16x32_bf16 v[76:79], a[4:7], v[236:239], 0
  s_waitcnt lgkmcnt(3)
  ds_read_b64_tr_b16 v[234:235], v246 offset:9216
  v_max3_u32 v252, v252, v138, v139
  v_mfma_f32_16x16x32_bf16 v[108:111], a[8:11], v[236:239], 0
  v_cmp_eq_u32 vcc, -1, v252
  v_mfma_f32_16x16x32_bf16 v[16:19], a[16:19], v[208:211], v[16:19]
  s_cbranch_vccnz HV2_slow
HV2_back:
  ds_read_b64_tr_b16 v[236:237], v247 offset:8192
  v_mfma_f32_16x16x32_bf16 v[48:51], a[20:23], v[208:211], v[48:51]
  s_add_u32 m0, s20, 32768
  ds_read_b64_tr_b16 v[238:239], v247 offset:9216
  buffer_load_dwordx4 v6, s[60:63], s19 offen lds
  s_barrier
  v_mfma_f32_16x16x32_bf16 v[80:83], a[24:27], v[208:211], v[80:83]
  ds_read_b64_tr_b16 v[176:177], v128 offset:28736
  ds_read_b64_tr_b16 v[178:179], v128 offset:30528
  v_mfma_f32_16x16x32_bf16 v[112:115], a[28:31], v[208:211], v[112:115]
  ds_read_b64_tr_b16 v[180:181], v128 offset:35920
  ds_read_b64_tr_b16 v[182:183], v128 offset:37712
  v_mfma_f32_16x16x32_bf16 v[20:23], a[16:19], v[212:215], v[20:23]
  ds_read_b64_tr_b16 v[208:209], v240 offset:16384
  ds_read_b64_tr_b16 v[184:185], v129 offset:28736
  v_mfma_f32_16x16x32_bf16 v[52:55], a[20:23], v[212:215], v[52:55]
  ds_read_b64_tr_b16 v[210:211], v240 offset:17408
  buffer_load_dwordx4 v13, s[60:63], s19 offen offset:1024 lds
  v_mfma_f32_16x16x32_bf16 v[84:87], a[24:27], v[212:215], v[84:87]
  s_add_u32 s19, s19, 131072
  ds_read_b64_tr_b16 v[186:187], v129 offset:30528
  ds_read_b64_tr_b16 v[188:189], v130 offset:28736
  v_mfma_f32_16x16x32_bf16 v[116:119], a[28:31], v[212:215], v[116:119]
  ds_read_b64_tr_b16 v[190:191], v131 offset:28736
  ds_read_b64_tr_b16 v[192:193], v128 offset:43104
  v_mfma_f32_16x16x32_bf16 v[24:27], a[16:19], v[216:219], v[24:27]
  ds_read_b64_tr_b16 v[212:213], v241 offset:16384
  ds_read_b64_tr_b16 v[194:195], v128 offset:44896
  v_mfma_f32_16x16x32_bf16 v[56:59], a[20:23], v[216:219], v[56:59]
  ds_read_b64_tr_b16 v[214:215], v241 offset:17408
  ds_read_b64_tr_b16 v[196:197], v128 offset:50288
  v_mfma_f32_16x16x32_bf16 v[88:91], a[24:27], v[216:219], v[88:91]
  s_add_u32 m0, s20, 40960
  s_nop 0
  buffer_load_dwordx4 v6, s[60:63], s19 offen lds
  ds_read_b64_tr_b16 v[198:199], v128 offset:52080
  v_mfma_f32_16x16x32_bf16 v[28:31], a[16:19], v[220:223], v[28:31]
  ds_read_b64_tr_b16 v[216:217], v242 offset:16384
  ds_read_b64_tr_b16 v[200:201], v129 offset:43104
  v_mfma_f32_16x16x32_bf16 v[60:63], a[20:23], v[220:223], v[60:63]
  ds_read_b64_tr_b16 v[218:219], v242 offset:17408
  ds_read_b64_tr_b16 v[202:203], v129 offset:44896
  v_mfma_f32_16x16x32_bf16 v[92:95], a[24:27], v[220:223], v[92:95]
  ds_read_b64_tr_b16 v[204:205], v130 offset:43104
  ds_read_b64_tr_b16 v[206:207], v131 offset:43104
  v_mfma_f32_16x16x32_bf16 v[32:35], a[16:19], v[224:227], v[32:35]
  ds_read_b64_tr_b16 v[220:221], v243 offset:16384
  buffer_load_dwordx4 v13, s[60:63], s19 offen offset:1024 lds
  v_mfma_f32_16x16x32_bf16 v[64:67], a[20:23], v[224:227], v[64:67]
  s_add_u32 s19, s19, 131072
  ds_read_b64_tr_b16 v[222:223], v243 offset:17408
  v_add_u32 v128, 0xe080, v128
  v_mfma_f32_16x16x32_bf16 v[96:99], a[24:27], v[224:227], v[96:99]
  v_add_u32 v129, 0xe080, v129
  v_add_u32 v130, 0xe080, v130
  v_mfma_f32_16x16x32_bf16 v[120:123], a[28:31], v[224:227], v[120:123]
  s_waitcnt lgkmcnt(15)
  v_add_u32 v131, 0xe080, v131
  v_mfma_f32_16x16x32_bf16 v[36:39], a[16:19], v[228:231], v[36:39]
  ds_read_b64_tr_b16 v[224:225], v244 offset:16384
  ds_read_b64_tr_b16 a[224:225], v128 offset:0
  v_mfma_f32_16x16x32_bf16 v[68:71], a[20:23], v[228:231], v[68:71]
  s_add_u32 m0, s20, 49152
  ds_read_b64_tr_b16 v[226:227], v244 offset:17408
  buffer_load_dwordx4 v6, s[60:63], s19 offen lds
  v_mfma_f32_16x16x32_bf16 v[100:103], a[24:27], v[228:231], v[100:103]
  ds_read_b64_tr_b16 a[226:227], v128 offset:1792
  ds_read_b64_tr_b16 a[228:229], v128 offset:7184
  v_mfma_f32_16x16x32_bf16 v[124:127], a[28:31], v[228:231], v[124:127]
  ds_read_b64_tr_b16 a[230:231], v128 offset:8976
  ds_read_b64_tr_b16 a[232:233], v129 offset:0
  v_mfma_f32_16x16x32_bf16 v[40:43], a[16:19], v[232:235], v[40:43]
  ds_read_b64_tr_b16 v[228:229], v245 offset:16384
  ds_read_b64_tr_b16 a[234:235], v129 offset:1792
  v_mfma_f32_16x16x32_bf16 v[72:75], a[20:23], v[232:235], v[72:75]
  ds_read_b64_tr_b16 v[230:231], v245 offset:17408
  buffer_load_dwordx4 v13, s[60:63], s19 offen offset:1024 lds
  v_mfma_f32_16x16x32_bf16 v[104:107], a[24:27], v[232:235], v[104:107]
  s_add_u32 s19, s19, 131072
  ds_read_b64_tr_b16 a[236:237], v130 offset:0
  ds_read_b64_tr_b16 a[238:239], v131 offset:0
  v_mfma_f32_16x16x32_bf16 v[44:47], a[16:19], v[236:239], v[44:47]
  ds_read_b64_tr_b16 v[232:233], v246 offset:16384
  ds_read_b64_tr_b16 a[240:241], v128 offset:14368
  v_mfma_f32_16x16x32_bf16 v[76:79], a[20:23], v[236:239], v[76:79]
  ds_read_b64_tr_b16 v[234:235], v246 offset:17408
  ds_read_b64_tr_b16 a[242:243], v128 offset:16160
  v_mfma_f32_16x16x32_bf16 v[108:111], a[24:27], v[236:239], v[108:111]
  ds_read_b64_tr_b16 a[244:245], v128 offset:21552
  ds_read_b64_tr_b16 a[246:247], v128 offset:23344
  v_mfma_f32_16x16x32_bf16 v[16:19], a[32:35], v[208:211], v[16:19]
  s_add_u32 m0, s20, 57344
  ds_read_b64_tr_b16 v[236:237], v247 offset:16384
  buffer_load_dwordx4 v6, s[60:63], s19 offen lds
  v_mfma_f32_16x16x32_bf16 v[48:51], a[36:39], v[208:211], v[48:51]
  ds_read_b64_tr_b16 v[238:239], v247 offset:17408
  ds_read_b64_tr_b16 a[248:249], v129 offset:14368
  v_mfma_f32_16x16x32_bf16 v[80:83], a[40:43], v[208:211], v[80:83]
  ds_read_b64_tr_b16 a[250:251], v129 offset:16160
  ds_read_b64_tr_b16 a[252:253], v130 offset:14368
  v_mfma_f32_16x16x32_bf16 v[112:115], a[44:47], v[208:211], v[112:115]
  s_waitcnt lgkmcnt(15)
  ds_read_b64_tr_b16 a[254:255], v131 offset:14368
  v_mfma_f32_16x16x32_bf16 v[20:23], a[32:35], v[212:215], v[20:23]
  ds_read_b64_tr_b16 v[208:209], v240 offset:24576
  buffer_load_dwordx4 v13, s[60:63], s19 offen offset:1024 lds
  v_mfma_f32_16x16x32_bf16 v[52:55], a[36:39], v[212:215], v[52:55]
  s_add_u32 s19, s19, 131072
  ds_read_b64_tr_b16 v[210:211], v240 offset:25600
  v_mfma_f32_16x16x32_bf16 v[84:87], a[40:43], v[212:215], v[84:87]
  v_mfma_f32_16x16x32_bf16 v[116:119], a[44:47], v[212:215], v[116:119]
  v_mfma_f32_16x16x32_bf16 v[24:27], a[32:35], v[216:219], v[24:27]
  ds_read_b64_tr_b16 v[212:213], v241 offset:24576
  v_mfma_f32_16x16x32_bf16 v[56:59], a[36:39], v[216:219], v[56:59]
  s_add_u32 m0, s20, 65536
  ds_read_b64_tr_b16 v[214:215], v241 offset:25600
  buffer_load_dwordx4 v6, s[60:63], s19 offen lds
  v_mfma_f32_16x16x32_bf16 v[88:91], a[40:43], v[216:219], v[88:91]
  v_mfma_f32_16x16x32_bf16 v[28:31], a[32:35], v[220:223], v[28:31]
  ds_read_b64_tr_b16 v[216:217], v242 offset:24576
  v_add_u32 v253, 16384, v253
  v_mfma_f32_16x16x32_bf16 v[60:63], a[36:39], v[220:223], v[60:63]
  ds_read_b64_tr_b16 v[218:219], v242 offset:25600
  v_mfma_f32_16x16x32_bf16 v[92:95], a[40:43], v[220:223], v[92:95]
  s_waitcnt vmcnt(7)
  ds_read2st64_b32 v[140:141], v253 offset0:0 offset1:4
  buffer_load_dwordx4 v13, s[60:63], s19 offen offset:1024 lds
  v_mfma_f32_16x16x32_bf16 v[32:35], a[32:35], v[224:227], v[32:35]
  s_add_u32 s19, s19, 131072
  ds_read_b64_tr_b16 v[220:221], v243 offset:24576
  v_mfma_f32_16x16x32_bf16 v[64:67], a[36:39], v[224:227], v[64:67]
  ds_read_b64_tr_b16 v[222:223], v243 offset:25600
  v_mfma_f32_16x16x32_bf16 v[96:99], a[40:43], v[224:227], v[96:99]
  s_waitcnt vmcnt(6)
  ds_read2st64_b32 v[142:143], v253 offset0:32 offset1:36
  v_mfma_f32_16x16x32_bf16 v[120:123], a[44:47], v[224:227], v[120:123]
  s_waitcnt lgkmcnt(15)
  v_mfma_f32_16x16x32_bf16 v[36:39], a[32:35], v[228:231], v[36:39]
  s_add_u32 m0, s20, 73728
  ds_read_b64_tr_b16 v[224:225], v244 offset:24576
  buffer_load_dwordx4 v6, s[60:63], s19 offen lds
  v_mfma_f32_16x16x32_bf16 v[68:71], a[36:39], v[228:231], v[68:71]
  s_waitcnt vmcnt(5)
  ds_read_b64_tr_b16 v[226:227], v244 offset:25600
  ds_read2st64_b32 v[138:139], v253 offset0:64 offset1:68
  v_mfma_f32_16x16x32_bf16 v[100:103], a[40:43], v[228:231], v[100:103]
  s_waitcnt lgkmcnt(6)
  v_max_u32 v252, v140, v141
  v_mfma_f32_16x16x32_bf16 v[124:127], a[44:47], v[228:231], v[124:127]
  v_mfma_f32_16x16x32_bf16 v[40:43], a[32:35], v[232:235], v[40:43]
  ds_read_b64_tr_b16 v[228:229], v245 offset:24576
  buffer_load_dwordx4 v13, s[60:63], s19 offen offset:1024 lds
  v_mfma_f32_16x16x32_bf16 v[72:75], a[36:39], v[232:235], v[72:75]
  s_add_u32 s19, s19, 131072
  ds_read_b64_tr_b16 v[230:231], v245 offset:25600
  v_mfma_f32_16x16x32_bf16 v[104:107], a[40:43], v[232:235], v[104:107]
  s_waitcnt lgkmcnt(5)
  v_max3_u32 v252, v252, v142, v143
  v_mfma_f32_16x16x32_bf16 v[44:47], a[32:35], v[236:239], v[44:47]
  ds_read_b64_tr_b16 v[232:233], v246 offset:24576
  v_mfma_f32_16x16x32_bf16 v[76:79], a[36:39], v[236:239], v[76:79]
  s_waitcnt lgkmcnt(3)
  ds_read_b64_tr_b16 v[234:235], v246 offset:25600
  v_max3_u32 v252, v252, v138, v139
  v_mfma_f32_16x16x32_bf16 v[108:111], a[40:43], v[236:239], v[108:111]
  s_add_u32 m0, s20, 81920
  s_nop 0
  buffer_load_dwordx4 v6, s[60:63], s19 offen lds
  v_cmp_eq_u32 vcc, -1, v252
  v_mfma_f32_16x16x32_bf16 v[16:19], a[48:51], v[208:211], v[16:19]
  s_cbranch_vccnz HV4_slow
HV4_back:
  ds_read_b64_tr_b16 v[236:237], v247 offset:24576
  v_mfma_f32_16x16x32_bf16 v[48:51], a[52:55], v[208:211], v[48:51]
  ds_read_b64_tr_b16 v[238:239], v247 offset:25600
  s_barrier
  v_mfma_f32_16x16x32_bf16 v[80:83], a[56:59], v[208:211], v[80:83]
  v_mfma_f32_16x16x32_bf16 v[112:115], a[60:63], v[208:211], v[112:115]
  buffer_load_dwordx4 v13, s[60:63], s19 offen offset:1024 lds
  v_mfma_f32_16x16x32_bf16 v[20:23], a[48:51], v[212:215], v[20:23]
  s_add_u32 s19, s19, 131072
  ds_read_b64_tr_b16 v[208:209], v240 offset:32768
  v_mfma_f32_16x16x32_bf16 v[52:55], a[52:55], v[212:215], v[52:55]
  s_add_u32 m0, s20, 90112
  ds_read_b64_tr_b16 v[210:211], v240 offset:33792
  buffer_load_dwordx4 v6, s[60:63], s19 offen lds
  v_mfma_f32_16x16x32_bf16 v[84:87], a[56:59], v[212:215], v[84:87]
  buffer_load_dwordx4 v13, s[60:63], s19 offen offset:1024 lds
  v_mfma_f32_16x16x32_bf16 v[116:119], a[60:63], v[212:215], v[116:119]
  s_add_u32 s19, s19, 131072
  v_mfma_f32_16x16x32_bf16 v[24:27], a[48:51], v[216:219], v[24:27]
  ds_read_b64_tr_b16 v[212:213], v241 offset:32768
  v_mfma_f32_16x16x32_bf16 v[56:59], a[52:55], v[216:219], v[56:59]
  ds_read_b64_tr_b16 v[214:215], v241 offset:33792
  v_mfma_f32_16x16x32_bf16 v[88:91], a[56:59], v[216:219], v[88:91]
  s_add_u32 m0, s20, 98304
  s_nop 0
  buffer_load_dwordx4 v6, s[60:63], s19 offen lds
  v_mfma_f32_16x16x32_bf16 v[28:31], a[48:51], v[220:223], v[28:31]
  ds_read_b64_tr_b16 v[216:217], v242 offset:32768
  v_mfma_f32_16x16x32_bf16 v[60:63], a[52:55], v[220:223], v[60:63]
  ds_read_b64_tr_b16 v[218:219], v242 offset:33792
  v_mfma_f32_16x16x32_bf16 v[92:95], a[56:59], v[220:223], v[92:95]
  buffer_load_dwordx4 v13, s[60:63], s19 offen offset:1024 lds
  v_mfma_f32_16x16x32_bf16 v[32:35], a[48:51], v[224:227], v[32:35]
  s_add_u32 s19, s19, 131072
  ds_read_b64_tr_b16 v[220:221], v243 offset:32768
  v_mfma_f32_16x16x32_bf16 v[64:67], a[52:55], v[224:227], v[64:67]
  ds_read_b64_tr_b16 v[222:223], v243 offset:33792
  v_mfma_f32_16x16x32_bf16 v[96:99], a[56:59], v[224:227], v[96:99]
  v_mfma_f32_16x16x32_bf16 v[120:123], a[60:63], v[224:227], v[120:123]
  s_waitcnt lgkmcnt(12)
  s_add_u32 m0, s20, 106496
  s_nop 0
  buffer_load_dwordx4 v6, s[60:63], s19 offen lds
  v_mfma_f32_16x16x32_bf16 v[36:39], a[48:51], v[228:231], v[36:39]
  ds_read_b64_tr_b16 v[224:225], v244 offset:32768
  v_mfma_f32_16x16x32_bf16 v[68:71], a[52:55], v[228:231], v[68:71]
  ds_read_b64_tr_b16 v[226:227], v244 offset:33792
  v_mfma_f32_16x16x32_bf16 v[100:103], a[56:59], v[228:231], v[100:103]
  buffer_load_dwordx4 v13, s[60:63], s19 offen offset:1024 lds
  v_mfma_f32_16x16x32_bf16 v[124:127], a[60:63], v[228:231], v[124:127]
  s_waitcnt lgkmcnt(12)
  s_add_u32 s19, s19, 131072
  v_mfma_f32_16x16x32_bf16 v[40:43], a[48:51], v[232:235], v[40:43]
  ds_read_b64_tr_b16 v[228:229], v245 offset:32768
  v_mfma_f32_16x16x32_bf16 v[72:75], a[52:55], v[232:235], v[72:75]
  ds_read_b64_tr_b16 v[230:231], v245 offset:33792
  v_mfma_f32_16x16x32_bf16 v[104:107], a[56:59], v[232:235], v[104:107]
  s_waitcnt lgkmcnt(12)
  s_add_u32 m0, s20, 114688
  s_nop 0
  buffer_load_dwordx4 v6, s[60:63], s19 offen lds
  v_mfma_f32_16x16x32_bf16 v[44:47], a[48:51], v[236:239], v[44:47]
  ds_read_b64_tr_b16 v[232:233], v246 offset:32768
  v_mfma_f32_16x16x32_bf16 v[76:79], a[52:55], v[236:239], v[76:79]
  ds_read_b64_tr_b16 v[234:235], v246 offset:33792
  v_mfma_f32_16x16x32_bf16 v[108:111], a[56:59], v[236:239], v[108:111]
  s_waitcnt lgkmcnt(12)
  buffer_load_dwordx4 v13, s[60:63], s19 offen offset:1024 lds
  v_mfma_f32_16x16x32_bf16 v[16:19], v[144:147], v[208:211], v[16:19]
  s_add_u32 s19, s19, 131072
  ds_read_b64_tr_b16 v[236:237], v247 offset:32768
  v_mfma_f32_16x16x32_bf16 v[48:51], v[148:151], v[208:211], v[48:51]
  ds_read_b64_tr_b16 v[238:239], v247 offset:33792
  v_mfma_f32_16x16x32_bf16 v[80:83], v[152:155], v[208:211], v[80:83]
  v_mfma_f32_16x16x32_bf16 v[112:115], v[156:159], v[208:211], v[112:115]
  s_waitcnt lgkmcnt(12)
  s_add_u32 m0, s20, 122880
  s_nop 0
  buffer_load_dwordx4 v6, s[60:63], s19 offen lds
  v_mfma_f32_16x16x32_bf16 v[20:23], v[144:147], v[212:215], v[20:23]
  ds_read_b64_tr_b16 v[208:209], v240 offset:40960
  v_mfma_f32_16x16x32_bf16 v[52:55], v[148:151], v[212:215], v[52:55]
  ds_read_b64_tr_b16 v[210:211], v240 offset:41984
  v_add_u32 v253, 24576, v253
  v_mfma_f32_16x16x32_bf16 v[84:87], v[152:155], v[212:215], v[84:87]
  buffer_load_dwordx4 v13, s[60:63], s19 offen offset:1024 lds
  v_mfma_f32_16x16x32_bf16 v[116:119], v[156:159], v[212:215], v[116:119]
  s_waitcnt vmcnt(16)
  s_waitcnt lgkmcnt(12)
  ds_read2st64_b32 v[140:141], v253 offset0:0 offset1:4
  v_mfma_f32_16x16x32_bf16 v[24:27], v[144:147], v[216:219], v[24:27]
  s_add_u32 s19, s19, 131072
  ds_read_b64_tr_b16 v[212:213], v241 offset:40960
  v_mfma_f32_16x16x32_bf16 v[56:59], v[148:151], v[216:219], v[56:59]
  ds_read_b64_tr_b16 v[214:215], v241 offset:41984
  v_mfma_f32_16x16x32_bf16 v[88:91], v[152:155], v[216:219], v[88:91]
  s_waitcnt vmcnt(14)
  s_waitcnt lgkmcnt(13)
  ds_read2st64_b32 v[142:143], v253 offset0:32 offset1:36
  v_mfma_f32_16x16x32_bf16 v[28:31], v[144:147], v[220:223], v[28:31]
  s_add_u32 m0, s20, 131072
  ds_read_b64_tr_b16 v[216:217], v242 offset:40960
  buffer_load_dwordx4 v6, s[60:63], s19 offen lds
  v_mfma_f32_16x16x32_bf16 v[60:63], v[148:151], v[220:223], v[60:63]
  ds_read_b64_tr_b16 v[218:219], v242 offset:41984
  v_mfma_f32_16x16x32_bf16 v[92:95], v[152:155], v[220:223], v[92:95]
  s_waitcnt vmcnt(13)
  s_waitcnt lgkmcnt(14)
  ds_read2st64_b32 v[138:139], v253 offset0:64 offset1:68
  v_mfma_f32_16x16x32_bf16 v[32:35], v[144:147], v[224:227], v[32:35]
  ds_read_b64_tr_b16 v[220:221], v243 offset:40960
  buffer_load_dwordx4 v13, s[60:63], s19 offen offset:1024 lds
  v_mfma_f32_16x16x32_bf16 v[64:67], v[148:151], v[224:227], v[64:67]
  s_add_u32 s19, s19, 131072
  ds_read_b64_tr_b16 v[222:223], v243 offset:41984
  v_mfma_f32_16x16x32_bf16 v[96:99], v[152:155], v[224:227], v[96:99]
  s_waitcnt lgkmcnt(8)
  v_max_u32 v252, v140, v141
  v_mfma_f32_16x16x32_bf16 v[120:123], v[156:159], v[224:227], v[120:123]
  s_waitcnt vmcnt(12)
  ds_read2st64_b32 v[140:141], v253 offset0:96 offset1:100
  v_mfma_f32_16x16x32_bf16 v[36:39], v[144:147], v[228:231], v[36:39]
  s_add_u32 m0, s20, 139264
  ds_read_b64_tr_b16 v[224:225], v244 offset:40960
  buffer_load_dwordx4 v6, s[60:63], s19 offen lds
  v_mfma_f32_16x16x32_bf16 v[68:71], v[148:151], v[228:231], v[68:71]
  s_waitcnt lgkmcnt(7)
  ds_read_b64_tr_b16 v[226:227], v244 offset:41984
  v_max3_u32 v252, v252, v142, v143
  v_mfma_f32_16x16x32_bf16 v[100:103], v[152:155], v[228:231], v[100:103]
  s_waitcnt vmcnt(11)
  ds_read2st64_b32 v[142:143], v253 offset0:128 offset1:132
  buffer_load_dwordx4 v13, s[60:63], s19 offen offset:1024 lds
  v_mfma_f32_16x16x32_bf16 v[124:127], v[156:159], v[228:231], v[124:127]
  s_waitcnt lgkmcnt(6)
  s_add_u32 s19, s19, 131072
  v_max3_u32 v252, v252, v138, v139
  v_mfma_f32_16x16x32_bf16 v[40:43], v[144:147], v[232:235], v[40:43]
  ds_read_b64_tr_b16 v[228:229], v245 offset:40960
  v_mfma_f32_16x16x32_bf16 v[72:75], v[148:151], v[232:235], v[72:75]
  s_waitcnt lgkmcnt(4)
  ds_read_b64_tr_b16 v[230:231], v245 offset:41984
  v_max3_u32 v252, v252, v140, v141
  v_mfma_f32_16x16x32_bf16 v[104:107], v[152:155], v[232:235], v[104:107]
  s_add_u32 m0, s20, 147456
  s_nop 0
  buffer_load_dwordx4 v6, s[60:63], s19 offen lds
  v_mfma_f32_16x16x32_bf16 v[44:47], v[144:147], v[236:239], v[44:47]
  ds_read_b64_tr_b16 v[232:233], v246 offset:40960
  buffer_load_dword v254, v249, s[60:63], s23 offen offset:0 sc1
  v_mfma_f32_16x16x32_bf16 v[76:79], v[148:151], v[236:239], v[76:79]
  s_waitcnt lgkmcnt(3)
  ds_read_b64_tr_b16 v[234:235], v246 offset:41984
  v_max3_u32 v252, v252, v142, v143
  v_mfma_f32_16x16x32_bf16 v[108:111], v[152:155], v[236:239], v[108:111]
  buffer_load_dwordx4 v13, s[60:63], s19 offen offset:1024 lds
  v_cmp_eq_u32 vcc, -1, v252
  v_mfma_f32_16x16x32_bf16 v[16:19], v[160:163], v[208:211], v[16:19]
  s_cbranch_vccnz HV7_slow
HV7_back:
  s_add_u32 s19, s19, 131072
  ds_read_b64_tr_b16 v[236:237], v247 offset:40960
  v_mfma_f32_16x16x32_bf16 v[48:51], v[164:167], v[208:211], v[48:51]
  ds_read_b64_tr_b16 v[238:239], v247 offset:41984
  s_barrier
  v_mfma_f32_16x16x32_bf16 v[80:83], v[168:171], v[208:211], v[80:83]
  v_mfma_f32_16x16x32_bf16 v[112:115], v[172:175], v[208:211], v[112:115]
  s_add_u32 m0, s20, 155648
  s_nop 0
  buffer_load_dwordx4 v6, s[60:63], s19 offen lds
  v_mov_b32 v132, -1
  v_mfma_f32_16x16x32_bf16 v[20:23], v[160:163], v[212:215], v[20:23]
  ds_read_b64_tr_b16 v[208:209], v240 offset:49152
  v_mov_b32 v133, -1
  v_mfma_f32_16x16x32_bf16 v[52:55], v[164:167], v[212:215], v[52:55]
  ds_read_b64_tr_b16 v[210:211], v240 offset:50176
  v_mov_b32 v134, -1
  v_mfma_f32_16x16x32_bf16 v[84:87], v[168:171], v[212:215], v[84:87]
  buffer_load_dwordx4 v13, s[60:63], s19 offen offset:1024 lds
  v_mov_b32 v135, -1
  v_mfma_f32_16x16x32_bf16 v[116:119], v[172:175], v[212:215], v[116:119]
  s_add_u32 s19, s19, 131072
  v_mfma_f32_16x16x32_bf16 v[24:27], v[160:163], v[216:219], v[24:27]
  ds_read_b64_tr_b16 v[212:213], v241 offset:49152
  v_mfma_f32_16x16x32_bf16 v[56:59], v[164:167], v[216:219], v[56:59]
  ds_read_b64_tr_b16 v[214:215], v241 offset:50176
  v_mfma_f32_16x16x32_bf16 v[88:91], v[168:171], v[216:219], v[88:91]
  v_mfma_f32_16x16x32_bf16 v[28:31], v[160:163], v[220:223], v[28:31]
  ds_read_b64_tr_b16 v[216:217], v242 offset:49152
  buffer_store_dwordx4 v[132:135], v5, s[60:63], s39 offen offset:0 sc1
  v_mfma_f32_16x16x32_bf16 v[60:63], v[164:167], v[220:223], v[60:63]
  ds_read_b64_tr_b16 v[218:219], v242 offset:50176
  v_mfma_f32_16x16x32_bf16 v[92:95], v[168:171], v[220:223], v[92:95]
  v_mfma_f32_16x16x32_bf16 v[32:35], v[160:163], v[224:227], v[32:35]
  ds_read_b64_tr_b16 v[220:221], v243 offset:49152
  buffer_store_dwordx4 v[132:135], v5, s[60:63], s39 offen offset:1024 sc1
  v_mfma_f32_16x16x32_bf16 v[64:67], v[164:167], v[224:227], v[64:67]
  ds_read_b64_tr_b16 v[222:223], v243 offset:50176
  v_mfma_f32_16x16x32_bf16 v[96:99], v[168:171], v[224:227], v[96:99]
  v_mfma_f32_16x16x32_bf16 v[120:123], v[172:175], v[224:227], v[120:123]
  s_waitcnt lgkmcnt(12)
  buffer_store_dwordx4 v[132:135], v5, s[60:63], s39 offen offset:2048 sc1
  v_mfma_f32_16x16x32_bf16 v[36:39], v[160:163], v[228:231], v[36:39]
  ds_read_b64_tr_b16 v[224:225], v244 offset:49152
  v_mfma_f32_16x16x32_bf16 v[68:71], v[164:167], v[228:231], v[68:71]
  ds_read_b64_tr_b16 v[226:227], v244 offset:50176
  v_mfma_f32_16x16x32_bf16 v[100:103], v[168:171], v[228:231], v[100:103]
  buffer_store_dwordx4 v[132:135], v5, s[60:63], s39 offen offset:2560 sc1
  v_mfma_f32_16x16x32_bf16 v[124:127], v[172:175], v[228:231], v[124:127]
  s_waitcnt lgkmcnt(12)
  v_mfma_f32_16x16x32_bf16 v[40:43], v[160:163], v[232:235], v[40:43]
  ds_read_b64_tr_b16 v[228:229], v245 offset:49152
  v_mfma_f32_16x16x32_bf16 v[72:75], v[164:167], v[232:235], v[72:75]
  s_add_u32 s39, s39, 57344
  ds_read_b64_tr_b16 v[230:231], v245 offset:50176
  v_mfma_f32_16x16x32_bf16 v[104:107], v[168:171], v[232:235], v[104:107]
  s_waitcnt lgkmcnt(12)
  v_add_u32 v253, 40960, v253
  v_mfma_f32_16x16x32_bf16 v[44:47], v[160:163], v[236:239], v[44:47]
  ds_read_b64_tr_b16 v[232:233], v246 offset:49152
  v_mfma_f32_16x16x32_bf16 v[76:79], v[164:167], v[236:239], v[76:79]
  s_waitcnt vmcnt(19)
  ds_read_b64_tr_b16 v[234:235], v246 offset:50176
  ds_read2st64_b32 v[138:139], v253 offset0:0 offset1:4
  v_mfma_f32_16x16x32_bf16 v[108:111], v[168:171], v[236:239], v[108:111]
  s_waitcnt lgkmcnt(13)
  buffer_store_dwordx4 v[132:135], v5, s[60:63], s39 offen offset:0 sc1
  v_mfma_f32_16x16x32_bf16 v[16:19], v[176:179], v[208:211], v[16:19]
  ds_read_b64_tr_b16 v[236:237], v247 offset:49152
  v_mfma_f32_16x16x32_bf16 v[48:51], v[180:183], v[208:211], v[48:51]
  s_waitcnt vmcnt(18)
  ds_read_b64_tr_b16 v[238:239], v247 offset:50176
  buffer_load_dwordx4 a[0:3], v5, s[60:63], s44 offen offset:0
  v_mfma_f32_16x16x32_bf16 v[80:83], v[184:187], v[208:211], v[80:83]
  ds_read2st64_b32 v[140:141], v253 offset0:32 offset1:36
  buffer_store_dwordx4 v[132:135], v5, s[60:63], s39 offen offset:1024 sc1
  v_mfma_f32_16x16x32_bf16 v[112:115], v[188:191], v[208:211], v[112:115]
  s_waitcnt lgkmcnt(14)
  v_mfma_f32_16x16x32_bf16 v[20:23], v[176:179], v[212:215], v[20:23]
  s_waitcnt vmcnt(18)
  ds_read_b64_tr_b16 v[208:209], v240 offset:57344
  ds_read2st64_b32 v[142:143], v253 offset0:64 offset1:68
  v_mfma_f32_16x16x32_bf16 v[52:55], v[180:183], v[212:215], v[52:55]
  ds_read_b64_tr_b16 v[210:211], v240 offset:58368
  buffer_store_dwordx4 v[132:135], v5, s[60:63], s39 offen offset:2048 sc1
  v_mfma_f32_16x16x32_bf16 v[84:87], v[184:187], v[212:215], v[84:87]
  s_waitcnt lgkmcnt(6)
  buffer_load_dwordx4 a[4:7], v5, s[60:63], s45 offen offset:0
  v_max_u32 v252, v138, v139
  v_mfma_f32_16x16x32_bf16 v[116:119], v[188:191], v[212:215], v[116:119]
  s_waitcnt vmcnt(18)
  ds_read2st64_b32 v[138:139], v253 offset0:96 offset1:100
  buffer_store_dwordx4 v[132:135], v5, s[60:63], s39 offen offset:2560 sc1
  v_mfma_f32_16x16x32_bf16 v[24:27], v[176:179], v[216:219], v[24:27]
  s_waitcnt lgkmcnt(4)
  ds_read_b64_tr_b16 v[212:213], v241 offset:57344
  v_max3_u32 v252, v252, v140, v141
  v_mfma_f32_16x16x32_bf16 v[56:59], v[180:183], v[216:219], v[56:59]
  ds_read_b64_tr_b16 v[214:215], v241 offset:58368
  v_mfma_f32_16x16x32_bf16 v[88:91], v[184:187], v[216:219], v[88:91]
  s_waitcnt vmcnt(17)
  ds_read2st64_b32 v[140:141], v253 offset0:128 offset1:132
  v_mfma_f32_16x16x32_bf16 v[28:31], v[176:179], v[220:223], v[28:31]
  ds_read_b64_tr_b16 v[216:217], v242 offset:57344
  buffer_load_dwordx4 a[8:11], v5, s[60:63], s46 offen offset:0
  v_mfma_f32_16x16x32_bf16 v[60:63], v[180:183], v[220:223], v[60:63]
  s_waitcnt lgkmcnt(6)
  ds_read_b64_tr_b16 v[218:219], v242 offset:58368
  v_max3_u32 v252, v252, v142, v143
  v_mfma_f32_16x16x32_bf16 v[92:95], v[184:187], v[220:223], v[92:95]
  s_waitcnt vmcnt(16)
  ds_read2st64_b32 v[142:143], v253 offset0:160 offset1:164
  v_mfma_f32_16x16x32_bf16 v[32:35], v[176:179], v[224:227], v[32:35]
  s_waitcnt lgkmcnt(6)
  ds_read_b64_tr_b16 v[220:221], v243 offset:57344
  v_max3_u32 v252, v252, v138, v139
  v_mfma_f32_16x16x32_bf16 v[64:67], v[180:183], v[224:227], v[64:67]
  ds_read_b64_tr_b16 v[222:223], v243 offset:58368
  v_mfma_f32_16x16x32_bf16 v[96:99], v[184:187], v[224:227], v[96:99]
  s_waitcnt vmcnt(13)
  buffer_load_dwordx4 a[12:15], v5, s[60:63], s47 offen offset:0
  ds_read2st64_b32 v[138:139], v253 offset0:192 offset1:196
  v_mfma_f32_16x16x32_bf16 v[120:123], v[188:191], v[224:227], v[120:123]
  s_waitcnt lgkmcnt(6)
  v_max3_u32 v252, v252, v140, v141
  v_mfma_f32_16x16x32_bf16 v[36:39], v[176:179], v[228:231], v[36:39]
  ds_read_b64_tr_b16 v[224:225], v244 offset:57344
  v_mfma_f32_16x16x32_bf16 v[68:71], v[180:183], v[228:231], v[68:71]
  s_waitcnt vmcnt(12)
  ds_read_b64_tr_b16 v[226:227], v244 offset:58368
  ds_read2st64_b32 v[140:141], v253 offset0:224 offset1:228
  v_mfma_f32_16x16x32_bf16 v[100:103], v[184:187], v[228:231], v[100:103]
  s_waitcnt lgkmcnt(6)
  v_max3_u32 v252, v252, v142, v143
  v_mfma_f32_16x16x32_bf16 v[124:127], v[188:191], v[228:231], v[124:127]
  v_cmp_ne_u32 vcc, s100, v254
  s_cbranch_vccz CF_ok
  s_waitcnt lgkmcnt(0)
  s_mov_b32 s11, 20000
  buffer_load_dword v254, v249, s[60:63], s23 offen offset:0 sc1
CF_spin:
  s_waitcnt vmcnt(0)
  v_cmp_ne_u32 vcc, s100, v254
  s_cbranch_vccz CF_done
  buffer_load_dword v254, v249, s[60:63], s23 offen offset:0 sc1
  s_sub_u32 s11, s11, 1
  s_cbranch_scc0 CF_spin
  s_waitcnt vmcnt(0)
CF_done:
CF_ok:
  v_mfma_f32_16x16x32_bf16 v[40:43], v[176:179], v[232:235], v[40:43]
  ds_read_b64_tr_b16 v[228:229], v245 offset:57344
  buffer_load_dwordx4 a[16:19], v5, s[60:63], s48 offen offset:0
  v_mfma_f32_16x16x32_bf16 v[72:75], v[180:183], v[232:235], v[72:75]
  s_waitcnt lgkmcnt(4)
  ds_read_b64_tr_b16 v[230:231], v245 offset:58368
  v_max3_u32 v252, v252, v138, v139
  v_mfma_f32_16x16x32_bf16 v[104:107], v[184:187], v[232:235], v[104:107]
  v_mfma_f32_16x16x32_bf16 v[44:47], v[176:179], v[236:239], v[44:47]
  ds_read_b64_tr_b16 v[232:233], v246 offset:57344
  v_mfma_f32_16x16x32_bf16 v[76:79], v[180:183], v[236:239], v[76:79]
  s_waitcnt lgkmcnt(3)
  ds_read_b64_tr_b16 v[234:235], v246 offset:58368
  v_max3_u32 v252, v252, v140, v141
  v_mfma_f32_16x16x32_bf16 v[108:111], v[184:187], v[236:239], v[108:111]
  buffer_load_dwordx4 a[20:23], v5, s[60:63], s44 offen offset:1024
  v_cmp_eq_u32 vcc, -1, v252
  v_mfma_f32_16x16x32_bf16 v[16:19], v[192:195], v[208:211], v[16:19]
  s_cbranch_vccnz HV12_slow
HV12_back:
  ds_read_b64_tr_b16 v[236:237], v247 offset:57344
  v_mfma_f32_16x16x32_bf16 v[48:51], v[196:199], v[208:211], v[48:51]
  ds_read_b64_tr_b16 v[238:239], v247 offset:58368
  s_barrier
  v_mfma_f32_16x16x32_bf16 v[80:83], v[200:203], v[208:211], v[80:83]
  v_add_u32 v240, 65536, v240
  v_mfma_f32_16x16x32_bf16 v[112:115], v[204:207], v[208:211], v[112:115]
  ds_read_b64_tr_b16 v[144:145], v11 offset:0
  ds_read_b64_tr_b16 v[146:147], v11 offset:4096
  v_mfma_f32_16x16x32_bf16 v[20:23], v[192:195], v[212:215], v[20:23]
  ds_read_b64_tr_b16 v[208:209], v240 offset:0
  buffer_load_dwordx4 a[24:27], v5, s[60:63], s45 offen offset:1024
  v_mfma_f32_16x16x32_bf16 v[52:55], v[196:199], v[212:215], v[52:55]
  ds_read_b64_tr_b16 v[210:211], v240 offset:1024
  ds_read_b64_tr_b16 v[148:149], v11 offset:8192
  v_mfma_f32_16x16x32_bf16 v[84:87], v[200:203], v[212:215], v[84:87]
  ds_read_b64_tr_b16 v[150:151], v11 offset:12288
  v_add_u32 v241, 65536, v241
  v_mfma_f32_16x16x32_bf16 v[116:119], v[204:207], v[212:215], v[116:119]
  ds_read_b64_tr_b16 v[14:15], v11 offset:16384
  v_xor_b32 v184, 4, v10
  v_mfma_f32_16x16x32_bf16 v[24:27], v[192:195], v[216:219], v[24:27]
  ds_read_b64_tr_b16 v[212:213], v241 offset:0
  v_xor_b32 v185, 8, v10
  v_mfma_f32_16x16x32_bf16 v[56:59], v[196:199], v[216:219], v[56:59]
  ds_read_b64_tr_b16 v[214:215], v241 offset:1024
  buffer_load_dwordx4 a[28:31], v5, s[60:63], s46 offen offset:1024
  v_mfma_f32_16x16x32_bf16 v[88:91], v[200:203], v[216:219], v[88:91]
  v_xor_b32 v186, 12, v10
  v_lshl_add_u32 v189, v1, 2, s12
  v_mfma_f32_16x16x32_bf16 v[28:31], v[192:195], v[220:223], v[28:31]
  ds_read_b64_tr_b16 v[216:217], v240 offset:8192
  v_cndmask_b32 v187, v189, v10, s[34:35]
  v_mfma_f32_16x16x32_bf16 v[60:63], v[196:199], v[220:223], v[60:63]
  ds_read_b64_tr_b16 v[218:219], v240 offset:9216
  v_cndmask_b32 v188, v189, v184, s[34:35]
  v_mfma_f32_16x16x32_bf16 v[92:95], v[200:203], v[220:223], v[92:95]
  v_add_u32 v191, s7, v5
  v_mfma_f32_16x16x32_bf16 v[32:35], v[192:195], v[224:227], v[32:35]
  ds_read_b64_tr_b16 v[220:221], v241 offset:8192
  buffer_load_dwordx4 a[32:35], v5, s[60:63], s47 offen offset:1024
  v_mfma_f32_16x16x32_bf16 v[64:67], v[196:199], v[224:227], v[64:67]
  ds_read_b64_tr_b16 v[222:223], v241 offset:9216
  ds_read_b64_tr_b16 v[128:129], v250 offset:0
  v_mfma_f32_16x16x32_bf16 v[96:99], v[200:203], v[224:227], v[96:99]
  ds_read_b64_tr_b16 v[130:131], v250 offset:1024
  ds_read_b64_tr_b16 v[132:133], v250 offset:8192
  v_mfma_f32_16x16x32_bf16 v[120:123], v[204:207], v[224:227], v[120:123]
  s_waitcnt lgkmcnt(15)
  ds_read_b64_tr_b16 v[134:135], v250 offset:9216
  ds_read_b64_tr_b16 v[136:137], v250 offset:16384
  v_mfma_f32_16x16x32_bf16 v[36:39], v[192:195], v[228:231], v[36:39]
  ds_read_b64_tr_b16 v[224:225], v240 offset:16384
  ds_read_b64_tr_b16 v[138:139], v250 offset:17408
  v_mfma_f32_16x16x32_bf16 v[68:71], v[196:199], v[228:231], v[68:71]
  ds_read_b64_tr_b16 v[226:227], v240 offset:17408
  buffer_load_dwordx4 a[36:39], v5, s[60:63], s48 offen offset:1024
  v_mfma_f32_16x16x32_bf16 v[100:103], v[200:203], v[228:231], v[100:103]
  v_mfma_f32_16x16x32_bf16 v[124:127], v[204:207], v[228:231], v[124:127]
  v_mfma_f32_16x16x32_bf16 v[40:43], v[192:195], v[232:235], v[40:43]
  ds_read_b64_tr_b16 v[228:229], v241 offset:16384
  v_mfma_f32_16x16x32_bf16 v[72:75], v[196:199], v[232:235], v[72:75]
  ds_read_b64_tr_b16 v[230:231], v241 offset:17408
  v_mfma_f32_16x16x32_bf16 v[104:107], v[200:203], v[232:235], v[104:107]
  buffer_load_dwordx4 a[40:43], v5, s[60:63], s44 offen offset:2048
  v_mfma_f32_16x16x32_bf16 v[44:47], v[192:195], v[236:239], v[44:47]
  ds_read_b64_tr_b16 v[232:233], v240 offset:24576
  v_mfma_f32_16x16x32_bf16 v[76:79], v[196:199], v[236:239], v[76:79]
  ds_read_b64_tr_b16 v[234:235], v240 offset:25600
  v_mfma_f32_16x16x32_bf16 v[108:111], v[200:203], v[236:239], v[108:111]
  s_waitcnt lgkmcnt(15)
  v_mfma_f32_16x16x32_bf16 v[16:19], a[64:67], v[208:211], v[16:19]
  ds_read_b64_tr_b16 v[236:237], v241 offset:24576
  v_mfma_f32_16x16x32_bf16 v[48:51], a[68:71], v[208:211], v[48:51]
  ds_read_b64_tr_b16 v[238:239], v241 offset:25600
  buffer_load_dwordx4 a[44:47], v5, s[60:63], s45 offen offset:2048
  v_mfma_f32_16x16x32_bf16 v[80:83], a[72:75], v[208:211], v[80:83]
  v_mfma_f32_16x16x32_bf16 v[112:115], a[76:79], v[208:211], v[112:115]
  s_waitcnt lgkmcnt(7)
  s_barrier
  v_mfma_f32_16x16x32_bf16 v[20:23], a[64:67], v[212:215], v[20:23]
  ds_read_b64_tr_b16 v[208:209], v240 offset:32768
  v_mfma_f32_16x16x32_bf16 v[52:55], a[68:71], v[212:215], v[52:55]
  ds_read_b64_tr_b16 v[210:211], v240 offset:33792
  v_mfma_f32_16x16x32_bf16 v[84:87], a[72:75], v[212:215], v[84:87]
  buffer_load_dwordx4 a[48:51], v5, s[60:63], s46 offen offset:2048
  v_mfma_f32_16x16x32_bf16 v[116:119], a[76:79], v[212:215], v[116:119]
  v_mfma_f32_16x16x32_bf16 v[204:207], v[132:135], v[132:135], 0
  v_mfma_f32_16x16x32_bf16 v[204:207], v[136:139], v[136:139], v[204:207]
  s_bitcmp1_b32 s17, 2
  s_cbranch_scc1 SQ_skip
  v_mfma_f32_16x16x32_bf16 v[204:207], v[128:131], v[128:131], v[204:207]
SQ_skip:
  v_mfma_f32_16x16x32_bf16 v[16:19], a[80:83], v[216:219], v[16:19]
  ds_read_b64_tr_b16 v[212:213], v241 offset:32768
  v_mfma_f32_16x16x32_bf16 v[48:51], a[84:87], v[216:219], v[48:51]
  ds_read_b64_tr_b16 v[214:215], v241 offset:33792
  v_mfma_f32_16x16x32_bf16 v[80:83], a[88:91], v[216:219], v[80:83]
  v_mfma_f32_16x16x32_bf16 v[112:115], a[92:95], v[216:219], v[112:115]
  buffer_load_dwordx4 a[52:55], v5, s[60:63], s47 offen offset:2048
  s_nop 0
  v_cndmask_b32 v189, v204, v205, s[50:51]
  v_mfma_f32_16x16x32_bf16 v[20:23], a[80:83], v[220:223], v[20:23]
  ds_read_b64_tr_b16 v[216:217], v240 offset:40960
  v_cndmask_b32 v189, v189, v206, s[52:53]
  v_mfma_f32_16x16x32_bf16 v[52:55], a[84:87], v[220:223], v[52:55]
  ds_read_b64_tr_b16 v[218:219], v240 offset:41984
  v_cndmask_b32 v189, v189, v207, s[54:55]
  v_mfma_f32_16x16x32_bf16 v[84:87], a[88:91], v[220:223], v[84:87]
  buffer_store_dword v189, v251, s[60:63], s30 offen sc1
  v_mfma_f32_16x16x32_bf16 v[116:119], a[92:95], v[220:223], v[116:119]
  s_waitcnt lgkmcnt(12)
  buffer_load_dwordx4 v[128:131], v12, s[60:63], s32 offen offset:0 sc1
  buffer_load_dwordx4 v[132:135], v12, s[60:63], s32 offen offset:64 sc1
  v_mfma_f32_16x16x32_bf16 v[16:19], a[96:99], v[224:227], v[16:19]
  ds_read_b64_tr_b16 v[220:221], v241 offset:40960
  buffer_load_dwordx4 a[56:59], v5, s[60:63], s48 offen offset:2048
  v_mfma_f32_16x16x32_bf16 v[48:51], a[100:103], v[224:227], v[48:51]
  ds_read_b64_tr_b16 v[222:223], v241 offset:41984
  buffer_load_dwordx4 v[136:139], v12, s[60:63], s32 offen offset:128 sc1
  v_mfma_f32_16x16x32_bf16 v[80:83], a[104:107], v[224:227], v[80:83]
  buffer_load_dwordx4 v[140:143], v12, s[60:63], s33 offen offset:0 sc1
  v_mfma_f32_16x16x32_bf16 v[112:115], a[108:111], v[224:227], v[112:115]
  s_waitcnt lgkmcnt(12)
  v_mfma_f32_16x16x32_bf16 v[20:23], a[96:99], v[228:231], v[20:23]
  ds_read_b64_tr_b16 v[224:225], v240 offset:49152
  v_mfma_f32_16x16x32_bf16 v[52:55], a[100:103], v[228:231], v[52:55]
  ds_read_b64_tr_b16 v[226:227], v240 offset:50176
  buffer_load_dwordx4 a[60:63], v5, s[60:63], s44 offen offset:3072
  v_mfma_f32_16x16x32_bf16 v[84:87], a[104:107], v[228:231], v[84:87]
  v_mfma_f32_16x16x32_bf16 v[116:119], a[108:111], v[228:231], v[116:119]
  s_waitcnt lgkmcnt(12)
  v_mfma_f32_16x16x32_bf16 v[16:19], a[112:115], v[232:235], v[16:19]
  ds_read_b64_tr_b16 v[228:229], v241 offset:49152
  v_mfma_f32_16x16x32_bf16 v[48:51], a[116:119], v[232:235], v[48:51]
  ds_read_b64_tr_b16 v[230:231], v241 offset:50176
  v_mfma_f32_16x16x32_bf16 v[80:83], a[120:123], v[232:235], v[80:83]
  buffer_load_dwordx4 v[152:155], v5, s[60:63], s45 offen offset:3072
  v_mfma_f32_16x16x32_bf16 v[112:115], a[124:127], v[232:235], v[112:115]
  s_waitcnt lgkmcnt(12)
  v_mfma_f32_16x16x32_bf16 v[20:23], a[112:115], v[236:239], v[20:23]
  ds_read_b64_tr_b16 v[232:233], v240 offset:57344
  v_mfma_f32_16x16x32_bf16 v[52:55], a[116:119], v[236:239], v[52:55]
  ds_read_b64_tr_b16 v[234:235], v240 offset:58368
  v_mfma_f32_16x16x32_bf16 v[84:87], a[120:123], v[236:239], v[84:87]
  v_mfma_f32_16x16x32_bf16 v[116:119], a[124:127], v[236:239], v[116:119]
  s_waitcnt lgkmcnt(12)
  buffer_load_dwordx4 v[156:159], v5, s[60:63], s46 offen offset:3072
  v_mfma_f32_16x16x32_bf16 v[16:19], a[128:131], v[208:211], v[16:19]
  ds_read_b64_tr_b16 v[236:237], v241 offset:57344
  v_mfma_f32_16x16x32_bf16 v[48:51], a[132:135], v[208:211], v[48:51]
  ds_read_b64_tr_b16 v[238:239], v241 offset:58368
  v_mfma_f32_16x16x32_bf16 v[80:83], a[136:139], v[208:211], v[80:83]
  v_add_u32 v240, 65536, v240
  v_mfma_f32_16x16x32_bf16 v[112:115], a[140:143], v[208:211], v[112:115]
  s_waitcnt lgkmcnt(12)
  v_mfma_f32_16x16x32_bf16 v[20:23], a[128:131], v[212:215], v[20:23]
  ds_read_b64_tr_b16 v[208:209], v240 offset:0
  buffer_load_dwordx4 v[160:163], v5, s[60:63], s47 offen offset:3072
  v_mfma_f32_16x16x32_bf16 v[52:55], a[132:135], v[212:215], v[52:55]
  ds_read_b64_tr_b16 v[210:211], v240 offset:1024
  v_mfma_f32_16x16x32_bf16 v[84:87], a[136:139], v[212:215], v[84:87]
  v_add_u32 v241, 65536, v241
  v_mfma_f32_16x16x32_bf16 v[116:119], a[140:143], v[212:215], v[116:119]
  s_waitcnt lgkmcnt(12)
  v_mfma_f32_16x16x32_bf16 v[16:19], a[144:147], v[216:219], v[16:19]
  ds_read_b64_tr_b16 v[212:213], v241 offset:0
  v_mfma_f32_16x16x32_bf16 v[48:51], a[148:151], v[216:219], v[48:51]
  ds_read_b64_tr_b16 v[214:215], v241 offset:1024
  buffer_load_dwordx4 v[164:167], v5, s[60:63], s48 offen offset:3072
  v_mfma_f32_16x16x32_bf16 v[80:83], a[152:155], v[216:219], v[80:83]
  v_mfma_f32_16x16x32_bf16 v[112:115], a[156:159], v[216:219], v[112:115]
  s_waitcnt lgkmcnt(12)
  v_mfma_f32_16x16x32_bf16 v[20:23], a[144:147], v[220:223], v[20:23]
  ds_read_b64_tr_b16 v[216:217], v240 offset:8192
  v_mfma_f32_16x16x32_bf16 v[52:55], a[148:151], v[220:223], v[52:55]
  ds_read_b64_tr_b16 v[218:219], v240 offset:9216
  v_mfma_f32_16x16x32_bf16 v[84:87], a[152:155], v[220:223], v[84:87]
  s_add_u32 s44, s44, 0x1000
  buffer_load_dwordx4 v[168:171], v5, s[60:63], s44 offen offset:0
  v_mfma_f32_16x16x32_bf16 v[116:119], a[156:159], v[220:223], v[116:119]
  s_waitcnt lgkmcnt(12)
  v_mfma_f32_16x16x32_bf16 v[16:19], a[160:163], v[224:227], v[16:19]
  ds_read_b64_tr_b16 v[220:221], v241 offset:8192
  v_mfma_f32_16x16x32_bf16 v[48:51], a[164:167], v[224:227], v[48:51]
  ds_read_b64_tr_b16 v[222:223], v241 offset:9216
  v_mfma_f32_16x16x32_bf16 v[80:83], a[168:171], v[224:227], v[80:83]
  v_mfma_f32_16x16x32_bf16 v[112:115], a[172:175], v[224:227], v[112:115]
  s_waitcnt lgkmcnt(12)
  s_add_u32 s45, s45, 0x1000
  buffer_load_dwordx4 v[172:175], v5, s[60:63], s45 offen offset:0
  v_mfma_f32_16x16x32_bf16 v[20:23], a[160:163], v[228:231], v[20:23]
  ds_read_b64_tr_b16 v[224:225], v240 offset:16384
  v_mfma_f32_16x16x32_bf16 v[52:55], a[164:167], v[228:231], v[52:55]
  ds_read_b64_tr_b16 v[226:227], v240 offset:17408
  v_mfma_f32_16x16x32_bf16 v[84:87], a[168:171], v[228:231], v[84:87]
  v_mfma_f32_16x16x32_bf16 v[116:119], a[172:175], v[228:231], v[116:119]
  s_waitcnt lgkmcnt(12)
  v_mfma_f32_16x16x32_bf16 v[16:19], a[176:179], v[232:235], v[16:19]
  ds_read_b64_tr_b16 v[228:229], v241 offset:16384
  v_mfma_f32_16x16x32_bf16 v[48:51], a[180:183], v[232:235], v[48:51]
  ds_read_b64_tr_b16 v[230:231], v241 offset:17408
  v_mfma_f32_16x16x32_bf16 v[80:83], a[184:187], v[232:235], v[80:83]
  s_add_u32 m0, s7, 0
  s_add_u32 s49, s10, 11264
  buffer_load_dwordx4 v5, s[60:63], s49 offen lds
  v_mfma_f32_16x16x32_bf16 v[112:115], a[188:191], v[232:235], v[112:115]
  s_waitcnt lgkmcnt(12)
  v_mfma_f32_16x16x32_bf16 v[20:23], a[176:179], v[236:239], v[20:23]
  ds_read_b64_tr_b16 v[232:233], v240 offset:24576
  v_mfma_f32_16x16x32_bf16 v[52:55], a[180:183], v[236:239], v[52:55]
  ds_read_b64_tr_b16 v[234:235], v240 offset:25600
  v_mfma_f32_16x16x32_bf16 v[84:87], a[184:187], v[236:239], v[84:87]
  v_mfma_f32_16x16x32_bf16 v[116:119], a[188:191], v[236:239], v[116:119]
  s_waitcnt lgkmcnt(12)
  v_mfma_f32_16x16x32_bf16 v[16:19], a[192:195], v[208:211], v[16:19]
  ds_read_b64_tr_b16 v[236:237], v241 offset:24576
  v_mfma_f32_16x16x32_bf16 v[48:51], a[196:199], v[208:211], v[48:51]
  ds_read_b64_tr_b16 v[238:239], v241 offset:25600
  v_mfma_f32_16x16x32_bf16 v[80:83], a[200:203], v[208:211], v[80:83]
  v_add_u32 v242, 65536, v242
  v_mfma_f32_16x16x32_bf16 v[112:115], a[204:207], v[208:211], v[112:115]
  s_waitcnt lgkmcnt(12)
  v_mfma_f32_16x16x32_bf16 v[20:23], a[192:195], v[212:215], v[20:23]
  ds_read_b64_tr_b16 v[208:209], v242 offset:0
  v_mfma_f32_16x16x32_bf16 v[52:55], a[196:199], v[212:215], v[52:55]
  ds_read_b64_tr_b16 v[210:211], v242 offset:1024
  v_mfma_f32_16x16x32_bf16 v[84:87], a[200:203], v[212:215], v[84:87]
  v_add_u32 v243, 65536, v243
  v_mfma_f32_16x16x32_bf16 v[116:119], a[204:207], v[212:215], v[116:119]
  s_waitcnt lgkmcnt(12)
  v_mfma_f32_16x16x32_bf16 v[16:19], a[208:211], v[216:219], v[16:19]
  ds_read_b64_tr_b16 v[212:213], v243 offset:0
  v_mfma_f32_16x16x32_bf16 v[48:51], a[212:215], v[216:219], v[48:51]
  ds_read_b64_tr_b16 v[214:215], v243 offset:1024
  v_mfma_f32_16x16x32_bf16 v[80:83], a[216:219], v[216:219], v[80:83]
  s_add_u32 m0, s7, 1024
  s_add_u32 s49, s10, 68608
  buffer_load_dwordx4 v5, s[60:63], s49 offen lds
  v_mfma_f32_16x16x32_bf16 v[112:115], a[220:223], v[216:219], v[112:115]
  s_waitcnt lgkmcnt(12)
  v_mfma_f32_16x16x32_bf16 v[20:23], a[208:211], v[220:223], v[20:23]
  ds_read_b64_tr_b16 v[216:217], v242 offset:8192
  v_mfma_f32_16x16x32_bf16 v[52:55], a[212:215], v[220:223], v[52:55]
  ds_read_b64_tr_b16 v[218:219], v242 offset:9216
  v_mfma_f32_16x16x32_bf16 v[84:87], a[216:219], v[220:223], v[84:87]
  v_mfma_f32_16x16x32_bf16 v[116:119], a[220:223], v[220:223], v[116:119]
  s_waitcnt lgkmcnt(12)
  v_mfma_f32_16x16x32_bf16 v[16:19], a[224:227], v[224:227], v[16:19]
  ds_read_b64_tr_b16 v[220:221], v243 offset:8192
  v_mfma_f32_16x16x32_bf16 v[48:51], a[228:231], v[224:227], v[48:51]
  ds_read_b64_tr_b16 v[222:223], v243 offset:9216
  v_mfma_f32_16x16x32_bf16 v[80:83], a[232:235], v[224:227], v[80:83]
  s_add_u32 m0, s7, 2048
  s_add_u32 s49, s10, 125952
  buffer_load_dwordx4 v5, s[60:63], s49 offen lds
  v_mfma_f32_16x16x32_bf16 v[112:115], a[236:239], v[224:227], v[112:115]
  s_waitcnt lgkmcnt(12)
  v_mfma_f32_16x16x32_bf16 v[20:23], a[224:227], v[228:231], v[20:23]
  ds_read_b64_tr_b16 v[224:225], v242 offset:16384
  v_mfma_f32_16x16x32_bf16 v[52:55], a[228:231], v[228:231], v[52:55]
  ds_read_b64_tr_b16 v[226:227], v242 offset:17408
  v_mfma_f32_16x16x32_bf16 v[84:87], a[232:235], v[228:231], v[84:87]
  v_mfma_f32_16x16x32_bf16 v[116:119], a[236:239], v[228:231], v[116:119]
  s_waitcnt lgkmcnt(12)
  v_mfma_f32_16x16x32_bf16 v[16:19], a[240:243], v[232:235], v[16:19]
  ds_read_b64_tr_b16 v[228:229], v243 offset:16384
  v_mfma_f32_16x16x32_bf16 v[48:51], a[244:247], v[232:235], v[48:51]
  ds_read_b64_tr_b16 v[230:231], v243 offset:17408
  v_mfma_f32_16x16x32_bf16 v[80:83], a[248:251], v[232:235], v[80:83]
  s_add_u32 m0, s7, 3072
  s_add_u32 s49, s10, 183296
  buffer_load_dwordx4 v5, s[60:63], s49 offen lds
  v_mfma_f32_16x16x32_bf16 v[112:115], a[252:255], v[232:235], v[112:115]
  s_waitcnt lgkmcnt(12)
  v_mfma_f32_16x16x32_bf16 v[20:23], a[240:243], v[236:239], v[20:23]
  ds_read_b64_tr_b16 v[232:233], v242 offset:24576
  v_mfma_f32_16x16x32_bf16 v[52:55], a[244:247], v[236:239], v[52:55]
  ds_read_b64_tr_b16 v[234:235], v242 offset:25600
  v_mfma_f32_16x16x32_bf16 v[84:87], a[248:251], v[236:239], v[84:87]
  v_mfma_f32_16x16x32_bf16 v[116:119], a[252:255], v[236:239], v[116:119]
  s_waitcnt lgkmcnt(12)
  v_mfma_f32_16x16x32_bf16 v[24:27], a[64:67], v[208:211], v[24:27]
  ds_read_b64_tr_b16 v[236:237], v243 offset:24576
  ds_read_b64_tr_b16 v[238:239], v243 offset:25600
  v_mfma_f32_16x16x32_bf16 v[56:59], a[68:71], v[208:211], v[56:59]
  s_add_u32 m0, s7, 4096
  s_add_u32 s49, s10, 240640
  buffer_load_dwordx4 v5, s[60:63], s49 offen lds
  v_mfma_f32_16x16x32_bf16 v[88:91], a[72:75], v[208:211], v[88:91]
  s_waitcnt lgkmcnt(12)
  v_mul_f32 v189, 0xbacccccd, v112
  v_mul_f32 v190, 0xbacccccd, v116
  v_mfma_f32_16x16x32_bf16 v[28:31], a[64:67], v[212:215], v[28:31]
  ds_read_b64_tr_b16 v[208:209], v242 offset:32768
  ds_read_b64_tr_b16 v[210:211], v242 offset:33792
  v_mfma_f32_16x16x32_bf16 v[60:63], a[68:71], v[212:215], v[60:63]
  ds_write_b32 v187, v189 offset:0
  ds_write_b32 v188, v190 offset:0
  v_mfma_f32_16x16x32_bf16 v[92:95], a[72:75], v[212:215], v[92:95]
  s_waitcnt lgkmcnt(14)
  v_mfma_f32_16x16x32_bf16 v[24:27], a[80:83], v[216:219], v[24:27]
  ds_read_b64_tr_b16 v[212:213], v243 offset:32768
  ds_read_b64_tr_b16 v[214:215], v243 offset:33792
  v_mfma_f32_16x16x32_bf16 v[56:59], a[84:87], v[216:219], v[56:59]
  s_add_u32 m0, s7, 5120
  s_add_u32 s49, s10, 12288
  buffer_load_dwordx4 v5, s[60:63], s49 offen lds
  v_mfma_f32_16x16x32_bf16 v[88:91], a[88:91], v[216:219], v[88:91]
  s_waitcnt lgkmcnt(14)
  v_mfma_f32_16x16x32_bf16 v[28:31], a[80:83], v[220:223], v[28:31]
  ds_read_b64_tr_b16 v[216:217], v242 offset:40960
  ds_read_b64_tr_b16 v[218:219], v242 offset:41984
  s_waitcnt lgkmcnt(4)
  s_waitcnt vmcnt(31)
  s_barrier
  s_cmp_lg_u32 s3, 0
  s_cbranch_scc1 FX_pub
  s_mov_b64 exec, 1
  buffer_store_dword v255, off, s[60:63], s41 offset:0 sc1
  s_mov_b64 exec, -1
FX_pub:
  v_mfma_f32_16x16x32_bf16 v[60:63], a[84:87], v[220:223], v[60:63]
  ds_read_b32 v176, v10 offset:0
  ds_read_b32 v177, v184 offset:0
  v_mfma_f32_16x16x32_bf16 v[92:95], a[88:91], v[220:223], v[92:95]
  ds_read_b32 v178, v185 offset:0
  ds_read_b32 v179, v186 offset:0
  v_mfma_f32_16x16x32_bf16 v[24:27], a[96:99], v[224:227], v[24:27]
  ds_read_b64_tr_b16 v[220:221], v243 offset:40960
  ds_read_b64_tr_b16 v[222:223], v243 offset:41984
  v_mfma_f32_16x16x32_bf16 v[56:59], a[100:103], v[224:227], v[56:59]
  s_add_u32 m0, s7, 6144
  s_add_u32 s49, s10, 69632
  buffer_load_dwordx4 v5, s[60:63], s49 offen lds
  v_mfma_f32_16x16x32_bf16 v[88:91], a[104:107], v[224:227], v[88:91]
  v_mfma_f32_16x16x32_bf16 v[28:31], a[96:99], v[228:231], v[28:31]
  ds_read_b64_tr_b16 v[224:225], v242 offset:49152
  ds_read_b64_tr_b16 v[226:227], v242 offset:50176
  v_mfma_f32_16x16x32_bf16 v[60:63], a[100:103], v[228:231], v[60:63]
  s_waitcnt vmcnt(18) lgkmcnt(7)
  v_fmac_f32 v16, v128, v176
  v_fmac_f32 v17, v129, v176
  v_mfma_f32_16x16x32_bf16 v[92:95], a[104:107], v[228:231], v[92:95]
  v_fmac_f32 v18, v130, v176
  v_fmac_f32 v19, v131, v176
  v_mfma_f32_16x16x32_bf16 v[24:27], a[112:115], v[232:235], v[24:27]
  ds_read_b64_tr_b16 v[228:229], v243 offset:49152
  ds_read_b64_tr_b16 v[230:231], v243 offset:50176
  v_mfma_f32_16x16x32_bf16 v[56:59], a[116:119], v[232:235], v[56:59]
  s_add_u32 m0, s7, 7168
  s_add_u32 s49, s10, 126976
  buffer_load_dwordx4 v5, s[60:63], s49 offen lds
  v_mfma_f32_16x16x32_bf16 v[88:91], a[120:123], v[232:235], v[88:91]
  s_waitcnt vmcnt(18)
  v_fmac_f32 v48, v132, v176
  v_fmac_f32 v49, v133, v176
  v_mfma_f32_16x16x32_bf16 v[28:31], a[112:115], v[236:239], v[28:31]
  ds_read_b64_tr_b16 v[232:233], v242 offset:57344
  ds_read_b64_tr_b16 v[234:235], v242 offset:58368
  v_mfma_f32_16x16x32_bf16 v[60:63], a[116:119], v[236:239], v[60:63]
  v_fmac_f32 v50, v134, v176
  v_fmac_f32 v51, v135, v176
  v_mfma_f32_16x16x32_bf16 v[92:95], a[120:123], v[236:239], v[92:95]
  v_max_f32 v16, 0, v16
  v_max_f32 v17, 0, v17
  v_mfma_f32_16x16x32_bf16 v[24:27], a[128:131], v[208:211], v[24:27]
  ds_read_b64_tr_b16 v[236:237], v243 offset:57344
  ds_read_b64_tr_b16 v[238:239], v243 offset:58368
  v_mfma_f32_16x16x32_bf16 v[56:59], a[132:135], v[208:211], v[56:59]
  s_add_u32 m0, s7, 8192
  s_add_u32 s49, s10, 184320
  buffer_load_dwordx4 v5, s[60:63], s49 offen lds
  v_mfma_f32_16x16x32_bf16 v[88:91], a[136:139], v[208:211], v[88:91]
  v_add_u32 v242, 65536, v242
  v_max_f32 v18, 0, v18
  v_mfma_f32_16x16x32_bf16 v[28:31], a[128:131], v[212:215], v[28:31]
  ds_read_b64_tr_b16 v[208:209], v242 offset:0
  ds_read_b64_tr_b16 v[210:211], v242 offset:1024
  v_mfma_f32_16x16x32_bf16 v[60:63], a[132:135], v[212:215], v[60:63]
  v_max_f32 v19, 0, v19
  v_mul_f32 v16, v16, v48
  v_mfma_f32_16x16x32_bf16 v[92:95], a[136:139], v[212:215], v[92:95]
  v_add_u32 v243, 65536, v243
  v_mul_f32 v17, v17, v49
  v_mfma_f32_16x16x32_bf16 v[24:27], a[144:147], v[216:219], v[24:27]
  ds_read_b64_tr_b16 v[212:213], v243 offset:0
  ds_read_b64_tr_b16 v[214:215], v243 offset:1024
  v_mfma_f32_16x16x32_bf16 v[56:59], a[148:151], v[216:219], v[56:59]
  s_add_u32 m0, s7, 9216
  s_add_u32 s49, s10, 241664
  buffer_load_dwordx4 v5, s[60:63], s49 offen lds
  v_mfma_f32_16x16x32_bf16 v[88:91], a[152:155], v[216:219], v[88:91]
  s_waitcnt lgkmcnt(12)
  v_mul_f32 v18, v18, v50
  v_mul_f32 v19, v19, v51
  v_mfma_f32_16x16x32_bf16 v[28:31], a[144:147], v[220:223], v[28:31]
  ds_read_b64_tr_b16 v[216:217], v242 offset:8192
  ds_read_b64_tr_b16 v[218:219], v242 offset:9216
  v_mfma_f32_16x16x32_bf16 v[60:63], a[148:151], v[220:223], v[60:63]
  v_cvt_pk_bf16_f32 v48, v16, v17
  v_cvt_pk_bf16_f32 v49, v18, v19
  v_mfma_f32_16x16x32_bf16 v[92:95], a[152:155], v[220:223], v[92:95]
  s_waitcnt lgkmcnt(12)
  v_fmac_f32 v20, v128, v177
  v_fmac_f32 v21, v129, v177
  v_mfma_f32_16x16x32_bf16 v[24:27], a[160:163], v[224:227], v[24:27]
  ds_read_b64_tr_b16 v[220:221], v243 offset:8192
  ds_read_b64_tr_b16 v[222:223], v243 offset:9216
  v_mfma_f32_16x16x32_bf16 v[56:59], a[164:167], v[224:227], v[56:59]
  s_add_u32 m0, s7, 10240
  s_add_u32 s49, s10, 13312
  buffer_load_dwordx4 v5, s[60:63], s49 offen lds
  v_mfma_f32_16x16x32_bf16 v[88:91], a[168:171], v[224:227], v[88:91]
  s_waitcnt lgkmcnt(12)
  v_fmac_f32 v22, v130, v177
  v_fmac_f32 v23, v131, v177
  v_mfma_f32_16x16x32_bf16 v[28:31], a[160:163], v[228:231], v[28:31]
  ds_read_b64_tr_b16 v[224:225], v242 offset:16384
  ds_read_b64_tr_b16 v[226:227], v242 offset:17408
  v_mfma_f32_16x16x32_bf16 v[60:63], a[164:167], v[228:231], v[60:63]
  v_fmac_f32 v52, v132, v177
  v_fmac_f32 v53, v133, v177
  v_mfma_f32_16x16x32_bf16 v[92:95], a[168:171], v[228:231], v[92:95]
  s_waitcnt lgkmcnt(12)
  v_fmac_f32 v54, v134, v177
  v_fmac_f32 v55, v135, v177
  v_mfma_f32_16x16x32_bf16 v[24:27], a[176:179], v[232:235], v[24:27]
  ds_read_b64_tr_b16 v[228:229], v243 offset:16384
  ds_read_b64_tr_b16 v[230:231], v243 offset:17408
  v_mfma_f32_16x16x32_bf16 v[56:59], a[180:183], v[232:235], v[56:59]
  s_add_u32 m0, s7, 11264
  s_add_u32 s49, s10, 70656
  buffer_load_dwordx4 v5, s[60:63], s49 offen lds
  v_mfma_f32_16x16x32_bf16 v[88:91], a[184:187], v[232:235], v[88:91]
  s_waitcnt lgkmcnt(12)
  v_max_f32 v20, 0, v20
  v_max_f32 v21, 0, v21
  v_mfma_f32_16x16x32_bf16 v[28:31], a[176:179], v[236:239], v[28:31]
  ds_read_b64_tr_b16 v[232:233], v242 offset:24576
  ds_read_b64_tr_b16 v[234:235], v242 offset:25600
  v_mfma_f32_16x16x32_bf16 v[60:63], a[180:183], v[236:239], v[60:63]
  v_max_f32 v22, 0, v22
  v_max_f32 v23, 0, v23
  v_mfma_f32_16x16x32_bf16 v[92:95], a[184:187], v[236:239], v[92:95]
  s_waitcnt lgkmcnt(12)
  v_mul_f32 v20, v20, v52
  v_mul_f32 v21, v21, v53
  v_mfma_f32_16x16x32_bf16 v[24:27], a[192:195], v[208:211], v[24:27]
  ds_read_b64_tr_b16 v[236:237], v243 offset:24576
  ds_read_b64_tr_b16 v[238:239], v243 offset:25600
  v_mfma_f32_16x16x32_bf16 v[56:59], a[196:199], v[208:211], v[56:59]
  s_add_u32 m0, s7, 12288
  s_add_u32 s49, s10, 128000
  buffer_load_dwordx4 v5, s[60:63], s49 offen lds
  v_mfma_f32_16x16x32_bf16 v[88:91], a[200:203], v[208:211], v[88:91]
  s_waitcnt lgkmcnt(12)
  v_add_u32 v244, 65536, v244
  v_mul_f32 v22, v22, v54
  v_mfma_f32_16x16x32_bf16 v[28:31], a[192:195], v[212:215], v[28:31]
  ds_read_b64_tr_b16 v[208:209], v244 offset:0
  ds_read_b64_tr_b16 v[210:211], v244 offset:1024
  v_mfma_f32_16x16x32_bf16 v[60:63], a[196:199], v[212:215], v[60:63]
  v_mul_f32 v23, v23, v55
  v_cvt_pk_bf16_f32 v50, v20, v21
  v_mfma_f32_16x16x32_bf16 v[92:95], a[200:203], v[212:215], v[92:95]
  s_waitcnt lgkmcnt(12)
  v_add_u32 v245, 65536, v245
  v_cvt_pk_bf16_f32 v51, v22, v23
  v_mfma_f32_16x16x32_bf16 v[24:27], a[208:211], v[216:219], v[24:27]
  ds_read_b64_tr_b16 v[212:213], v245 offset:0
  ds_read_b64_tr_b16 v[214:215], v245 offset:1024
  v_mfma_f32_16x16x32_bf16 v[56:59], a[212:215], v[216:219], v[56:59]
  s_add_u32 m0, s7, 13312
  s_add_u32 s49, s10, 185344
  buffer_load_dwordx4 v5, s[60:63], s49 offen lds
  v_mfma_f32_16x16x32_bf16 v[88:91], a[216:219], v[216:219], v[88:91]
  s_waitcnt lgkmcnt(12)
  v_permlane16_swap_b32 v48, v50
  v_mfma_f32_16x16x32_bf16 v[28:31], a[208:211], v[220:223], v[28:31]
  ds_read_b64_tr_b16 v[216:217], v244 offset:8192
  ds_read_b64_tr_b16 v[218:219], v244 offset:9216
  v_mfma_f32_16x16x32_bf16 v[60:63], a[212:215], v[220:223], v[60:63]
  v_permlane16_swap_b32 v49, v51
  v_mfma_f32_16x16x32_bf16 v[92:95], a[216:219], v[220:223], v[92:95]
  s_waitcnt vmcnt(22) lgkmcnt(12)
  buffer_store_dwordx4 v[48:51], v7, s[60:63], s8 offen sc1
  v_fmac_f32 v80, v136, v176
  v_mfma_f32_16x16x32_bf16 v[24:27], a[224:227], v[224:227], v[24:27]
  ds_read_b64_tr_b16 v[220:221], v245 offset:8192
  ds_read_b64_tr_b16 v[222:223], v245 offset:9216
  v_mfma_f32_16x16x32_bf16 v[56:59], a[228:231], v[224:227], v[56:59]
  s_add_u32 m0, s7, 14336
  s_add_u32 s49, s10, 242688
  buffer_load_dwordx4 v5, s[60:63], s49 offen lds
  v_mfma_f32_16x16x32_bf16 v[88:91], a[232:235], v[224:227], v[88:91]
  s_waitcnt lgkmcnt(12)
  v_fmac_f32 v81, v137, v176
  v_fmac_f32 v82, v138, v176
  v_mfma_f32_16x16x32_bf16 v[28:31], a[224:227], v[228:231], v[28:31]
  ds_read_b64_tr_b16 v[224:225], v244 offset:16384
  ds_read_b64_tr_b16 v[226:227], v244 offset:17408
  v_mfma_f32_16x16x32_bf16 v[60:63], a[228:231], v[228:231], v[60:63]
  s_waitcnt vmcnt(23)
  v_fmac_f32 v83, v139, v176
  v_fmac_f32 v112, v140, v176
  v_mfma_f32_16x16x32_bf16 v[92:95], a[232:235], v[228:231], v[92:95]
  s_waitcnt lgkmcnt(12)
  v_fmac_f32 v113, v141, v176
  v_fmac_f32 v114, v142, v176
  v_mfma_f32_16x16x32_bf16 v[24:27], a[240:243], v[232:235], v[24:27]
  ds_read_b64_tr_b16 v[228:229], v245 offset:16384
  ds_read_b64_tr_b16 v[230:231], v245 offset:17408
  v_mfma_f32_16x16x32_bf16 v[56:59], a[244:247], v[232:235], v[56:59]
  v_fmac_f32 v115, v143, v176
  v_fmac_f32 v84, v136, v177
  v_mfma_f32_16x16x32_bf16 v[88:91], a[248:251], v[232:235], v[88:91]
  s_waitcnt lgkmcnt(12)
  v_permlane32_swap_b32 v80, v112
  v_mfma_f32_16x16x32_bf16 v[28:31], a[240:243], v[236:239], v[28:31]
  ds_read_b64_tr_b16 v[232:233], v244 offset:24576
  ds_read_b64_tr_b16 v[234:235], v244 offset:25600
  v_mfma_f32_16x16x32_bf16 v[60:63], a[244:247], v[236:239], v[60:63]
  v_permlane32_swap_b32 v81, v113
  v_mfma_f32_16x16x32_bf16 v[92:95], a[248:251], v[236:239], v[92:95]
  s_waitcnt lgkmcnt(12)
  v_permlane32_swap_b32 v82, v114
  v_mfma_f32_16x16x32_bf16 v[32:35], a[64:67], v[208:211], v[32:35]
  ds_read_b64_tr_b16 v[236:237], v245 offset:24576
  ds_read_b64_tr_b16 v[238:239], v245 offset:25600
  v_mfma_f32_16x16x32_bf16 v[64:67], a[68:71], v[208:211], v[64:67]
  v_permlane32_swap_b32 v83, v115
  v_mfma_f32_16x16x32_bf16 v[96:99], a[72:75], v[208:211], v[96:99]
  v_max_f32 v80, 0, v80
  v_max_f32 v81, 0, v81
  v_mfma_f32_16x16x32_bf16 v[120:123], a[76:79], v[208:211], v[120:123]
  s_waitcnt lgkmcnt(12)
  v_max_f32 v82, 0, v82
  v_max_f32 v83, 0, v83
  v_mfma_f32_16x16x32_bf16 v[36:39], a[64:67], v[212:215], v[36:39]
  ds_read_b64_tr_b16 v[208:209], v244 offset:32768
  ds_read_b64_tr_b16 v[210:211], v244 offset:33792
  v_mfma_f32_16x16x32_bf16 v[68:71], a[68:71], v[212:215], v[68:71]
  v_mul_f32 v80, v80, v112
  v_mul_f32 v81, v81, v113
  v_mfma_f32_16x16x32_bf16 v[100:103], a[72:75], v[212:215], v[100:103]
  v_mul_f32 v82, v82, v114
  v_mul_f32 v83, v83, v115
  v_mfma_f32_16x16x32_bf16 v[124:127], a[76:79], v[212:215], v[124:127]
  s_waitcnt lgkmcnt(12)
  v_cvt_pk_bf16_f32 v112, v80, v81
  v_cvt_pk_bf16_f32 v113, v82, v83
  v_mfma_f32_16x16x32_bf16 v[32:35], a[80:83], v[216:219], v[32:35]
  ds_read_b64_tr_b16 v[212:213], v245 offset:32768
  ds_read_b64_tr_b16 v[214:215], v245 offset:33792
  v_mfma_f32_16x16x32_bf16 v[64:67], a[84:87], v[216:219], v[64:67]
  s_add_u32 s46, s46, 0x1000
  buffer_load_dwordx4 a[76:79], v5, s[60:63], s46 offen offset:0
  v_fmac_f32 v85, v137, v177
  v_mfma_f32_16x16x32_bf16 v[96:99], a[88:91], v[216:219], v[96:99]
  v_fmac_f32 v86, v138, v177
  v_fmac_f32 v87, v139, v177
  v_mfma_f32_16x16x32_bf16 v[120:123], a[92:95], v[216:219], v[120:123]
  s_waitcnt lgkmcnt(12)
  v_fmac_f32 v116, v140, v177
  v_fmac_f32 v117, v141, v177
  v_mfma_f32_16x16x32_bf16 v[36:39], a[80:83], v[220:223], v[36:39]
  ds_read_b64_tr_b16 v[216:217], v244 offset:40960
  ds_read_b64_tr_b16 v[218:219], v244 offset:41984
  v_mfma_f32_16x16x32_bf16 v[68:71], a[84:87], v[220:223], v[68:71]
  v_fmac_f32 v118, v142, v177
  v_fmac_f32 v119, v143, v177
  v_mfma_f32_16x16x32_bf16 v[100:103], a[88:91], v[220:223], v[100:103]
  v_permlane32_swap_b32 v84, v116
  v_mfma_f32_16x16x32_bf16 v[124:127], a[92:95], v[220:223], v[124:127]
  s_waitcnt lgkmcnt(12)
  v_permlane32_swap_b32 v85, v117
  v_mfma_f32_16x16x32_bf16 v[32:35], a[96:99], v[224:227], v[32:35]
  ds_read_b64_tr_b16 v[220:221], v245 offset:40960
  ds_read_b64_tr_b16 v[222:223], v245 offset:41984
  v_mfma_f32_16x16x32_bf16 v[64:67], a[100:103], v[224:227], v[64:67]
  s_add_u32 s47, s47, 0x1000
  buffer_load_dwordx4 a[92:95], v5, s[60:63], s47 offen offset:0
  v_max_f32 v84, 0, v84
  v_mfma_f32_16x16x32_bf16 v[96:99], a[104:107], v[224:227], v[96:99]
  v_permlane32_swap_b32 v86, v118
  v_mfma_f32_16x16x32_bf16 v[120:123], a[108:111], v[224:227], v[120:123]
  s_waitcnt lgkmcnt(12)
  v_permlane32_swap_b32 v87, v119
  v_mfma_f32_16x16x32_bf16 v[36:39], a[96:99], v[228:231], v[36:39]
  ds_read_b64_tr_b16 v[224:225], v244 offset:49152
  ds_read_b64_tr_b16 v[226:227], v244 offset:50176
  v_mfma_f32_16x16x32_bf16 v[68:71], a[100:103], v[228:231], v[68:71]
  v_max_f32 v85, 0, v85
  v_max_f32 v86, 0, v86
  v_mfma_f32_16x16x32_bf16 v[100:103], a[104:107], v[228:231], v[100:103]
  v_max_f32 v87, 0, v87
  v_mul_f32 v84, v84, v116
  v_mfma_f32_16x16x32_bf16 v[124:127], a[108:111], v[228:231], v[124:127]
  s_waitcnt lgkmcnt(12)
  v_mul_f32 v85, v85, v117
  v_mul_f32 v86, v86, v118
  v_mfma_f32_16x16x32_bf16 v[32:35], a[112:115], v[232:235], v[32:35]
  ds_read_b64_tr_b16 v[228:229], v245 offset:49152
  ds_read_b64_tr_b16 v[230:231], v245 offset:50176
  v_mfma_f32_16x16x32_bf16 v[64:67], a[116:119], v[232:235], v[64:67]
  s_add_u32 s48, s48, 0x1000
  buffer_load_dwordx4 a[108:111], v5, s[60:63], s48 offen offset:0
  v_mul_f32 v87, v87, v119
  v_mfma_f32_16x16x32_bf16 v[96:99], a[120:123], v[232:235], v[96:99]
  v_cvt_pk_bf16_f32 v114, v84, v85
  v_cvt_pk_bf16_f32 v115, v86, v87
  v_mfma_f32_16x16x32_bf16 v[120:123], a[124:127], v[232:235], v[120:123]
  s_waitcnt lgkmcnt(12)
  v_permlane16_swap_b32 v112, v114
  v_mfma_f32_16x16x32_bf16 v[36:39], a[112:115], v[236:239], v[36:39]
  ds_read_b64_tr_b16 v[232:233], v244 offset:57344
  ds_read_b64_tr_b16 v[234:235], v244 offset:58368
  v_mfma_f32_16x16x32_bf16 v[68:71], a[116:119], v[236:239], v[68:71]
  v_permlane16_swap_b32 v113, v115
  v_mfma_f32_16x16x32_bf16 v[100:103], a[120:123], v[236:239], v[100:103]
  buffer_store_dwordx4 v[112:115], v8, s[60:63], s8 offen sc1
  v_fmac_f32 v24, v128, v178
  v_mfma_f32_16x16x32_bf16 v[124:127], a[124:127], v[236:239], v[124:127]
  s_waitcnt lgkmcnt(12)
  v_fmac_f32 v25, v129, v178
  v_fmac_f32 v26, v130, v178
  v_mfma_f32_16x16x32_bf16 v[32:35], a[128:131], v[208:211], v[32:35]
  ds_read_b64_tr_b16 v[236:237], v245 offset:57344
  ds_read_b64_tr_b16 v[238:239], v245 offset:58368
  v_mfma_f32_16x16x32_bf16 v[64:67], a[132:135], v[208:211], v[64:67]
  buffer_load_dwordx4 a[124:127], v5, s[60:63], s44 offen offset:1024
  v_fmac_f32 v27, v131, v178
  v_mfma_f32_16x16x32_bf16 v[96:99], a[136:139], v[208:211], v[96:99]
  v_add_u32 v244, 65536, v244
  v_fmac_f32 v56, v132, v178
  v_mfma_f32_16x16x32_bf16 v[120:123], a[140:143], v[208:211], v[120:123]
  s_waitcnt lgkmcnt(12)
  v_fmac_f32 v57, v133, v178
  v_fmac_f32 v58, v134, v178
  v_mfma_f32_16x16x32_bf16 v[36:39], a[128:131], v[212:215], v[36:39]
  ds_read_b64_tr_b16 v[208:209], v244 offset:0
  ds_read_b64_tr_b16 v[210:211], v244 offset:1024
  v_mfma_f32_16x16x32_bf16 v[68:71], a[132:135], v[212:215], v[68:71]
  v_fmac_f32 v59, v135, v178
  v_max_f32 v24, 0, v24
  v_mfma_f32_16x16x32_bf16 v[100:103], a[136:139], v[212:215], v[100:103]
  v_add_u32 v245, 65536, v245
  v_max_f32 v25, 0, v25
  v_mfma_f32_16x16x32_bf16 v[124:127], a[140:143], v[212:215], v[124:127]
  s_waitcnt lgkmcnt(12)
  v_max_f32 v26, 0, v26
  v_max_f32 v27, 0, v27
  v_mfma_f32_16x16x32_bf16 v[32:35], a[144:147], v[216:219], v[32:35]
  ds_read_b64_tr_b16 v[212:213], v245 offset:0
  ds_read_b64_tr_b16 v[214:215], v245 offset:1024
  v_mfma_f32_16x16x32_bf16 v[64:67], a[148:151], v[216:219], v[64:67]
  buffer_load_dwordx4 a[140:143], v5, s[60:63], s45 offen offset:1024
  v_mul_f32 v24, v24, v56
  v_mfma_f32_16x16x32_bf16 v[96:99], a[152:155], v[216:219], v[96:99]
  v_mul_f32 v25, v25, v57
  v_mul_f32 v26, v26, v58
  v_mfma_f32_16x16x32_bf16 v[120:123], a[156:159], v[216:219], v[120:123]
  s_waitcnt lgkmcnt(12)
  v_mul_f32 v27, v27, v59
  v_cvt_pk_bf16_f32 v56, v24, v25
  v_mfma_f32_16x16x32_bf16 v[36:39], a[144:147], v[220:223], v[36:39]
  ds_read_b64_tr_b16 v[216:217], v244 offset:8192
  ds_read_b64_tr_b16 v[218:219], v244 offset:9216
  v_mfma_f32_16x16x32_bf16 v[68:71], a[148:151], v[220:223], v[68:71]
  v_cvt_pk_bf16_f32 v57, v26, v27
  v_fmac_f32 v28, v128, v179
  v_mfma_f32_16x16x32_bf16 v[100:103], a[152:155], v[220:223], v[100:103]
  v_fmac_f32 v29, v129, v179
  v_fmac_f32 v30, v130, v179
  v_mfma_f32_16x16x32_bf16 v[124:127], a[156:159], v[220:223], v[124:127]
  s_waitcnt lgkmcnt(12)
  v_fmac_f32 v31, v131, v179
  v_fmac_f32 v60, v132, v179
  v_mfma_f32_16x16x32_bf16 v[32:35], a[160:163], v[224:227], v[32:35]
  ds_read_b64_tr_b16 v[220:221], v245 offset:8192
  ds_read_b64_tr_b16 v[222:223], v245 offset:9216
  v_mfma_f32_16x16x32_bf16 v[64:67], a[164:167], v[224:227], v[64:67]
  buffer_load_dwordx4 a[156:159], v5, s[60:63], s46 offen offset:1024
  v_fmac_f32 v61, v133, v179
  v_mfma_f32_16x16x32_bf16 v[96:99], a[168:171], v[224:227], v[96:99]
  v_fmac_f32 v62, v134, v179
  v_fmac_f32 v63, v135, v179
  v_mfma_f32_16x16x32_bf16 v[120:123], a[172:175], v[224:227], v[120:123]
  s_waitcnt lgkmcnt(12)
  v_max_f32 v28, 0, v28
  v_max_f32 v29, 0, v29
  v_mfma_f32_16x16x32_bf16 v[36:39], a[160:163], v[228:231], v[36:39]
  ds_read_b64_tr_b16 v[224:225], v244 offset:16384
  ds_read_b64_tr_b16 v[226:227], v244 offset:17408
  v_mfma_f32_16x16x32_bf16 v[68:71], a[164:167], v[228:231], v[68:71]
  v_max_f32 v30, 0, v30
  v_max_f32 v31, 0, v31
  v_mfma_f32_16x16x32_bf16 v[100:103], a[168:171], v[228:231], v[100:103]
  v_mul_f32 v28, v28, v60
  v_mul_f32 v29, v29, v61
  v_mfma_f32_16x16x32_bf16 v[124:127], a[172:175], v[228:231], v[124:127]
  s_waitcnt lgkmcnt(12)
  v_mul_f32 v30, v30, v62
  v_mul_f32 v31, v31, v63
  v_mfma_f32_16x16x32_bf16 v[32:35], a[176:179], v[232:235], v[32:35]
  ds_read_b64_tr_b16 v[228:229], v245 offset:16384
  ds_read_b64_tr_b16 v[230:231], v245 offset:17408
  v_mfma_f32_16x16x32_bf16 v[64:67], a[180:183], v[232:235], v[64:67]
  buffer_load_dwordx4 a[172:175], v5, s[60:63], s47 offen offset:1024
  v_bfe_u32 v253, v1, 2, 2
  v_mfma_f32_16x16x32_bf16 v[96:99], a[184:187], v[232:235], v[96:99]
  v_lshl_add_u32 v253, v253, 7, v249
  v_cvt_pk_bf16_f32 v58, v28, v29
  v_mfma_f32_16x16x32_bf16 v[120:123], a[188:191], v[232:235], v[120:123]
  s_waitcnt lgkmcnt(12)
  v_cvt_pk_bf16_f32 v59, v30, v31
  v_fmac_f32 v88, v136, v178
  v_mfma_f32_16x16x32_bf16 v[36:39], a[176:179], v[236:239], v[36:39]
  ds_read_b64_tr_b16 v[232:233], v244 offset:24576
  ds_read_b64_tr_b16 v[234:235], v244 offset:25600
  v_mfma_f32_16x16x32_bf16 v[68:71], a[180:183], v[236:239], v[68:71]
  v_permlane16_swap_b32 v56, v58
  v_mfma_f32_16x16x32_bf16 v[100:103], a[184:187], v[236:239], v[100:103]
  v_permlane16_swap_b32 v57, v59
  v_mfma_f32_16x16x32_bf16 v[124:127], a[188:191], v[236:239], v[124:127]
  s_waitcnt lgkmcnt(12)
  buffer_store_dwordx4 v[56:59], v7, s[60:63], s9 offen sc1
  v_fmac_f32 v89, v137, v178
  v_mfma_f32_16x16x32_bf16 v[32:35], a[192:195], v[208:211], v[32:35]
  ds_read_b64_tr_b16 v[236:237], v245 offset:24576
  ds_read_b64_tr_b16 v[238:239], v245 offset:25600
  v_mfma_f32_16x16x32_bf16 v[64:67], a[196:199], v[208:211], v[64:67]
  buffer_load_dwordx4 a[188:191], v5, s[60:63], s48 offen offset:1024
  v_fmac_f32 v90, v138, v178
  v_mfma_f32_16x16x32_bf16 v[96:99], a[200:203], v[208:211], v[96:99]
  v_add_u32 v246, 65536, v246
  v_fmac_f32 v91, v139, v178
  v_mfma_f32_16x16x32_bf16 v[120:123], a[204:207], v[208:211], v[120:123]
  s_waitcnt lgkmcnt(12)
  buffer_load_dword v254, v253, s[60:63], s40 offen offset:0 sc1
  v_mfma_f32_16x16x32_bf16 v[36:39], a[192:195], v[212:215], v[36:39]
  ds_read_b64_tr_b16 v[208:209], v246 offset:0
  ds_read_b64_tr_b16 v[210:211], v246 offset:1024
  v_mfma_f32_16x16x32_bf16 v[68:71], a[196:199], v[212:215], v[68:71]
  v_fmac_f32 v92, v136, v179
  v_fmac_f32 v93, v137, v179
  v_mfma_f32_16x16x32_bf16 v[100:103], a[200:203], v[212:215], v[100:103]
  v_add_u32 v247, 65536, v247
  v_fmac_f32 v94, v138, v179
  v_mfma_f32_16x16x32_bf16 v[124:127], a[204:207], v[212:215], v[124:127]
  s_waitcnt lgkmcnt(12)
  v_fmac_f32 v95, v139, v179
  v_mfma_f32_16x16x32_bf16 v[32:35], a[208:211], v[216:219], v[32:35]
  ds_read_b64_tr_b16 v[212:213], v247 offset:0
  ds_read_b64_tr_b16 v[214:215], v247 offset:1024
  v_mfma_f32_16x16x32_bf16 v[64:67], a[212:215], v[216:219], v[64:67]
  buffer_load_dwordx4 a[204:207], v5, s[60:63], s44 offen offset:2048
  v_mfma_f32_16x16x32_bf16 v[96:99], a[216:219], v[216:219], v[96:99]
  v_permlane32_swap_b32 v88, v92
  v_mfma_f32_16x16x32_bf16 v[120:123], a[220:223], v[216:219], v[120:123]
  s_waitcnt lgkmcnt(12)
  v_permlane32_swap_b32 v89, v93
  v_mfma_f32_16x16x32_bf16 v[36:39], a[208:211], v[220:223], v[36:39]
  ds_read_b64_tr_b16 v[216:217], v246 offset:8192
  ds_read_b64_tr_b16 v[218:219], v246 offset:9216
  v_mfma_f32_16x16x32_bf16 v[68:71], a[212:215], v[220:223], v[68:71]
  v_permlane32_swap_b32 v90, v94
  v_mfma_f32_16x16x32_bf16 v[100:103], a[216:219], v[220:223], v[100:103]
  v_permlane32_swap_b32 v91, v95
  v_mfma_f32_16x16x32_bf16 v[124:127], a[220:223], v[220:223], v[124:127]
  s_waitcnt lgkmcnt(12)
  v_max_f32 v88, 0, v88
  v_max_f32 v89, 0, v89
  v_mfma_f32_16x16x32_bf16 v[32:35], a[224:227], v[224:227], v[32:35]
  ds_read_b64_tr_b16 v[220:221], v247 offset:8192
  ds_read_b64_tr_b16 v[222:223], v247 offset:9216
  v_mfma_f32_16x16x32_bf16 v[64:67], a[228:231], v[224:227], v[64:67]
  buffer_load_dwordx4 a[220:223], v5, s[60:63], s45 offen offset:2048
  v_max_f32 v90, 0, v90
  v_mfma_f32_16x16x32_bf16 v[96:99], a[232:235], v[224:227], v[96:99]
  v_max_f32 v91, 0, v91
  v_mul_f32 v88, v88, v92
  v_mfma_f32_16x16x32_bf16 v[120:123], a[236:239], v[224:227], v[120:123]
  s_waitcnt lgkmcnt(12)
  v_mul_f32 v89, v89, v93
  v_mul_f32 v90, v90, v94
  v_mfma_f32_16x16x32_bf16 v[36:39], a[224:227], v[228:231], v[36:39]
  ds_read_b64_tr_b16 v[224:225], v246 offset:16384
  ds_read_b64_tr_b16 v[226:227], v246 offset:17408
  v_mfma_f32_16x16x32_bf16 v[68:71], a[228:231], v[228:231], v[68:71]
  v_mul_f32 v91, v91, v95
  v_cvt_pk_bf16_f32 v92, v88, v89
  v_mfma_f32_16x16x32_bf16 v[100:103], a[232:235], v[228:231], v[100:103]
  v_cvt_pk_bf16_f32 v93, v90, v91
  v_mfma_f32_16x16x32_bf16 v[124:127], a[236:239], v[228:231], v[124:127]
  s_waitcnt lgkmcnt(12)
  buffer_store_dwordx2 v[92:93], v9, s[60:63], s9 offen sc1
  v_mfma_f32_16x16x32_bf16 v[32:35], a[240:243], v[232:235], v[32:35]
  ds_read_b64_tr_b16 v[228:229], v247 offset:16384
  ds_read_b64_tr_b16 v[230:231], v247 offset:17408
  v_mfma_f32_16x16x32_bf16 v[64:67], a[244:247], v[232:235], v[64:67]
  buffer_load_dwordx4 a[236:239], v5, s[60:63], s46 offen offset:2048
  v_mfma_f32_16x16x32_bf16 v[96:99], a[248:251], v[232:235], v[96:99]
  v_mfma_f32_16x16x32_bf16 v[120:123], a[252:255], v[232:235], v[120:123]
  s_waitcnt lgkmcnt(12)
  v_mfma_f32_16x16x32_bf16 v[36:39], a[240:243], v[236:239], v[36:39]
  ds_read_b64_tr_b16 v[232:233], v246 offset:24576
  ds_read_b64_tr_b16 v[234:235], v246 offset:25600
  v_mfma_f32_16x16x32_bf16 v[68:71], a[244:247], v[236:239], v[68:71]
  v_mfma_f32_16x16x32_bf16 v[100:103], a[248:251], v[236:239], v[100:103]
  v_mfma_f32_16x16x32_bf16 v[124:127], a[252:255], v[236:239], v[124:127]
  s_waitcnt lgkmcnt(12)
  v_mfma_f32_16x16x32_bf16 v[40:43], a[64:67], v[208:211], v[40:43]
  ds_read_b64_tr_b16 v[236:237], v247 offset:24576
  ds_read_b64_tr_b16 v[238:239], v247 offset:25600
  v_mfma_f32_16x16x32_bf16 v[72:75], a[68:71], v[208:211], v[72:75]
  buffer_load_dwordx4 a[252:255], v5, s[60:63], s47 offen offset:2048
  v_mfma_f32_16x16x32_bf16 v[104:107], a[72:75], v[208:211], v[104:107]
  s_waitcnt lgkmcnt(12)
  v_mul_f32 v189, 0xbacccccd, v120
  v_mul_f32 v190, 0xbacccccd, v124
  v_mfma_f32_16x16x32_bf16 v[44:47], a[64:67], v[212:215], v[44:47]
  ds_read_b64_tr_b16 v[208:209], v246 offset:32768
  ds_read_b64_tr_b16 v[210:211], v246 offset:33792
  v_mfma_f32_16x16x32_bf16 v[76:79], a[68:71], v[212:215], v[76:79]
  ds_write_b32 v187, v189 offset:16
  ds_write_b32 v188, v190 offset:16
  v_mfma_f32_16x16x32_bf16 v[108:111], a[72:75], v[212:215], v[108:111]
  s_waitcnt lgkmcnt(14)
  v_mfma_f32_16x16x32_bf16 v[40:43], a[80:83], v[216:219], v[40:43]
  ds_read_b64_tr_b16 v[212:213], v247 offset:32768
  ds_read_b64_tr_b16 v[214:215], v247 offset:33792
  v_mfma_f32_16x16x32_bf16 v[72:75], a[84:87], v[216:219], v[72:75]
  buffer_load_dwordx4 a[64:67], v5, s[60:63], s48 offen offset:2048
  v_mfma_f32_16x16x32_bf16 v[104:107], a[88:91], v[216:219], v[104:107]
  s_waitcnt lgkmcnt(14)
  v_mfma_f32_16x16x32_bf16 v[44:47], a[80:83], v[220:223], v[44:47]
  ds_read_b64_tr_b16 v[216:217], v246 offset:40960
  ds_read_b64_tr_b16 v[218:219], v246 offset:41984
  s_waitcnt lgkmcnt(4)
  s_barrier
  v_mfma_f32_16x16x32_bf16 v[76:79], a[84:87], v[220:223], v[76:79]
  ds_read_b32 v180, v10 offset:16
  ds_read_b32 v181, v184 offset:16
  v_mfma_f32_16x16x32_bf16 v[108:111], a[88:91], v[220:223], v[108:111]
  ds_read_b32 v182, v185 offset:16
  ds_read_b32 v183, v186 offset:16
  v_mfma_f32_16x16x32_bf16 v[40:43], a[96:99], v[224:227], v[40:43]
  ds_read_b64_tr_b16 v[220:221], v247 offset:40960
  ds_read_b64_tr_b16 v[222:223], v247 offset:41984
  v_mfma_f32_16x16x32_bf16 v[72:75], a[100:103], v[224:227], v[72:75]
  buffer_load_dwordx4 a[68:71], v5, s[60:63], s44 offen offset:3072
  v_mfma_f32_16x16x32_bf16 v[104:107], a[104:107], v[224:227], v[104:107]
  v_mfma_f32_16x16x32_bf16 v[44:47], a[96:99], v[228:231], v[44:47]
  s_add_u32 s8, s8, 229376
  ds_read_b64_tr_b16 v[224:225], v246 offset:49152
  ds_read_b64_tr_b16 v[226:227], v246 offset:50176
  v_mfma_f32_16x16x32_bf16 v[76:79], a[100:103], v[228:231], v[76:79]
  s_waitcnt lgkmcnt(7)
  v_fmac_f32 v32, v128, v180
  v_fmac_f32 v33, v129, v180
  v_mfma_f32_16x16x32_bf16 v[108:111], a[104:107], v[228:231], v[108:111]
  v_fmac_f32 v34, v130, v180
  v_fmac_f32 v35, v131, v180
  v_mfma_f32_16x16x32_bf16 v[40:43], a[112:115], v[232:235], v[40:43]
  ds_read_b64_tr_b16 v[228:229], v247 offset:49152
  ds_read_b64_tr_b16 v[230:231], v247 offset:50176
  v_mfma_f32_16x16x32_bf16 v[72:75], a[116:119], v[232:235], v[72:75]
  buffer_load_dwordx4 a[72:75], v5, s[60:63], s45 offen offset:3072
  v_fmac_f32 v64, v132, v180
  v_mfma_f32_16x16x32_bf16 v[104:107], a[120:123], v[232:235], v[104:107]
  v_fmac_f32 v65, v133, v180
  v_fmac_f32 v66, v134, v180
  v_mfma_f32_16x16x32_bf16 v[44:47], a[112:115], v[236:239], v[44:47]
  ds_read_b64_tr_b16 v[232:233], v246 offset:57344
  ds_read_b64_tr_b16 v[234:235], v246 offset:58368
  v_mfma_f32_16x16x32_bf16 v[76:79], a[116:119], v[236:239], v[76:79]
  v_fmac_f32 v67, v135, v180
  v_max_f32 v32, 0, v32
  v_mfma_f32_16x16x32_bf16 v[108:111], a[120:123], v[236:239], v[108:111]
  v_max_f32 v33, 0, v33
  v_max_f32 v34, 0, v34
  v_mfma_f32_16x16x32_bf16 v[40:43], a[128:131], v[208:211], v[40:43]
  ds_read_b64_tr_b16 v[236:237], v247 offset:57344
  ds_read_b64_tr_b16 v[238:239], v247 offset:58368
  v_mfma_f32_16x16x32_bf16 v[72:75], a[132:135], v[208:211], v[72:75]
  buffer_load_dwordx4 a[80:83], v5, s[60:63], s46 offen offset:3072
  v_max_f32 v35, 0, v35
  v_mfma_f32_16x16x32_bf16 v[104:107], a[136:139], v[208:211], v[104:107]
  v_add_u32 v246, 65536, v246
  v_mul_f32 v32, v32, v64
  v_mfma_f32_16x16x32_bf16 v[44:47], a[128:131], v[212:215], v[44:47]
  ds_read_b64_tr_b16 v[208:209], v246 offset:0
  ds_read_b64_tr_b16 v[210:211], v246 offset:1024
  v_mfma_f32_16x16x32_bf16 v[76:79], a[132:135], v[212:215], v[76:79]
  v_mul_f32 v33, v33, v65
  v_mul_f32 v34, v34, v66
  v_mfma_f32_16x16x32_bf16 v[108:111], a[136:139], v[212:215], v[108:111]
  v_add_u32 v247, 65536, v247
  v_mul_f32 v35, v35, v67
  v_mfma_f32_16x16x32_bf16 v[40:43], a[144:147], v[216:219], v[40:43]
  ds_read_b64_tr_b16 v[212:213], v247 offset:0
  ds_read_b64_tr_b16 v[214:215], v247 offset:1024
  v_mfma_f32_16x16x32_bf16 v[72:75], a[148:151], v[216:219], v[72:75]
  s_waitcnt vmcnt(9)
  v_cmp_ne_u32 vcc, s100, v254
  s_cbranch_vccz FX_ok
  s_waitcnt lgkmcnt(0)
  s_mov_b32 s11, 20000
  buffer_load_dword v254, v253, s[60:63], s40 offen offset:0 sc1
FX_spin:
  s_waitcnt vmcnt(0)
  v_cmp_ne_u32 vcc, s100, v254
  s_cbranch_vccz FX_done
  buffer_load_dword v254, v253, s[60:63], s40 offen offset:0 sc1
  s_sub_u32 s11, s11, 1
  s_cbranch_scc0 FX_spin
  s_waitcnt vmcnt(0)
FX_done:
FX_ok:
  v_mfma_f32_16x16x32_bf16 v[104:107], a[152:155], v[216:219], v[104:107]
  s_waitcnt lgkmcnt(12)
  buffer_load_dwordx4 a[84:87], v5, s[60:63], s47 offen offset:3072
  v_cvt_pk_bf16_f32 v64, v32, v33
  v_mfma_f32_16x16x32_bf16 v[44:47], a[144:147], v[220:223], v[44:47]
  ds_read_b64_tr_b16 v[216:217], v246 offset:8192
  ds_read_b64_tr_b16 v[218:219], v246 offset:9216
  v_mfma_f32_16x16x32_bf16 v[76:79], a[148:151], v[220:223], v[76:79]
  v_cvt_pk_bf16_f32 v65, v34, v35
  v_fmac_f32 v36, v128, v181
  v_mfma_f32_16x16x32_bf16 v[108:111], a[152:155], v[220:223], v[108:111]
  s_waitcnt lgkmcnt(12)
  v_fmac_f32 v37, v129, v181
  v_fmac_f32 v38, v130, v181
  v_mfma_f32_16x16x32_bf16 v[40:43], a[160:163], v[224:227], v[40:43]
  ds_read_b64_tr_b16 v[220:221], v247 offset:8192
  ds_read_b64_tr_b16 v[222:223], v247 offset:9216
  v_mfma_f32_16x16x32_bf16 v[72:75], a[164:167], v[224:227], v[72:75]
  buffer_load_dwordx4 a[88:91], v5, s[60:63], s48 offen offset:3072
  v_fmac_f32 v39, v131, v181
  v_mfma_f32_16x16x32_bf16 v[104:107], a[168:171], v[224:227], v[104:107]
  s_waitcnt lgkmcnt(12)
  v_fmac_f32 v68, v132, v181
  v_fmac_f32 v69, v133, v181
  v_mfma_f32_16x16x32_bf16 v[44:47], a[160:163], v[228:231], v[44:47]
  ds_read_b64_tr_b16 v[224:225], v246 offset:16384
  ds_read_b64_tr_b16 v[226:227], v246 offset:17408
  v_mfma_f32_16x16x32_bf16 v[76:79], a[164:167], v[228:231], v[76:79]
  v_fmac_f32 v70, v134, v181
  v_fmac_f32 v71, v135, v181
  v_mfma_f32_16x16x32_bf16 v[108:111], a[168:171], v[228:231], v[108:111]
  s_waitcnt lgkmcnt(12)
  v_max_f32 v36, 0, v36
  v_max_f32 v37, 0, v37
  v_mfma_f32_16x16x32_bf16 v[40:43], a[176:179], v[232:235], v[40:43]
  ds_read_b64_tr_b16 v[228:229], v247 offset:16384
  ds_read_b64_tr_b16 v[230:231], v247 offset:17408
  v_mfma_f32_16x16x32_bf16 v[72:75], a[180:183], v[232:235], v[72:75]
  s_add_u32 s44, s44, 0x1000
  buffer_load_dwordx4 a[96:99], v5, s[60:63], s44 offen offset:0
  v_max_f32 v38, 0, v38
  v_mfma_f32_16x16x32_bf16 v[104:107], a[184:187], v[232:235], v[104:107]
  s_waitcnt lgkmcnt(12)
  v_max_f32 v39, 0, v39
  v_mul_f32 v36, v36, v68
  v_mfma_f32_16x16x32_bf16 v[44:47], a[176:179], v[236:239], v[44:47]
  ds_read_b64_tr_b16 v[232:233], v246 offset:24576
  ds_read_b64_tr_b16 v[234:235], v246 offset:25600
  v_mfma_f32_16x16x32_bf16 v[76:79], a[180:183], v[236:239], v[76:79]
  v_mul_f32 v37, v37, v69
  v_mul_f32 v38, v38, v70
  v_mfma_f32_16x16x32_bf16 v[108:111], a[184:187], v[236:239], v[108:111]
  s_waitcnt lgkmcnt(12)
  v_mul_f32 v39, v39, v71
  v_cvt_pk_bf16_f32 v66, v36, v37
  v_mfma_f32_16x16x32_bf16 v[40:43], a[192:195], v[208:211], v[40:43]
  ds_read_b64_tr_b16 v[236:237], v247 offset:24576
  ds_read_b64_tr_b16 v[238:239], v247 offset:25600
  v_mfma_f32_16x16x32_bf16 v[72:75], a[196:199], v[208:211], v[72:75]
  s_add_u32 s45, s45, 0x1000
  buffer_load_dwordx4 a[100:103], v5, s[60:63], s45 offen offset:0
  ds_read_b128 a[176:179], v191 offset:0
  v_mfma_f32_16x16x32_bf16 v[104:107], a[200:203], v[208:211], v[104:107]
  s_waitcnt lgkmcnt(13)
  ds_read_b128 a[180:183], v191 offset:1024
  ds_read_b128 a[184:187], v191 offset:2048
  v_mfma_f32_16x16x32_bf16 v[44:47], a[192:195], v[212:215], v[44:47]
  v_cvt_pk_bf16_f32 v67, v38, v39
  v_fmac_f32 v96, v136, v180
  v_mfma_f32_16x16x32_bf16 v[76:79], a[196:199], v[212:215], v[76:79]
  v_permlane16_swap_b32 v64, v66
  v_mfma_f32_16x16x32_bf16 v[108:111], a[200:203], v[212:215], v[108:111]
  s_waitcnt lgkmcnt(13)
  v_permlane16_swap_b32 v65, v67
  v_mfma_f32_16x16x32_bf16 v[40:43], a[208:211], v[216:219], v[40:43]
  s_add_u32 s46, s46, 0x1000
  buffer_load_dwordx4 a[104:107], v5, s[60:63], s46 offen offset:0
  ds_read_b128 a[192:195], v191 offset:3072
  v_mfma_f32_16x16x32_bf16 v[72:75], a[212:215], v[216:219], v[72:75]
  ds_read_b128 a[196:199], v191 offset:4096
  ds_read_b128 a[200:203], v191 offset:5120
  v_mfma_f32_16x16x32_bf16 v[104:107], a[216:219], v[216:219], v[104:107]
  s_waitcnt lgkmcnt(14)
  buffer_store_dwordx4 v[64:67], v7, s[60:63], s8 offen sc1
  v_fmac_f32 v97, v137, v180
  v_mfma_f32_16x16x32_bf16 v[44:47], a[208:211], v[220:223], v[44:47]
  v_fmac_f32 v98, v138, v180
  v_fmac_f32 v99, v139, v180
  v_mfma_f32_16x16x32_bf16 v[76:79], a[212:215], v[220:223], v[76:79]
  v_fmac_f32 v120, v140, v180
  v_fmac_f32 v121, v141, v180
  v_mfma_f32_16x16x32_bf16 v[108:111], a[216:219], v[220:223], v[108:111]
  s_waitcnt lgkmcnt(12)
  buffer_load_dwordx4 v[16:19], v5, s[60:63], s24 offen offset:0
  v_fmac_f32 v122, v142, v180
  v_mfma_f32_16x16x32_bf16 v[40:43], a[224:227], v[224:227], v[40:43]
  ds_read_b128 a[208:211], v191 offset:6144
  ds_read_b128 a[212:215], v191 offset:7168
  v_mfma_f32_16x16x32_bf16 v[72:75], a[228:231], v[224:227], v[72:75]
  ds_read_b128 a[216:219], v191 offset:8192
  v_fmac_f32 v123, v143, v180
  v_mfma_f32_16x16x32_bf16 v[104:107], a[232:235], v[224:227], v[104:107]
  s_waitcnt lgkmcnt(13)
  v_permlane32_swap_b32 v96, v120
  v_mfma_f32_16x16x32_bf16 v[44:47], a[224:227], v[228:231], v[44:47]
  v_permlane32_swap_b32 v97, v121
  v_mfma_f32_16x16x32_bf16 v[76:79], a[228:231], v[228:231], v[76:79]
  buffer_load_dwordx4 v[48:51], v5, s[60:63], s25 offen offset:0
  v_max_f32 v96, 0, v96
  v_mfma_f32_16x16x32_bf16 v[108:111], a[232:235], v[228:231], v[108:111]
  s_waitcnt lgkmcnt(11)
  v_permlane32_swap_b32 v98, v122
  v_mfma_f32_16x16x32_bf16 v[40:43], a[240:243], v[232:235], v[40:43]
  ds_read_b128 a[224:227], v191 offset:9216
  ds_read_b128 a[228:231], v191 offset:10240
  v_mfma_f32_16x16x32_bf16 v[72:75], a[244:247], v[232:235], v[72:75]
  ds_read_b128 a[232:235], v191 offset:11264
  v_max_f32 v97, 0, v97
  v_mfma_f32_16x16x32_bf16 v[104:107], a[248:251], v[232:235], v[104:107]
  s_waitcnt lgkmcnt(12)
  v_permlane32_swap_b32 v99, v123
  v_mfma_f32_16x16x32_bf16 v[44:47], a[240:243], v[236:239], v[44:47]
  buffer_load_dwordx4 v[80:83], v5, s[60:63], s24 offen offset:1024
  v_max_f32 v98, 0, v98
  v_mfma_f32_16x16x32_bf16 v[76:79], a[244:247], v[236:239], v[76:79]
  v_max_f32 v99, 0, v99
  v_mul_f32 v96, v96, v120
  v_mfma_f32_16x16x32_bf16 v[108:111], a[248:251], v[236:239], v[108:111]
  v_mul_f32 v97, v97, v121
  v_mul_f32 v98, v98, v122
  s_lshl_b32 s4, s15, 2
  s_add_u32 s4, s4, s21
  v_and_b32 v2, 15, v1
  v_lshl_add_u32 v3, v2, 5, s4
  ds_read_b32 v13, v3
  v_lshlrev_b32 v2, 5, v2
  ds_read_b128 a[240:243], v191 offset:12288
  ds_read_b128 a[244:247], v191 offset:13312
  ds_read_b128 a[248:251], v191 offset:14336
  v_mul_f32 v99, v99, v123
  v_cvt_pk_bf16_f32 v120, v96, v97
  v_cvt_pk_bf16_f32 v121, v98, v99
  v_fmac_f32 v100, v136, v181
  v_fmac_f32 v101, v137, v181
  v_fmac_f32 v102, v138, v181
  v_fmac_f32 v103, v139, v181
  buffer_load_dwordx4 v[112:115], v5, s[60:63], s25 offen offset:1024
  v_fmac_f32 v124, v140, v181
  v_fmac_f32 v125, v141, v181
  v_fmac_f32 v126, v142, v181
  v_fmac_f32 v127, v143, v181
  v_permlane32_swap_b32 v100, v124
  v_permlane32_swap_b32 v101, v125
  v_permlane32_swap_b32 v102, v126
  v_permlane32_swap_b32 v103, v127
  v_max_f32 v100, 0, v100
  v_max_f32 v101, 0, v101
  buffer_load_dwordx4 v[20:23], v5, s[60:63], s24 offen offset:2048
  v_max_f32 v102, 0, v102
  v_max_f32 v103, 0, v103
  v_mul_f32 v100, v100, v124
  v_mul_f32 v101, v101, v125
  v_mul_f32 v102, v102, v126
  v_mul_f32 v103, v103, v127
  v_cvt_pk_bf16_f32 v122, v100, v101
  v_cvt_pk_bf16_f32 v123, v102, v103
  s_nop 0
  v_permlane16_swap_b32 v120, v122
  v_permlane16_swap_b32 v121, v123
  buffer_load_dwordx4 v[52:55], v5, s[60:63], s25 offen offset:2048
  buffer_store_dwordx4 v[120:123], v8, s[60:63], s8 offen sc1
  s_add_u32 s9, s9, 229376
  v_pk_fma_f32 v[40:41], v[128:129], v[182:183], v[40:41] op_sel:[0,0,0] op_sel_hi:[1,0,1]
  v_pk_fma_f32 v[42:43], v[130:131], v[182:183], v[42:43] op_sel:[0,0,0] op_sel_hi:[1,0,1]
  v_pk_fma_f32 v[72:73], v[132:133], v[182:183], v[72:73] op_sel:[0,0,0] op_sel_hi:[1,0,1]
  v_pk_fma_f32 v[74:75], v[134:135], v[182:183], v[74:75] op_sel:[0,0,0] op_sel_hi:[1,0,1]
  v_max_f32 v40, 0, v40
  v_max_f32 v41, 0, v41
  v_max_f32 v42, 0, v42
  v_max_f32 v43, 0, v43
  buffer_load_dwordx4 v[84:87], v5, s[60:63], s24 offen offset:3072
  v_pk_mul_f32 v[40:41], v[40:41], v[72:73]
  v_pk_mul_f32 v[42:43], v[42:43], v[74:75]
  v_cvt_pk_bf16_f32 v72, v40, v41
  v_cvt_pk_bf16_f32 v73, v42, v43
  v_pk_fma_f32 v[44:45], v[128:129], v[182:183], v[44:45] op_sel:[0,1,0] op_sel_hi:[1,1,1]
  v_pk_fma_f32 v[46:47], v[130:131], v[182:183], v[46:47] op_sel:[0,1,0] op_sel_hi:[1,1,1]
  v_pk_fma_f32 v[76:77], v[132:133], v[182:183], v[76:77] op_sel:[0,1,0] op_sel_hi:[1,1,1]
  v_pk_fma_f32 v[78:79], v[134:135], v[182:183], v[78:79] op_sel:[0,1,0] op_sel_hi:[1,1,1]
  v_max_f32 v44, 0, v44
  v_max_f32 v45, 0, v45
  buffer_load_dwordx4 v[116:119], v5, s[60:63], s25 offen offset:3072
  v_max_f32 v46, 0, v46
  v_max_f32 v47, 0, v47
  v_pk_mul_f32 v[44:45], v[44:45], v[76:77]
  v_pk_mul_f32 v[46:47], v[46:47], v[78:79]
  v_cvt_pk_bf16_f32 v74, v44, v45
  v_cvt_pk_bf16_f32 v75, v46, v47
  s_nop 0
  v_permlane16_swap_b32 v72, v74
  v_permlane16_swap_b32 v73, v75
  buffer_store_dwordx4 v[72:75], v7, s[60:63], s9 offen sc1
  v_pk_fma_f32 v[104:105], v[136:137], v[182:183], v[104:105] op_sel:[0,0,0] op_sel_hi:[1,0,1]
  s_add_u32 s24, s24, 0x1000
  buffer_load_dwordx4 v[24:27], v5, s[60:63], s24 offen offset:0
  v_pk_fma_f32 v[106:107], v[138:139], v[182:183], v[106:107] op_sel:[0,0,0] op_sel_hi:[1,0,1]
  v_pk_fma_f32 v[108:109], v[136:137], v[182:183], v[108:109] op_sel:[0,1,0] op_sel_hi:[1,1,1]
  v_pk_fma_f32 v[110:111], v[138:139], v[182:183], v[110:111] op_sel:[0,1,0] op_sel_hi:[1,1,1]
  s_nop 0
  v_permlane32_swap_b32 v104, v108
  v_permlane32_swap_b32 v105, v109
  v_permlane32_swap_b32 v106, v110
  v_permlane32_swap_b32 v107, v111
  v_max_f32 v104, 0, v104
  v_max_f32 v105, 0, v105
  v_max_f32 v106, 0, v106
  s_add_u32 s25, s25, 0x1000
  buffer_load_dwordx4 v[56:59], v5, s[60:63], s25 offen offset:0
  v_max_f32 v107, 0, v107
  v_pk_mul_f32 v[104:105], v[104:105], v[108:109]
  v_pk_mul_f32 v[106:107], v[106:107], v[110:111]
  v_cvt_pk_bf16_f32 v108, v104, v105
  v_cvt_pk_bf16_f32 v109, v106, v107
  buffer_store_dwordx2 v[108:109], v9, s[60:63], s9 offen sc1
  s_waitcnt vmcnt(11)
  v_max3_u32 v252, v16, v18, v48
  v_max_u32 v252, v252, v50
  v_cmp_eq_u32 vcc, -1, v252
  s_cbranch_vccnz HC0_0_slow
HC0_0_back:
  v_mfma_f32_16x16x32_bf16 v[208:211], a[0:3], v[16:19], 0
  buffer_load_dwordx4 v[88:91], v5, s[60:63], s24 offen offset:1024
  v_mfma_f32_16x16x32_bf16 v[212:215], a[4:7], v[16:19], 0
  v_mfma_f32_16x16x32_bf16 v[216:219], a[8:11], v[16:19], 0
  v_mfma_f32_16x16x32_bf16 v[220:223], a[12:15], v[16:19], 0
  buffer_load_dwordx4 v[28:31], v5, s[60:63], s25 offen offset:1024
  v_mfma_f32_16x16x32_bf16 v[224:227], a[16:19], v[16:19], 0
  s_waitcnt vmcnt(11)
  v_max3_u32 v252, v80, v82, v112
  v_max_u32 v252, v252, v114
  v_mfma_f32_16x16x32_bf16 v[228:231], a[0:3], v[48:51], 0
  v_cmp_eq_u32 vcc, -1, v252
  v_mfma_f32_16x16x32_bf16 v[232:235], a[4:7], v[48:51], 0
  s_cbranch_vccnz HC0_1_slow
HC0_1_back:
  buffer_load_dwordx4 v[60:63], v5, s[60:63], s24 offen offset:2048
  v_mfma_f32_16x16x32_bf16 v[236:239], a[8:11], v[48:51], 0
  v_mfma_f32_16x16x32_bf16 v[240:243], a[12:15], v[48:51], 0
  v_mfma_f32_16x16x32_bf16 v[244:247], a[16:19], v[48:51], 0
  buffer_load_dwordx4 v[92:95], v5, s[60:63], s25 offen offset:2048
  v_mfma_f32_16x16x32_bf16 v[208:211], a[20:23], v[80:83], v[208:211]
  v_mfma_f32_16x16x32_bf16 v[212:215], a[24:27], v[80:83], v[212:215]
  v_mfma_f32_16x16x32_bf16 v[216:219], a[28:31], v[80:83], v[216:219]
  buffer_load_dwordx4 v[32:35], v5, s[60:63], s24 offen offset:3072
  v_mfma_f32_16x16x32_bf16 v[220:223], a[32:35], v[80:83], v[220:223]
  v_mfma_f32_16x16x32_bf16 v[224:227], a[36:39], v[80:83], v[224:227]
  s_waitcnt vmcnt(12)
  v_max3_u32 v252, v20, v22, v52
  v_max_u32 v252, v252, v54
  v_mfma_f32_16x16x32_bf16 v[228:231], a[20:23], v[112:115], v[228:231]
  buffer_load_dwordx4 v[64:67], v5, s[60:63], s25 offen offset:3072
  v_cmp_eq_u32 vcc, -1, v252
  v_mfma_f32_16x16x32_bf16 v[232:235], a[24:27], v[112:115], v[232:235]
  s_cbranch_vccnz HC0_2_slow
HC0_2_back:
  v_mfma_f32_16x16x32_bf16 v[236:239], a[28:31], v[112:115], v[236:239]
  v_mfma_f32_16x16x32_bf16 v[240:243], a[32:35], v[112:115], v[240:243]
  s_add_u32 s24, s24, 0x1000
  buffer_load_dwordx4 v[96:99], v5, s[60:63], s24 offen offset:0
  v_mfma_f32_16x16x32_bf16 v[244:247], a[36:39], v[112:115], v[244:247]
  v_mfma_f32_16x16x32_bf16 v[208:211], a[40:43], v[20:23], v[208:211]
  v_mfma_f32_16x16x32_bf16 v[212:215], a[44:47], v[20:23], v[212:215]
  s_add_u32 s25, s25, 0x1000
  buffer_load_dwordx4 v[120:123], v5, s[60:63], s25 offen offset:0
  v_mfma_f32_16x16x32_bf16 v[216:219], a[48:51], v[20:23], v[216:219]
  v_mfma_f32_16x16x32_bf16 v[220:223], a[52:55], v[20:23], v[220:223]
  v_mfma_f32_16x16x32_bf16 v[224:227], a[56:59], v[20:23], v[224:227]
  s_waitcnt vmcnt(12)
  buffer_load_dwordx4 v[36:39], v5, s[60:63], s24 offen offset:1024
  v_max3_u32 v252, v84, v86, v116
  v_mfma_f32_16x16x32_bf16 v[228:231], a[40:43], v[52:55], v[228:231]
  v_max_u32 v252, v252, v118
  v_cmp_eq_u32 vcc, -1, v252
  v_mfma_f32_16x16x32_bf16 v[232:235], a[44:47], v[52:55], v[232:235]
  s_cbranch_vccnz HC0_3_slow
HC0_3_back:
  v_mfma_f32_16x16x32_bf16 v[236:239], a[48:51], v[52:55], v[236:239]
  buffer_load_dwordx4 v[68:71], v5, s[60:63], s25 offen offset:1024
  v_mfma_f32_16x16x32_bf16 v[240:243], a[52:55], v[52:55], v[240:243]
  v_mfma_f32_16x16x32_bf16 v[244:247], a[56:59], v[52:55], v[244:247]
  v_mfma_f32_16x16x32_bf16 v[208:211], a[60:63], v[84:87], v[208:211]
  s_add_u32 s47, s47, 0x1000
  buffer_load_dwordx4 a[112:115], v5, s[60:63], s47 offen offset:0
  v_mfma_f32_16x16x32_bf16 v[212:215], v[152:155], v[84:87], v[212:215]
  v_mfma_f32_16x16x32_bf16 v[216:219], v[156:159], v[84:87], v[216:219]
  v_mfma_f32_16x16x32_bf16 v[220:223], v[160:163], v[84:87], v[220:223]
  s_add_u32 s48, s48, 0x1000
  buffer_load_dwordx4 a[116:119], v5, s[60:63], s48 offen offset:0
  v_mfma_f32_16x16x32_bf16 v[224:227], v[164:167], v[84:87], v[224:227]
  s_waitcnt vmcnt(13)
  v_max3_u32 v252, v24, v26, v56
  v_max_u32 v252, v252, v58
  v_mfma_f32_16x16x32_bf16 v[228:231], a[60:63], v[116:119], v[228:231]
  v_cmp_eq_u32 vcc, -1, v252
  v_mfma_f32_16x16x32_bf16 v[232:235], v[152:155], v[116:119], v[232:235]
  s_cbranch_vccnz HC0_4_slow
HC0_4_back:
  buffer_load_dwordx4 v[100:103], v5, s[60:63], s24 offen offset:2048
  v_mfma_f32_16x16x32_bf16 v[236:239], v[156:159], v[116:119], v[236:239]
  v_mfma_f32_16x16x32_bf16 v[240:243], v[160:163], v[116:119], v[240:243]
  v_mfma_f32_16x16x32_bf16 v[244:247], v[164:167], v[116:119], v[244:247]
  s_waitcnt lgkmcnt(0)
  s_barrier
  v_mfma_f32_16x16x32_bf16 v[208:211], v[168:171], v[24:27], v[208:211]
  buffer_load_dwordx4 a[120:123], v5, s[60:63], s44 offen offset:1024
  v_mfma_f32_16x16x32_bf16 v[212:215], v[172:175], v[24:27], v[212:215]
  v_mfma_f32_16x16x32_bf16 v[216:219], a[76:79], v[24:27], v[216:219]
  v_mfma_f32_16x16x32_bf16 v[220:223], a[92:95], v[24:27], v[220:223]
  buffer_load_dwordx4 v[124:127], v5, s[60:63], s25 offen offset:2048
  v_mfma_f32_16x16x32_bf16 v[224:227], a[108:111], v[24:27], v[224:227]
  s_waitcnt vmcnt(13)
  v_max3_u32 v252, v88, v90, v28
  v_max_u32 v252, v252, v30
  v_mfma_f32_16x16x32_bf16 v[228:231], v[168:171], v[56:59], v[228:231]
  v_cmp_eq_u32 vcc, -1, v252
  v_mfma_f32_16x16x32_bf16 v[232:235], v[172:175], v[56:59], v[232:235]
  s_cbranch_vccnz HC0_5_slow
HC0_5_back:
  buffer_load_dwordx4 a[128:131], v5, s[60:63], s45 offen offset:1024
  v_mfma_f32_16x16x32_bf16 v[236:239], a[76:79], v[56:59], v[236:239]
  v_mfma_f32_16x16x32_bf16 v[240:243], a[92:95], v[56:59], v[240:243]
  v_mfma_f32_16x16x32_bf16 v[244:247], a[108:111], v[56:59], v[244:247]
  buffer_load_dwordx4 a[132:135], v5, s[60:63], s46 offen offset:1024
  v_mfma_f32_16x16x32_bf16 v[208:211], a[124:127], v[88:91], v[208:211]
  v_mfma_f32_16x16x32_bf16 v[212:215], a[140:143], v[88:91], v[212:215]
  v_mfma_f32_16x16x32_bf16 v[216:219], a[156:159], v[88:91], v[216:219]
  buffer_load_dwordx4 a[136:139], v5, s[60:63], s47 offen offset:1024
  v_mfma_f32_16x16x32_bf16 v[220:223], a[172:175], v[88:91], v[220:223]
  v_mfma_f32_16x16x32_bf16 v[224:227], a[188:191], v[88:91], v[224:227]
  s_waitcnt vmcnt(14)
  v_max3_u32 v252, v60, v62, v92
  v_max_u32 v252, v252, v94
  v_mfma_f32_16x16x32_bf16 v[228:231], a[124:127], v[28:31], v[228:231]
  buffer_load_dwordx4 a[144:147], v5, s[60:63], s48 offen offset:1024
  v_cmp_eq_u32 vcc, -1, v252
  v_mfma_f32_16x16x32_bf16 v[232:235], a[140:143], v[28:31], v[232:235]
  s_cbranch_vccnz HC0_6_slow
HC0_6_back:
  v_mfma_f32_16x16x32_bf16 v[236:239], a[156:159], v[28:31], v[236:239]
  v_mfma_f32_16x16x32_bf16 v[240:243], a[172:175], v[28:31], v[240:243]
  buffer_load_dwordx4 v[40:43], v5, s[60:63], s24 offen offset:3072
  v_mfma_f32_16x16x32_bf16 v[244:247], a[188:191], v[28:31], v[244:247]
  v_mfma_f32_16x16x32_bf16 v[208:211], a[204:207], v[60:63], v[208:211]
  v_mfma_f32_16x16x32_bf16 v[212:215], a[220:223], v[60:63], v[212:215]
  buffer_load_dwordx4 a[148:151], v5, s[60:63], s44 offen offset:2048
  v_mfma_f32_16x16x32_bf16 v[216:219], a[236:239], v[60:63], v[216:219]
  v_mfma_f32_16x16x32_bf16 v[220:223], a[252:255], v[60:63], v[220:223]
  v_mfma_f32_16x16x32_bf16 v[224:227], a[64:67], v[60:63], v[224:227]
  s_waitcnt vmcnt(15)
  buffer_load_dwordx4 v[72:75], v5, s[60:63], s25 offen offset:3072
  v_max3_u32 v252, v32, v34, v64
  v_mfma_f32_16x16x32_bf16 v[228:231], a[204:207], v[92:95], v[228:231]
  v_max_u32 v252, v252, v66
  v_cmp_eq_u32 vcc, -1, v252
  v_mfma_f32_16x16x32_bf16 v[232:235], a[220:223], v[92:95], v[232:235]
  s_cbranch_vccnz HC0_7_slow
HC0_7_back:
  v_mfma_f32_16x16x32_bf16 v[236:239], a[236:239], v[92:95], v[236:239]
  buffer_load_dwordx4 a[152:155], v5, s[60:63], s45 offen offset:2048
  v_mfma_f32_16x16x32_bf16 v[240:243], a[252:255], v[92:95], v[240:243]
  v_mfma_f32_16x16x32_bf16 v[244:247], a[64:67], v[92:95], v[244:247]
  v_mfma_f32_16x16x32_bf16 v[208:211], a[68:71], v[32:35], v[208:211]
  buffer_load_dwordx4 a[160:163], v5, s[60:63], s46 offen offset:2048
  v_mfma_f32_16x16x32_bf16 v[212:215], a[72:75], v[32:35], v[212:215]
  v_mfma_f32_16x16x32_bf16 v[216:219], a[80:83], v[32:35], v[216:219]
  v_mfma_f32_16x16x32_bf16 v[220:223], a[84:87], v[32:35], v[220:223]
  buffer_load_dwordx4 a[164:167], v5, s[60:63], s47 offen offset:2048
  v_mfma_f32_16x16x32_bf16 v[224:227], a[88:91], v[32:35], v[224:227]
  s_waitcnt vmcnt(17)
  v_max3_u32 v252, v96, v98, v120
  v_max_u32 v252, v252, v122
  v_mfma_f32_16x16x32_bf16 v[228:231], a[68:71], v[64:67], v[228:231]
  v_cmp_eq_u32 vcc, -1, v252
  v_mfma_f32_16x16x32_bf16 v[232:235], a[72:75], v[64:67], v[232:235]
  s_cbranch_vccnz HC0_8_slow
HC0_8_back:
  buffer_load_dwordx4 a[168:171], v5, s[60:63], s48 offen offset:2048
  v_mfma_f32_16x16x32_bf16 v[236:239], a[80:83], v[64:67], v[236:239]
  v_mfma_f32_16x16x32_bf16 v[240:243], a[84:87], v[64:67], v[240:243]
  v_mfma_f32_16x16x32_bf16 v[244:247], a[88:91], v[64:67], v[244:247]
  s_add_u32 s24, s24, 0x1000
  buffer_load_dwordx4 v[104:107], v5, s[60:63], s24 offen offset:0
  v_mfma_f32_16x16x32_bf16 v[208:211], a[96:99], v[96:99], v[208:211]
  v_mfma_f32_16x16x32_bf16 v[212:215], a[100:103], v[96:99], v[212:215]
  v_mfma_f32_16x16x32_bf16 v[216:219], a[104:107], v[96:99], v[216:219]
  s_waitcnt vmcnt(16)
  s_add_u32 s25, s25, 0x1000
  buffer_load_dwordx4 v[44:47], v5, s[60:63], s25 offen offset:0
  v_mfma_f32_16x16x32_bf16 v[220:223], a[112:115], v[96:99], v[220:223]
  s_waitcnt vmcnt(16)
  v_mfma_f32_16x16x32_bf16 v[224:227], a[116:119], v[96:99], v[224:227]
  v_max3_u32 v252, v36, v38, v68
  v_max_u32 v252, v252, v70
  v_mfma_f32_16x16x32_bf16 v[228:231], a[96:99], v[120:123], v[228:231]
  buffer_load_dwordx4 v[76:79], v5, s[60:63], s24 offen offset:1024
  v_cmp_eq_u32 vcc, -1, v252
  v_mfma_f32_16x16x32_bf16 v[232:235], a[100:103], v[120:123], v[232:235]
  s_cbranch_vccnz HC0_9_slow
HC0_9_back:
  v_mfma_f32_16x16x32_bf16 v[236:239], a[104:107], v[120:123], v[236:239]
  v_mfma_f32_16x16x32_bf16 v[240:243], a[112:115], v[120:123], v[240:243]
  buffer_load_dwordx4 v[108:111], v5, s[60:63], s25 offen offset:1024
  v_mfma_f32_16x16x32_bf16 v[244:247], a[116:119], v[120:123], v[244:247]
  s_waitcnt vmcnt(16)
  v_mfma_f32_16x16x32_bf16 v[208:211], a[120:123], v[36:39], v[208:211]
  s_waitcnt vmcnt(14)
  v_mfma_f32_16x16x32_bf16 v[212:215], a[128:131], v[36:39], v[212:215]
  s_waitcnt vmcnt(13)
  buffer_load_dwordx4 v[16:19], v5, s[60:63], s26 offen offset:0
  v_mfma_f32_16x16x32_bf16 v[216:219], a[132:135], v[36:39], v[216:219]
  s_waitcnt vmcnt(13)
  v_mfma_f32_16x16x32_bf16 v[220:223], a[136:139], v[36:39], v[220:223]
  s_waitcnt vmcnt(12)
  v_mfma_f32_16x16x32_bf16 v[224:227], a[144:147], v[36:39], v[224:227]
  buffer_load_dwordx4 v[48:51], v5, s[60:63], s27 offen offset:0
  v_max3_u32 v252, v100, v102, v124
  v_mfma_f32_16x16x32_bf16 v[228:231], a[120:123], v[68:71], v[228:231]
  v_max_u32 v252, v252, v126
  v_cmp_eq_u32 vcc, -1, v252
  v_mfma_f32_16x16x32_bf16 v[232:235], a[128:131], v[68:71], v[232:235]
  s_cbranch_vccnz HC0_10_slow
HC0_10_back:
  v_mfma_f32_16x16x32_bf16 v[236:239], a[132:135], v[68:71], v[236:239]
  buffer_load_dwordx4 v[80:83], v5, s[60:63], s26 offen offset:1024
  v_mfma_f32_16x16x32_bf16 v[240:243], a[136:139], v[68:71], v[240:243]
  v_mfma_f32_16x16x32_bf16 v[244:247], a[144:147], v[68:71], v[244:247]
  s_waitcnt vmcnt(12)
  v_mfma_f32_16x16x32_bf16 v[208:211], a[148:151], v[100:103], v[208:211]
  s_waitcnt vmcnt(10)
  buffer_load_dwordx4 v[112:115], v5, s[60:63], s27 offen offset:1024
  v_mfma_f32_16x16x32_bf16 v[212:215], a[152:155], v[100:103], v[212:215]
  s_waitcnt vmcnt(10)
  v_mfma_f32_16x16x32_bf16 v[216:219], a[160:163], v[100:103], v[216:219]
  s_waitcnt vmcnt(9)
  v_mfma_f32_16x16x32_bf16 v[220:223], a[164:167], v[100:103], v[220:223]
  s_waitcnt vmcnt(8)
  v_mfma_f32_16x16x32_bf16 v[224:227], a[168:171], v[100:103], v[224:227]
  buffer_load_dwordx4 v[20:23], v5, s[60:63], s26 offen offset:2048
  v_max3_u32 v252, v40, v42, v72
  v_mfma_f32_16x16x32_bf16 v[228:231], a[148:151], v[124:127], v[228:231]
  v_max_u32 v252, v252, v74
  v_cmp_eq_u32 vcc, -1, v252
  v_mfma_f32_16x16x32_bf16 v[232:235], a[152:155], v[124:127], v[232:235]
  s_cbranch_vccnz HC0_11_slow
HC0_11_back:
  v_mfma_f32_16x16x32_bf16 v[236:239], a[160:163], v[124:127], v[236:239]
  buffer_load_dwordx4 v[52:55], v5, s[60:63], s27 offen offset:2048
  v_mfma_f32_16x16x32_bf16 v[240:243], a[164:167], v[124:127], v[240:243]
  v_mfma_f32_16x16x32_bf16 v[244:247], a[168:171], v[124:127], v[244:247]
  v_mfma_f32_16x16x32_bf16 v[208:211], a[176:179], v[40:43], v[208:211]
  v_mfma_f32_16x16x32_bf16 v[212:215], a[180:183], v[40:43], v[212:215]
  v_mfma_f32_16x16x32_bf16 v[216:219], a[184:187], v[40:43], v[216:219]
  v_mfma_f32_16x16x32_bf16 v[220:223], a[192:195], v[40:43], v[220:223]
  v_mfma_f32_16x16x32_bf16 v[224:227], a[196:199], v[40:43], v[224:227]
  s_waitcnt vmcnt(8)
  buffer_load_dwordx4 v[84:87], v5, s[60:63], s26 offen offset:3072
  v_max3_u32 v252, v104, v106, v44
  v_mfma_f32_16x16x32_bf16 v[228:231], a[176:179], v[72:75], v[228:231]
  v_max_u32 v252, v252, v46
  v_cmp_eq_u32 vcc, -1, v252
  v_mfma_f32_16x16x32_bf16 v[232:235], a[180:183], v[72:75], v[232:235]
  s_cbranch_vccnz HC0_12_slow
HC0_12_back:
  v_mfma_f32_16x16x32_bf16 v[236:239], a[184:187], v[72:75], v[236:239]
  buffer_load_dwordx4 v[116:119], v5, s[60:63], s27 offen offset:3072
  v_mfma_f32_16x16x32_bf16 v[240:243], a[192:195], v[72:75], v[240:243]
  v_mfma_f32_16x16x32_bf16 v[244:247], a[196:199], v[72:75], v[244:247]
  v_mfma_f32_16x16x32_bf16 v[208:211], a[200:203], v[104:107], v[208:211]
  v_mfma_f32_16x16x32_bf16 v[212:215], a[208:211], v[104:107], v[212:215]
  v_mfma_f32_16x16x32_bf16 v[216:219], a[212:215], v[104:107], v[216:219]
  v_mfma_f32_16x16x32_bf16 v[220:223], a[216:219], v[104:107], v[220:223]
  v_mfma_f32_16x16x32_bf16 v[224:227], a[224:227], v[104:107], v[224:227]
  s_add_u32 s26, s26, 0x1000
  buffer_load_dwordx4 v[24:27], v5, s[60:63], s26 offen offset:0
  v_mfma_f32_16x16x32_bf16 v[228:231], a[200:203], v[44:47], v[228:231]
  s_waitcnt vmcnt(9)
  v_max3_u32 v252, v76, v78, v108
  v_max_u32 v252, v252, v110
  v_mfma_f32_16x16x32_bf16 v[232:235], a[208:211], v[44:47], v[232:235]
  v_cmp_eq_u32 vcc, -1, v252
  v_mfma_f32_16x16x32_bf16 v[236:239], a[212:215], v[44:47], v[236:239]
  s_add_u32 s27, s27, 0x1000
  buffer_load_dwordx4 v[56:59], v5, s[60:63], s27 offen offset:0
  v_mfma_f32_16x16x32_bf16 v[240:243], a[216:219], v[44:47], v[240:243]
  s_cbranch_vccnz HC0_13_slow
HC0_13_back:
  v_mfma_f32_16x16x32_bf16 v[244:247], a[224:227], v[44:47], v[244:247]
  v_mfma_f32_16x16x32_bf16 v[208:211], a[228:231], v[76:79], v[208:211]
  v_mfma_f32_16x16x32_bf16 v[212:215], a[232:235], v[76:79], v[212:215]
  v_mfma_f32_16x16x32_bf16 v[216:219], a[240:243], v[76:79], v[216:219]
  v_mfma_f32_16x16x32_bf16 v[220:223], a[244:247], v[76:79], v[220:223]
  v_mfma_f32_16x16x32_bf16 v[224:227], a[248:251], v[76:79], v[224:227]
  buffer_load_dwordx4 v[88:91], v5, s[60:63], s26 offen offset:1024
  v_mfma_f32_16x16x32_bf16 v[228:231], a[228:231], v[108:111], v[228:231]
  v_mfma_f32_16x16x32_bf16 v[232:235], a[232:235], v[108:111], v[232:235]
  v_mfma_f32_16x16x32_bf16 v[236:239], a[240:243], v[108:111], v[236:239]
  buffer_load_dwordx4 v[28:31], v5, s[60:63], s27 offen offset:1024
  v_mfma_f32_16x16x32_bf16 v[240:243], a[244:247], v[108:111], v[240:243]
  v_mfma_f32_16x16x32_bf16 v[244:247], a[248:251], v[108:111], v[244:247]
  buffer_load_dwordx4 v[136:139], v2, s[60:63], s29 offen offset:0 sc1
  buffer_load_dwordx4 v[140:143], v2, s[60:63], s29 offen offset:16 sc1
  s_mul_i32 s4, s3, 5120
  v_add_u32 v3, s4, v5
  s_mul_i32 s4, s3, 20480
  v_add_u32 v4, s4, v5
  v_add_u32 v251, 40960, v3
  s_waitcnt vmcnt(12)
  v_max3_u32 v252, v16, v18, v48
  v_max_u32 v252, v252, v50
  v_cmp_eq_u32 vcc, -1, v252
  s_cbranch_vccnz HC1_0_slow
HC1_0_back:
  v_mfma_f32_16x16x32_bf16 v[176:179], a[0:3], v[16:19], 0
  v_mfma_f32_16x16x32_bf16 v[180:183], a[4:7], v[16:19], 0
  ds_write_b128 v3, v[208:211] offset:0
  v_mfma_f32_16x16x32_bf16 v[184:187], a[8:11], v[16:19], 0
  v_mfma_f32_16x16x32_bf16 v[188:191], a[12:15], v[16:19], 0
  v_mfma_f32_16x16x32_bf16 v[192:195], a[16:19], v[16:19], 0
  s_waitcnt vmcnt(10)
  buffer_load_dwordx4 v[60:63], v5, s[60:63], s26 offen offset:2048
  v_max3_u32 v252, v80, v82, v112
  v_mfma_f32_16x16x32_bf16 v[196:199], a[0:3], v[48:51], 0
  v_max_u32 v252, v252, v114
  v_cmp_eq_u32 vcc, -1, v252
  v_mfma_f32_16x16x32_bf16 v[200:203], a[4:7], v[48:51], 0
  s_cbranch_vccnz HC1_1_slow
HC1_1_back:
  ds_write_b128 v3, v[212:215] offset:1024
  v_mfma_f32_16x16x32_bf16 v[204:207], a[8:11], v[48:51], 0
  buffer_load_dwordx4 v[92:95], v5, s[60:63], s27 offen offset:2048
  v_mfma_f32_16x16x32_bf16 v[128:131], a[12:15], v[48:51], 0
  v_mfma_f32_16x16x32_bf16 v[132:135], a[16:19], v[48:51], 0
  v_mfma_f32_16x16x32_bf16 v[176:179], a[20:23], v[80:83], v[176:179]
  v_mfma_f32_16x16x32_bf16 v[180:183], a[24:27], v[80:83], v[180:183]
  ds_write_b128 v3, v[216:219] offset:2048
  v_mfma_f32_16x16x32_bf16 v[184:187], a[28:31], v[80:83], v[184:187]
  v_mfma_f32_16x16x32_bf16 v[188:191], a[32:35], v[80:83], v[188:191]
  v_mfma_f32_16x16x32_bf16 v[192:195], a[36:39], v[80:83], v[192:195]
  s_waitcnt vmcnt(10)
  buffer_load_dwordx4 v[32:35], v5, s[60:63], s26 offen offset:3072
  v_max3_u32 v252, v20, v22, v52
  v_mfma_f32_16x16x32_bf16 v[196:199], a[20:23], v[112:115], v[196:199]
  v_max_u32 v252, v252, v54
  v_cmp_eq_u32 vcc, -1, v252
  v_mfma_f32_16x16x32_bf16 v[200:203], a[24:27], v[112:115], v[200:203]
  s_cbranch_vccnz HC1_2_slow
HC1_2_back:
  ds_write_b128 v3, v[220:223] offset:3072
  v_mfma_f32_16x16x32_bf16 v[204:207], a[28:31], v[112:115], v[204:207]
  buffer_load_dwordx4 v[64:67], v5, s[60:63], s27 offen offset:3072
  v_mfma_f32_16x16x32_bf16 v[128:131], a[32:35], v[112:115], v[128:131]
  v_mfma_f32_16x16x32_bf16 v[132:135], a[36:39], v[112:115], v[132:135]
  v_mfma_f32_16x16x32_bf16 v[176:179], a[40:43], v[20:23], v[176:179]
  v_mfma_f32_16x16x32_bf16 v[180:183], a[44:47], v[20:23], v[180:183]
  ds_write_b128 v3, v[224:227] offset:4096
  v_mfma_f32_16x16x32_bf16 v[184:187], a[48:51], v[20:23], v[184:187]
  v_mfma_f32_16x16x32_bf16 v[188:191], a[52:55], v[20:23], v[188:191]
  v_mfma_f32_16x16x32_bf16 v[192:195], a[56:59], v[20:23], v[192:195]
  s_add_u32 s26, s26, 0x1000
  buffer_load_dwordx4 v[96:99], v5, s[60:63], s26 offen offset:0
  v_mfma_f32_16x16x32_bf16 v[196:199], a[40:43], v[52:55], v[196:199]
  s_waitcnt vmcnt(11)
  v_max3_u32 v252, v84, v86, v116
  v_max_u32 v252, v252, v118
  v_mfma_f32_16x16x32_bf16 v[200:203], a[44:47], v[52:55], v[200:203]
  ds_write_b128 v3, v[228:231] offset:20480
  v_cmp_eq_u32 vcc, -1, v252
  v_mfma_f32_16x16x32_bf16 v[204:207], a[48:51], v[52:55], v[204:207]
  s_add_u32 s27, s27, 0x1000
  buffer_load_dwordx4 v[120:123], v5, s[60:63], s27 offen offset:0
  v_mfma_f32_16x16x32_bf16 v[128:131], a[52:55], v[52:55], v[128:131]
  s_cbranch_vccnz HC1_3_slow
HC1_3_back:
  v_mfma_f32_16x16x32_bf16 v[132:135], a[56:59], v[52:55], v[132:135]
  v_mfma_f32_16x16x32_bf16 v[176:179], a[60:63], v[84:87], v[176:179]
  v_mfma_f32_16x16x32_bf16 v[180:183], v[152:155], v[84:87], v[180:183]
  ds_write_b128 v3, v[232:235] offset:21504
  v_mfma_f32_16x16x32_bf16 v[184:187], v[156:159], v[84:87], v[184:187]
  v_mfma_f32_16x16x32_bf16 v[188:191], v[160:163], v[84:87], v[188:191]
  v_mfma_f32_16x16x32_bf16 v[192:195], v[164:167], v[84:87], v[192:195]
  s_waitcnt vmcnt(10)
  buffer_load_dwordx4 v[36:39], v5, s[60:63], s26 offen offset:1024
  v_max3_u32 v252, v24, v26, v56
  v_mfma_f32_16x16x32_bf16 v[196:199], a[60:63], v[116:119], v[196:199]
  v_max_u32 v252, v252, v58
  v_cmp_eq_u32 vcc, -1, v252
  v_mfma_f32_16x16x32_bf16 v[200:203], v[152:155], v[116:119], v[200:203]
  s_cbranch_vccnz HC1_4_slow
HC1_4_back:
  ds_write_b128 v3, v[236:239] offset:22528
  v_mfma_f32_16x16x32_bf16 v[204:207], v[156:159], v[116:119], v[204:207]
  buffer_load_dwordx4 v[68:71], v5, s[60:63], s27 offen offset:1024
  v_mfma_f32_16x16x32_bf16 v[128:131], v[160:163], v[116:119], v[128:131]
  v_mfma_f32_16x16x32_bf16 v[132:135], v[164:167], v[116:119], v[132:135]
  v_mfma_f32_16x16x32_bf16 v[176:179], v[168:171], v[24:27], v[176:179]
  v_mfma_f32_16x16x32_bf16 v[180:183], v[172:175], v[24:27], v[180:183]
  ds_write_b128 v3, v[240:243] offset:23552
  v_mfma_f32_16x16x32_bf16 v[184:187], a[76:79], v[24:27], v[184:187]
  v_mfma_f32_16x16x32_bf16 v[188:191], a[92:95], v[24:27], v[188:191]
  v_mfma_f32_16x16x32_bf16 v[192:195], a[108:111], v[24:27], v[192:195]
  s_waitcnt vmcnt(10)
  buffer_load_dwordx4 v[100:103], v5, s[60:63], s26 offen offset:2048
  v_max3_u32 v252, v88, v90, v28
  v_mfma_f32_16x16x32_bf16 v[196:199], v[168:171], v[56:59], v[196:199]
  v_max_u32 v252, v252, v30
  v_cmp_eq_u32 vcc, -1, v252
  v_mfma_f32_16x16x32_bf16 v[200:203], v[172:175], v[56:59], v[200:203]
  s_cbranch_vccnz HC1_5_slow
HC1_5_back:
  ds_write_b128 v3, v[244:247] offset:24576
  v_mfma_f32_16x16x32_bf16 v[204:207], a[76:79], v[56:59], v[204:207]
  buffer_load_dwordx4 v[124:127], v5, s[60:63], s27 offen offset:2048
  v_mfma_f32_16x16x32_bf16 v[128:131], a[92:95], v[56:59], v[128:131]
  v_mfma_f32_16x16x32_bf16 v[132:135], a[108:111], v[56:59], v[132:135]
  v_mfma_f32_16x16x32_bf16 v[176:179], a[124:127], v[88:91], v[176:179]
  buffer_load_dwordx4 v[40:43], v5, s[60:63], s26 offen offset:3072
  v_mfma_f32_16x16x32_bf16 v[180:183], a[140:143], v[88:91], v[180:183]
  v_mfma_f32_16x16x32_bf16 v[184:187], a[156:159], v[88:91], v[184:187]
  v_mfma_f32_16x16x32_bf16 v[188:191], a[172:175], v[88:91], v[188:191]
  buffer_load_dwordx4 v[72:75], v5, s[60:63], s27 offen offset:3072
  v_mfma_f32_16x16x32_bf16 v[192:195], a[188:191], v[88:91], v[192:195]
  s_waitcnt vmcnt(10)
  v_max3_u32 v252, v60, v62, v92
  v_max_u32 v252, v252, v94
  v_mfma_f32_16x16x32_bf16 v[196:199], a[124:127], v[28:31], v[196:199]
  s_waitcnt lgkmcnt(0)
  s_barrier
  v_mfma_f32_16x16x32_bf16 v[200:203], a[140:143], v[28:31], v[200:203]
  s_add_u32 s26, s26, 0x1000
  buffer_load_dwordx4 v[104:107], v5, s[60:63], s26 offen offset:0
  v_cmp_eq_u32 vcc, -1, v252
  v_mfma_f32_16x16x32_bf16 v[204:207], a[156:159], v[28:31], v[204:207]
  s_cbranch_vccnz HC1_6_slow
HC1_6_back:
  v_mfma_f32_16x16x32_bf16 v[128:131], a[172:175], v[28:31], v[128:131]
  v_mfma_f32_16x16x32_bf16 v[132:135], a[188:191], v[28:31], v[132:135]
  s_add_u32 s27, s27, 0x1000
  buffer_load_dwordx4 v[44:47], v5, s[60:63], s27 offen offset:0
  v_max3_u32 v252, v136, v137, v138
  v_mfma_f32_16x16x32_bf16 v[176:179], a[204:207], v[60:63], v[176:179]
  v_max3_u32 v252, v252, v139, v140
  v_max3_u32 v252, v252, v141, v142
  v_mfma_f32_16x16x32_bf16 v[180:183], a[220:223], v[60:63], v[180:183]
  v_max_u32 v252, v252, v143
  v_cmp_eq_u32 vcc, -1, v252
  v_mfma_f32_16x16x32_bf16 v[184:187], a[236:239], v[60:63], v[184:187]
  s_cbranch_vccnz SQC_slow
SQC_back:
  buffer_load_dwordx4 v[76:79], v5, s[60:63], s26 offen offset:1024
  v_mfma_f32_16x16x32_bf16 v[188:191], a[252:255], v[60:63], v[188:191]
  v_mfma_f32_16x16x32_bf16 v[192:195], a[64:67], v[60:63], v[192:195]
  s_waitcnt vmcnt(11)
  v_max3_u32 v252, v32, v34, v64
  v_max_u32 v252, v252, v66
  v_mfma_f32_16x16x32_bf16 v[196:199], a[204:207], v[92:95], v[196:199]
  buffer_load_dwordx4 v[108:111], v5, s[60:63], s27 offen offset:1024
  v_cmp_eq_u32 vcc, -1, v252
  v_mfma_f32_16x16x32_bf16 v[200:203], a[220:223], v[92:95], v[200:203]
  s_cbranch_vccnz HC1_7_slow
HC1_7_back:
  v_mfma_f32_16x16x32_bf16 v[204:207], a[236:239], v[92:95], v[204:207]
  v_mfma_f32_16x16x32_bf16 v[128:131], a[252:255], v[92:95], v[128:131]
  v_mfma_f32_16x16x32_bf16 v[132:135], a[64:67], v[92:95], v[132:135]
  v_mfma_f32_16x16x32_bf16 v[176:179], a[68:71], v[32:35], v[176:179]
  v_mfma_f32_16x16x32_bf16 v[180:183], a[72:75], v[32:35], v[180:183]
  v_add_f32 v136, v136, v140
  v_add_f32 v137, v137, v141
  v_mfma_f32_16x16x32_bf16 v[184:187], a[80:83], v[32:35], v[184:187]
  v_add_f32 v138, v138, v142
  v_add_f32 v139, v139, v143
  v_mfma_f32_16x16x32_bf16 v[188:191], a[84:87], v[32:35], v[188:191]
  v_add_f32 v136, v136, v137
  v_add_f32 v138, v138, v139
  v_mfma_f32_16x16x32_bf16 v[192:195], a[88:91], v[32:35], v[192:195]
  s_waitcnt vmcnt(10)
  v_max3_u32 v252, v96, v98, v120
  v_max_u32 v252, v252, v122
  v_mfma_f32_16x16x32_bf16 v[196:199], a[68:71], v[64:67], v[196:199]
  v_cmp_eq_u32 vcc, -1, v252
  v_add_f32 v136, v136, v138
  v_mfma_f32_16x16x32_bf16 v[200:203], a[72:75], v[64:67], v[200:203]
  s_cbranch_vccnz HC1_8_slow
HC1_8_back:
  v_mul_f32 v137, v13, v13
  v_mul_f32 v136, 0x3acccccd, v136
  v_mfma_f32_16x16x32_bf16 v[204:207], a[80:83], v[64:67], v[204:207]
  v_sub_f32 v136, v136, v137
  v_max_f32 v136, 0, v136
  v_mfma_f32_16x16x32_bf16 v[128:131], a[84:87], v[64:67], v[128:131]
  v_cvt_pk_bf16_f32 v136, v136, v136
  v_and_b32 v136, 0xffff0000, v136
  v_mfma_f32_16x16x32_bf16 v[132:135], a[88:91], v[64:67], v[132:135]
  v_add_f32 v136, 0x3727c5ac, v136
  v_cvt_pk_bf16_f32 v136, v136, v136
  v_mfma_f32_16x16x32_bf16 v[176:179], a[96:99], v[96:99], v[176:179]
  v_and_b32 v136, 0xffff0000, v136
  v_mfma_f32_16x16x32_bf16 v[180:183], a[100:103], v[96:99], v[180:183]
  v_sqrt_f32 v136, v136
  v_mfma_f32_16x16x32_bf16 v[184:187], a[104:107], v[96:99], v[184:187]
  v_cvt_pk_bf16_f32 v136, v136, v136
  v_and_b32 v136, 0xffff0000, v136
  v_mfma_f32_16x16x32_bf16 v[188:191], a[112:115], v[96:99], v[188:191]
  v_rcp_f32 v136, v136
  v_mfma_f32_16x16x32_bf16 v[192:195], a[116:119], v[96:99], v[192:195]
  s_waitcnt vmcnt(8)
  v_max3_u32 v252, v36, v38, v68
  v_max_u32 v252, v252, v70
  v_mfma_f32_16x16x32_bf16 v[196:199], a[96:99], v[120:123], v[196:199]
  v_cmp_eq_u32 vcc, -1, v252
  v_mul_f32 v13, v136, v136
  v_mfma_f32_16x16x32_bf16 v[200:203], a[100:103], v[120:123], v[200:203]
  s_cbranch_vccnz HC1_9_slow
HC1_9_back:
  v_mfma_f32_16x16x32_bf16 v[204:207], a[104:107], v[120:123], v[204:207]
  s_waitcnt vmcnt(6)
  v_max3_u32 v252, v100, v102, v124
  v_max_u32 v252, v252, v126
  v_mfma_f32_16x16x32_bf16 v[128:131], a[112:115], v[120:123], v[128:131]
  v_cmp_eq_u32 vcc, -1, v252
  v_mfma_f32_16x16x32_bf16 v[132:135], a[116:119], v[120:123], v[132:135]
  s_cbranch_vccnz HC1_10_slow
HC1_10_back:
  v_mfma_f32_16x16x32_bf16 v[176:179], a[120:123], v[36:39], v[176:179]
  s_waitcnt vmcnt(4)
  v_max3_u32 v252, v40, v42, v72
  v_max_u32 v252, v252, v74
  v_mfma_f32_16x16x32_bf16 v[180:183], a[128:131], v[36:39], v[180:183]
  v_cmp_eq_u32 vcc, -1, v252
  v_mfma_f32_16x16x32_bf16 v[184:187], a[132:135], v[36:39], v[184:187]
  s_cbranch_vccnz HC1_11_slow
HC1_11_back:
  v_mfma_f32_16x16x32_bf16 v[188:191], a[136:139], v[36:39], v[188:191]
  s_waitcnt vmcnt(2)
  v_max3_u32 v252, v104, v106, v44
  v_max_u32 v252, v252, v46
  v_mfma_f32_16x16x32_bf16 v[192:195], a[144:147], v[36:39], v[192:195]
  v_cmp_eq_u32 vcc, -1, v252
  v_mfma_f32_16x16x32_bf16 v[196:199], a[120:123], v[68:71], v[196:199]
  s_cbranch_vccnz HC1_12_slow
HC1_12_back:
  v_mfma_f32_16x16x32_bf16 v[200:203], a[128:131], v[68:71], v[200:203]
  s_waitcnt vmcnt(0)
  v_max3_u32 v252, v76, v78, v108
  v_max_u32 v252, v252, v110
  v_mfma_f32_16x16x32_bf16 v[204:207], a[132:135], v[68:71], v[204:207]
  v_cmp_eq_u32 vcc, -1, v252
  v_mfma_f32_16x16x32_bf16 v[128:131], a[136:139], v[68:71], v[128:131]
  s_cbranch_vccnz HC1_13_slow
HC1_13_back:
  v_mfma_f32_16x16x32_bf16 v[132:135], a[144:147], v[68:71], v[132:135]
  v_mfma_f32_16x16x32_bf16 v[176:179], a[148:151], v[100:103], v[176:179]
  v_mfma_f32_16x16x32_bf16 v[176:179], a[176:179], v[40:43], v[176:179]
  v_mfma_f32_16x16x32_bf16 v[176:179], a[200:203], v[104:107], v[176:179]
  s_cmp_ge_u32 s3, 2
  s_cbranch_scc1 RD_e0
  ds_read_b128 v[16:19], v4 offset:0
  ds_read_b128 v[48:51], v4 offset:5120
  ds_read_b128 v[80:83], v4 offset:10240
  ds_read_b128 v[112:115], v4 offset:15360
RD_e0:
  v_mfma_f32_16x16x32_bf16 v[176:179], a[228:231], v[76:79], v[176:179]
  v_mfma_f32_16x16x32_bf16 v[180:183], a[152:155], v[100:103], v[180:183]
  v_mfma_f32_16x16x32_bf16 v[180:183], a[180:183], v[40:43], v[180:183]
  s_nop 5
  ds_write_b128 v251, v[176:179] offset:0
  v_mfma_f32_16x16x32_bf16 v[180:183], a[208:211], v[104:107], v[180:183]
  v_mfma_f32_16x16x32_bf16 v[180:183], a[232:235], v[76:79], v[180:183]
  v_mfma_f32_16x16x32_bf16 v[184:187], a[160:163], v[100:103], v[184:187]
  s_cmp_ge_u32 s3, 2
  s_cbranch_scc1 RD_e1
  ds_read_b128 v[20:23], v4 offset:1024
  ds_read_b128 v[52:55], v4 offset:6144
  ds_read_b128 v[84:87], v4 offset:11264
  ds_read_b128 v[116:119], v4 offset:16384
RD_e1:
  v_mfma_f32_16x16x32_bf16 v[184:187], a[184:187], v[40:43], v[184:187]
  s_nop 3
  ds_write_b128 v251, v[180:183] offset:1024
  v_mfma_f32_16x16x32_bf16 v[184:187], a[212:215], v[104:107], v[184:187]
  v_mfma_f32_16x16x32_bf16 v[184:187], a[240:243], v[76:79], v[184:187]
  v_mfma_f32_16x16x32_bf16 v[188:191], a[164:167], v[100:103], v[188:191]
  v_mfma_f32_16x16x32_bf16 v[188:191], a[192:195], v[40:43], v[188:191]
  s_nop 5
  ds_write_b128 v251, v[184:187] offset:2048
  v_mfma_f32_16x16x32_bf16 v[188:191], a[216:219], v[104:107], v[188:191]
  s_cmp_ge_u32 s3, 2
  s_cbranch_scc1 RD_e2
  ds_read_b128 v[24:27], v4 offset:2048
  ds_read_b128 v[56:59], v4 offset:7168
  ds_read_b128 v[88:91], v4 offset:12288
  ds_read_b128 v[28:31], v4 offset:17408
RD_e2:
  v_mfma_f32_16x16x32_bf16 v[188:191], a[244:247], v[76:79], v[188:191]
  v_mfma_f32_16x16x32_bf16 v[192:195], a[168:171], v[100:103], v[192:195]
  v_mfma_f32_16x16x32_bf16 v[192:195], a[196:199], v[40:43], v[192:195]
  s_nop 5
  ds_write_b128 v251, v[188:191] offset:3072
  v_mfma_f32_16x16x32_bf16 v[192:195], a[224:227], v[104:107], v[192:195]
  v_mfma_f32_16x16x32_bf16 v[192:195], a[248:251], v[76:79], v[192:195]
  v_mfma_f32_16x16x32_bf16 v[196:199], a[148:151], v[124:127], v[196:199]
  s_cmp_ge_u32 s3, 2
  s_cbranch_scc1 RD_e3
  ds_read_b128 v[60:63], v4 offset:3072
  ds_read_b128 v[92:95], v4 offset:8192
  ds_read_b128 v[32:35], v4 offset:13312
  ds_read_b128 v[64:67], v4 offset:18432
RD_e3:
  v_mfma_f32_16x16x32_bf16 v[196:199], a[176:179], v[72:75], v[196:199]
  s_nop 3
  ds_write_b128 v251, v[192:195] offset:4096
  v_mfma_f32_16x16x32_bf16 v[196:199], a[200:203], v[44:47], v[196:199]
  v_mfma_f32_16x16x32_bf16 v[196:199], a[228:231], v[108:111], v[196:199]
  v_mfma_f32_16x16x32_bf16 v[200:203], a[152:155], v[124:127], v[200:203]
  v_mfma_f32_16x16x32_bf16 v[200:203], a[180:183], v[72:75], v[200:203]
  s_nop 5
  ds_write_b128 v251, v[196:199] offset:20480
  v_mfma_f32_16x16x32_bf16 v[200:203], a[208:211], v[44:47], v[200:203]
  s_cmp_ge_u32 s3, 2
  s_cbranch_scc1 RD_e4
  ds_read_b128 v[96:99], v4 offset:4096
  ds_read_b128 v[120:123], v4 offset:9216
  ds_read_b128 v[36:39], v4 offset:14336
  ds_read_b128 v[68:71], v4 offset:19456
RD_e4:
  v_mfma_f32_16x16x32_bf16 v[200:203], a[232:235], v[108:111], v[200:203]
  v_mfma_f32_16x16x32_bf16 v[204:207], a[160:163], v[124:127], v[204:207]
  v_mfma_f32_16x16x32_bf16 v[204:207], a[184:187], v[72:75], v[204:207]
  s_nop 5
  ds_write_b128 v251, v[200:203] offset:21504
  v_mfma_f32_16x16x32_bf16 v[204:207], a[212:215], v[44:47], v[204:207]
  v_mfma_f32_16x16x32_bf16 v[204:207], a[240:243], v[108:111], v[204:207]
  v_mfma_f32_16x16x32_bf16 v[128:131], a[164:167], v[124:127], v[128:131]
  v_mfma_f32_16x16x32_bf16 v[128:131], a[192:195], v[72:75], v[128:131]
  s_nop 5
  ds_write_b128 v251, v[204:207] offset:22528
  v_mfma_f32_16x16x32_bf16 v[128:131], a[216:219], v[44:47], v[128:131]
  v_mfma_f32_16x16x32_bf16 v[128:131], a[244:247], v[108:111], v[128:131]
  v_mfma_f32_16x16x32_bf16 v[132:135], a[168:171], v[124:127], v[132:135]
  v_mfma_f32_16x16x32_bf16 v[132:135], a[196:199], v[72:75], v[132:135]
  s_nop 5
  ds_write_b128 v251, v[128:131] offset:23552
  v_mfma_f32_16x16x32_bf16 v[132:135], a[224:227], v[44:47], v[132:135]
  v_mfma_f32_16x16x32_bf16 v[132:135], a[248:251], v[108:111], v[132:135]
  s_nop 7
  ds_write_b128 v251, v[132:135] offset:24576
  s_waitcnt lgkmcnt(0)
  s_barrier
  s_cmp_lt_u32 s3, 2
  s_cbranch_scc1 RD_l
  ds_read_b128 v[16:19], v4 offset:0
  ds_read_b128 v[48:51], v4 offset:5120
  ds_read_b128 v[80:83], v4 offset:10240
  ds_read_b128 v[112:115], v4 offset:15360
  ds_read_b128 v[20:23], v4 offset:1024
  ds_read_b128 v[52:55], v4 offset:6144
  ds_read_b128 v[84:87], v4 offset:11264
  ds_read_b128 v[116:119], v4 offset:16384
  ds_read_b128 v[24:27], v4 offset:2048
  ds_read_b128 v[56:59], v4 offset:7168
  ds_read_b128 v[88:91], v4 offset:12288
  ds_read_b128 v[28:31], v4 offset:17408
  ds_read_b128 v[60:63], v4 offset:3072
  ds_read_b128 v[92:95], v4 offset:8192
  ds_read_b128 v[32:35], v4 offset:13312
  ds_read_b128 v[64:67], v4 offset:18432
  ds_read_b128 v[96:99], v4 offset:4096
  ds_read_b128 v[120:123], v4 offset:9216
  ds_read_b128 v[36:39], v4 offset:14336
  ds_read_b128 v[68:71], v4 offset:19456
RD_l:
  v_and_b32 v2, 15, v1
  v_mul_u32_u24 v2, 1280, v2
  v_lshrrev_b32 v3, 1, v12
  v_add_u32 v110, v2, v3
  s_waitcnt lgkmcnt(15)
  v_pk_add_f32 v[16:17], v[16:17], v[48:49]
  v_pk_add_f32 v[80:81], v[80:81], v[112:113]
  v_pk_add_f32 v[18:19], v[18:19], v[50:51]
  v_pk_add_f32 v[82:83], v[82:83], v[114:115]
  v_lshlrev_b32 v104, 16, v144
  v_and_b32 v105, 0xffff0000, v144
  v_lshlrev_b32 v106, 16, v145
  v_and_b32 v107, 0xffff0000, v145
  v_pk_add_f32 v[16:17], v[16:17], v[80:81]
  v_pk_add_f32 v[18:19], v[18:19], v[82:83]
  v_pk_fma_f32 v[16:17], v[16:17], v[12:13], v[104:105] op_sel:[0,1,0] op_sel_hi:[1,1,1]
  v_pk_fma_f32 v[18:19], v[18:19], v[12:13], v[106:107] op_sel:[0,1,0] op_sel_hi:[1,1,1]
  v_cvt_pk_bf16_f32 v40, v16, v17
  v_cvt_pk_bf16_f32 v41, v18, v19
  s_waitcnt lgkmcnt(14)
  v_pk_add_f32 v[20:21], v[20:21], v[52:53]
  s_waitcnt lgkmcnt(12)
  v_pk_add_f32 v[84:85], v[84:85], v[116:117]
  v_pk_add_f32 v[22:23], v[22:23], v[54:55]
  v_pk_add_f32 v[86:87], v[86:87], v[118:119]
  v_lshlrev_b32 v104, 16, v146
  v_and_b32 v105, 0xffff0000, v146
  v_lshlrev_b32 v106, 16, v147
  v_and_b32 v107, 0xffff0000, v147
  v_pk_add_f32 v[20:21], v[20:21], v[84:85]
  v_pk_add_f32 v[22:23], v[22:23], v[86:87]
  v_pk_fma_f32 v[20:21], v[20:21], v[12:13], v[104:105] op_sel:[0,1,0] op_sel_hi:[1,1,1]
  v_pk_fma_f32 v[22:23], v[22:23], v[12:13], v[106:107] op_sel:[0,1,0] op_sel_hi:[1,1,1]
  v_cvt_pk_bf16_f32 v42, v20, v21
  v_cvt_pk_bf16_f32 v43, v22, v23
  s_nop 0
  v_permlane16_swap_b32 v40, v42
  v_permlane16_swap_b32 v41, v43
  buffer_store_dwordx4 v[40:43], v248, s[56:59], s22 offen offset:0
  s_waitcnt lgkmcnt(10)
  v_pk_add_f32 v[24:25], v[24:25], v[56:57]
  s_waitcnt lgkmcnt(8)
  v_pk_add_f32 v[88:89], v[88:89], v[28:29]
  v_pk_add_f32 v[26:27], v[26:27], v[58:59]
  v_pk_add_f32 v[90:91], v[90:91], v[30:31]
  v_lshlrev_b32 v104, 16, v148
  v_and_b32 v105, 0xffff0000, v148
  v_lshlrev_b32 v106, 16, v149
  v_and_b32 v107, 0xffff0000, v149
  v_pk_add_f32 v[24:25], v[24:25], v[88:89]
  v_pk_add_f32 v[26:27], v[26:27], v[90:91]
  v_pk_fma_f32 v[24:25], v[24:25], v[12:13], v[104:105] op_sel:[0,1,0] op_sel_hi:[1,1,1]
  v_pk_fma_f32 v[26:27], v[26:27], v[12:13], v[106:107] op_sel:[0,1,0] op_sel_hi:[1,1,1]
  v_cvt_pk_bf16_f32 v44, v24, v25
  v_cvt_pk_bf16_f32 v45, v26, v27
  s_waitcnt lgkmcnt(6)
  v_pk_add_f32 v[60:61], v[60:61], v[92:93]
  s_waitcnt lgkmcnt(4)
  v_pk_add_f32 v[32:33], v[32:33], v[64:65]
  v_pk_add_f32 v[62:63], v[62:63], v[94:95]
  v_pk_add_f32 v[34:35], v[34:35], v[66:67]
  v_lshlrev_b32 v104, 16, v150
  v_and_b32 v105, 0xffff0000, v150
  v_lshlrev_b32 v106, 16, v151
  v_and_b32 v107, 0xffff0000, v151
  v_pk_add_f32 v[60:61], v[60:61], v[32:33]
  v_pk_add_f32 v[62:63], v[62:63], v[34:35]
  v_pk_fma_f32 v[60:61], v[60:61], v[12:13], v[104:105] op_sel:[0,1,0] op_sel_hi:[1,1,1]
  v_pk_fma_f32 v[62:63], v[62:63], v[12:13], v[106:107] op_sel:[0,1,0] op_sel_hi:[1,1,1]
  v_cvt_pk_bf16_f32 v46, v60, v61
  v_cvt_pk_bf16_f32 v47, v62, v63
  s_nop 0
  v_permlane16_swap_b32 v44, v46
  v_permlane16_swap_b32 v45, v47
  buffer_store_dwordx4 v[44:47], v248, s[56:59], s22 offen offset:64
  s_waitcnt lgkmcnt(2)
  v_pk_add_f32 v[96:97], v[96:97], v[120:121]
  s_waitcnt lgkmcnt(0)
  v_pk_add_f32 v[36:37], v[36:37], v[68:69]
  v_pk_add_f32 v[98:99], v[98:99], v[122:123]
  v_pk_add_f32 v[38:39], v[38:39], v[70:71]
  v_lshlrev_b32 v104, 16, v14
  v_and_b32 v105, 0xffff0000, v14
  v_lshlrev_b32 v106, 16, v15
  v_and_b32 v107, 0xffff0000, v15
  v_pk_add_f32 v[96:97], v[96:97], v[36:37]
  v_pk_add_f32 v[98:99], v[98:99], v[38:39]
  v_pk_fma_f32 v[96:97], v[96:97], v[12:13], v[104:105] op_sel:[0,1,0] op_sel_hi:[1,1,1]
  v_pk_fma_f32 v[98:99], v[98:99], v[12:13], v[106:107] op_sel:[0,1,0] op_sel_hi:[1,1,1]
  v_cvt_pk_bf16_f32 v108, v96, v97
  v_cvt_pk_bf16_f32 v109, v98, v99
  buffer_store_dwordx2 v[108:109], v110, s[56:59], s22 offen offset:128
  s_endpgm
HV0_slow:
  s_mov_b32 s11, 20000
  s_mov_b32 s5, m0
  s_add_u32 m0, s20, 0
  s_add_u32 s4, s36, 0
  buffer_load_dwordx4 v6, s[60:63], s4 offen sc1 lds
  buffer_load_dwordx4 v13, s[60:63], s4 offen offset:1024 sc1 lds
  s_add_u32 m0, s20, 8192
  s_add_u32 s4, s36, 131072
  buffer_load_dwordx4 v6, s[60:63], s4 offen sc1 lds
  buffer_load_dwordx4 v13, s[60:63], s4 offen offset:1024 sc1 lds
  s_mov_b32 m0, s5
HV0_spin:
  s_waitcnt vmcnt(0)
  ds_read2st64_b32 v[138:139], v253 offset0:0 offset1:4
  s_waitcnt lgkmcnt(0)
  v_max_u32 v252, v138, v139
  ds_read2st64_b32 v[140:141], v253 offset0:32 offset1:36
  s_waitcnt lgkmcnt(0)
  v_max3_u32 v252, v252, v140, v141
  v_cmp_eq_u32 vcc, -1, v252
  s_cbranch_vccz HV0_back
  s_mov_b32 s5, m0
  s_add_u32 m0, s20, 0
  s_add_u32 s4, s36, 0
  buffer_load_dwordx4 v6, s[60:63], s4 offen sc1 lds
  buffer_load_dwordx4 v13, s[60:63], s4 offen offset:1024 sc1 lds
  s_add_u32 m0, s20, 8192
  s_add_u32 s4, s36, 131072
  buffer_load_dwordx4 v6, s[60:63], s4 offen sc1 lds
  buffer_load_dwordx4 v13, s[60:63], s4 offen offset:1024 sc1 lds
  s_mov_b32 m0, s5
  s_sub_u32 s11, s11, 1
  s_cbranch_scc0 HV0_spin
  s_waitcnt vmcnt(0)
  s_branch HV0_back
HV2_slow:
  s_waitcnt lgkmcnt(0)
  s_mov_b32 s11, 20000
  s_mov_b32 s5, m0
  s_add_u32 m0, s20, 16384
  s_add_u32 s4, s36, 262144
  buffer_load_dwordx4 v6, s[60:63], s4 offen sc1 lds
  buffer_load_dwordx4 v13, s[60:63], s4 offen offset:1024 sc1 lds
  s_add_u32 m0, s20, 24576
  s_add_u32 s4, s36, 393216
  buffer_load_dwordx4 v6, s[60:63], s4 offen sc1 lds
  buffer_load_dwordx4 v13, s[60:63], s4 offen offset:1024 sc1 lds
  s_mov_b32 m0, s5
HV2_spin:
  s_waitcnt vmcnt(0)
  ds_read2st64_b32 v[142:143], v253 offset0:0 offset1:4
  s_waitcnt lgkmcnt(0)
  v_max_u32 v252, v142, v143
  ds_read2st64_b32 v[138:139], v253 offset0:32 offset1:36
  s_waitcnt lgkmcnt(0)
  v_max3_u32 v252, v252, v138, v139
  v_cmp_eq_u32 vcc, -1, v252
  s_cbranch_vccz HV2_back
  s_mov_b32 s5, m0
  s_add_u32 m0, s20, 16384
  s_add_u32 s4, s36, 262144
  buffer_load_dwordx4 v6, s[60:63], s4 offen sc1 lds
  buffer_load_dwordx4 v13, s[60:63], s4 offen offset:1024 sc1 lds
  s_add_u32 m0, s20, 24576
  s_add_u32 s4, s36, 393216
  buffer_load_dwordx4 v6, s[60:63], s4 offen sc1 lds
  buffer_load_dwordx4 v13, s[60:63], s4 offen offset:1024 sc1 lds
  s_mov_b32 m0, s5
  s_sub_u32 s11, s11, 1
  s_cbranch_scc0 HV2_spin
  s_waitcnt vmcnt(0)
  s_branch HV2_back
HV4_slow:
  s_waitcnt lgkmcnt(0)
  s_mov_b32 s11, 20000
  s_mov_b32 s5, m0
  s_add_u32 m0, s20, 32768
  s_add_u32 s4, s36, 524288
  buffer_load_dwordx4 v6, s[60:63], s4 offen sc1 lds
  buffer_load_dwordx4 v13, s[60:63], s4 offen offset:1024 sc1 lds
  s_add_u32 m0, s20, 40960
  s_add_u32 s4, s36, 655360
  buffer_load_dwordx4 v6, s[60:63], s4 offen sc1 lds
  buffer_load_dwordx4 v13, s[60:63], s4 offen offset:1024 sc1 lds
  s_add_u32 m0, s20, 49152
  s_add_u32 s4, s36, 786432
  buffer_load_dwordx4 v6, s[60:63], s4 offen sc1 lds
  buffer_load_dwordx4 v13, s[60:63], s4 offen offset:1024 sc1 lds
  s_mov_b32 m0, s5
HV4_spin:
  s_waitcnt vmcnt(0)
  ds_read2st64_b32 v[140:141], v253 offset0:0 offset1:4
  s_waitcnt lgkmcnt(0)
  v_max_u32 v252, v140, v141
  ds_read2st64_b32 v[142:143], v253 offset0:32 offset1:36
  s_waitcnt lgkmcnt(0)
  v_max3_u32 v252, v252, v142, v143
  ds_read2st64_b32 v[138:139], v253 offset0:64 offset1:68
  s_waitcnt lgkmcnt(0)
  v_max3_u32 v252, v252, v138, v139
  v_cmp_eq_u32 vcc, -1, v252
  s_cbranch_vccz HV4_back
  s_mov_b32 s5, m0
  s_add_u32 m0, s20, 32768
  s_add_u32 s4, s36, 524288
  buffer_load_dwordx4 v6, s[60:63], s4 offen sc1 lds
  buffer_load_dwordx4 v13, s[60:63], s4 offen offset:1024 sc1 lds
  s_add_u32 m0, s20, 40960
  s_add_u32 s4, s36, 655360
  buffer_load_dwordx4 v6, s[60:63], s4 offen sc1 lds
  buffer_load_dwordx4 v13, s[60:63], s4 offen offset:1024 sc1 lds
  s_add_u32 m0, s20, 49152
  s_add_u32 s4, s36, 786432
  buffer_load_dwordx4 v6, s[60:63], s4 offen sc1 lds
  buffer_load_dwordx4 v13, s[60:63], s4 offen offset:1024 sc1 lds
  s_mov_b32 m0, s5
  s_sub_u32 s11, s11, 1
  s_cbranch_scc0 HV4_spin
  s_waitcnt vmcnt(0)
  s_branch HV4_back
HV7_slow:
  s_waitcnt lgkmcnt(0)
  s_mov_b32 s11, 20000
  s_mov_b32 s5, m0
  s_add_u32 m0, s20, 57344
  s_add_u32 s4, s36, 917504
  buffer_load_dwordx4 v6, s[60:63], s4 offen sc1 lds
  buffer_load_dwordx4 v13, s[60:63], s4 offen offset:1024 sc1 lds
  s_add_u32 m0, s20, 65536
  s_add_u32 s4, s36, 1048576
  buffer_load_dwordx4 v6, s[60:63], s4 offen sc1 lds
  buffer_load_dwordx4 v13, s[60:63], s4 offen offset:1024 sc1 lds
  s_add_u32 m0, s20, 73728
  s_add_u32 s4, s36, 1179648
  buffer_load_dwordx4 v6, s[60:63], s4 offen sc1 lds
  buffer_load_dwordx4 v13, s[60:63], s4 offen offset:1024 sc1 lds
  s_add_u32 m0, s20, 81920
  s_add_u32 s4, s36, 1310720
  buffer_load_dwordx4 v6, s[60:63], s4 offen sc1 lds
  buffer_load_dwordx4 v13, s[60:63], s4 offen offset:1024 sc1 lds
  s_add_u32 m0, s20, 90112
  s_add_u32 s4, s36, 1441792
  buffer_load_dwordx4 v6, s[60:63], s4 offen sc1 lds
  buffer_load_dwordx4 v13, s[60:63], s4 offen offset:1024 sc1 lds
  s_mov_b32 m0, s5
HV7_spin:
  s_waitcnt vmcnt(0)
  ds_read2st64_b32 v[140:141], v253 offset0:0 offset1:4
  s_waitcnt lgkmcnt(0)
  v_max_u32 v252, v140, v141
  ds_read2st64_b32 v[142:143], v253 offset0:32 offset1:36
  s_waitcnt lgkmcnt(0)
  v_max3_u32 v252, v252, v142, v143
  ds_read2st64_b32 v[138:139], v253 offset0:64 offset1:68
  s_waitcnt lgkmcnt(0)
  v_max3_u32 v252, v252, v138, v139
  ds_read2st64_b32 v[140:141], v253 offset0:96 offset1:100
  s_waitcnt lgkmcnt(0)
  v_max3_u32 v252, v252, v140, v141
  ds_read2st64_b32 v[142:143], v253 offset0:128 offset1:132
  s_waitcnt lgkmcnt(0)
  v_max3_u32 v252, v252, v142, v143
  v_cmp_eq_u32 vcc, -1, v252
  s_cbranch_vccz HV7_back
  s_mov_b32 s5, m0
  s_add_u32 m0, s20, 57344
  s_add_u32 s4, s36, 917504
  buffer_load_dwordx4 v6, s[60:63], s4 offen sc1 lds
  buffer_load_dwordx4 v13, s[60:63], s4 offen offset:1024 sc1 lds
  s_add_u32 m0, s20, 65536
  s_add_u32 s4, s36, 1048576
  buffer_load_dwordx4 v6, s[60:63], s4 offen sc1 lds
  buffer_load_dwordx4 v13, s[60:63], s4 offen offset:1024 sc1 lds
  s_add_u32 m0, s20, 73728
  s_add_u32 s4, s36, 1179648
  buffer_load_dwordx4 v6, s[60:63], s4 offen sc1 lds
  buffer_load_dwordx4 v13, s[60:63], s4 offen offset:1024 sc1 lds
  s_add_u32 m0, s20, 81920
  s_add_u32 s4, s36, 1310720
  buffer_load_dwordx4 v6, s[60:63], s4 offen sc1 lds
  buffer_load_dwordx4 v13, s[60:63], s4 offen offset:1024 sc1 lds
  s_add_u32 m0, s20, 90112
  s_add_u32 s4, s36, 1441792
  buffer_load_dwordx4 v6, s[60:63], s4 offen sc1 lds
  buffer_load_dwordx4 v13, s[60:63], s4 offen offset:1024 sc1 lds
  s_mov_b32 m0, s5
  s_sub_u32 s11, s11, 1
  s_cbranch_scc0 HV7_spin
  s_waitcnt vmcnt(0)
  s_branch HV7_back
HV12_slow:
  s_waitcnt lgkmcnt(0)
  s_mov_b32 s11, 20000
  s_mov_b32 s5, m0
  s_add_u32 m0, s20, 98304
  s_add_u32 s4, s36, 1572864
  buffer_load_dwordx4 v6, s[60:63], s4 offen sc1 lds
  buffer_load_dwordx4 v13, s[60:63], s4 offen offset:1024 sc1 lds
  s_add_u32 m0, s20, 106496
  s_add_u32 s4, s36, 1703936
  buffer_load_dwordx4 v6, s[60:63], s4 offen sc1 lds
  buffer_load_dwordx4 v13, s[60:63], s4 offen offset:1024 sc1 lds
  s_add_u32 m0, s20, 114688
  s_add_u32 s4, s36, 1835008
  buffer_load_dwordx4 v6, s[60:63], s4 offen sc1 lds
  buffer_load_dwordx4 v13, s[60:63], s4 offen offset:1024 sc1 lds
  s_add_u32 m0, s20, 122880
  s_add_u32 s4, s36, 1966080
  buffer_load_dwordx4 v6, s[60:63], s4 offen sc1 lds
  buffer_load_dwordx4 v13, s[60:63], s4 offen offset:1024 sc1 lds
  s_add_u32 m0, s20, 131072
  s_add_u32 s4, s36, 2097152
  buffer_load_dwordx4 v6, s[60:63], s4 offen sc1 lds
  buffer_load_dwordx4 v13, s[60:63], s4 offen offset:1024 sc1 lds
  s_add_u32 m0, s20, 139264
  s_add_u32 s4, s36, 2228224
  buffer_load_dwordx4 v6, s[60:63], s4 offen sc1 lds
  buffer_load_dwordx4 v13, s[60:63], s4 offen offset:1024 sc1 lds
  s_add_u32 m0, s20, 147456
  s_add_u32 s4, s36, 2359296
  buffer_load_dwordx4 v6, s[60:63], s4 offen sc1 lds
  buffer_load_dwordx4 v13, s[60:63], s4 offen offset:1024 sc1 lds
  s_add_u32 m0, s20, 155648
  s_add_u32 s4, s36, 2490368
  buffer_load_dwordx4 v6, s[60:63], s4 offen sc1 lds
  buffer_load_dwordx4 v13, s[60:63], s4 offen offset:1024 sc1 lds
  s_mov_b32 m0, s5
HV12_spin:
  s_waitcnt vmcnt(0)
  ds_read2st64_b32 v[138:139], v253 offset0:0 offset1:4
  s_waitcnt lgkmcnt(0)
  v_max_u32 v252, v138, v139
  ds_read2st64_b32 v[140:141], v253 offset0:32 offset1:36
  s_waitcnt lgkmcnt(0)
  v_max3_u32 v252, v252, v140, v141
  ds_read2st64_b32 v[142:143], v253 offset0:64 offset1:68
  s_waitcnt lgkmcnt(0)
  v_max3_u32 v252, v252, v142, v143
  ds_read2st64_b32 v[138:139], v253 offset0:96 offset1:100
  s_waitcnt lgkmcnt(0)
  v_max3_u32 v252, v252, v138, v139
  ds_read2st64_b32 v[140:141], v253 offset0:128 offset1:132
  s_waitcnt lgkmcnt(0)
  v_max3_u32 v252, v252, v140, v141
  ds_read2st64_b32 v[142:143], v253 offset0:160 offset1:164
  s_waitcnt lgkmcnt(0)
  v_max3_u32 v252, v252, v142, v143
  ds_read2st64_b32 v[138:139], v253 offset0:192 offset1:196
  s_waitcnt lgkmcnt(0)
  v_max3_u32 v252, v252, v138, v139
  ds_read2st64_b32 v[140:141], v253 offset0:224 offset1:228
  s_waitcnt lgkmcnt(0)
  v_max3_u32 v252, v252, v140, v141
  v_cmp_eq_u32 vcc, -1, v252
  s_cbranch_vccz HV12_back
  s_mov_b32 s5, m0
  s_add_u32 m0, s20, 98304
  s_add_u32 s4, s36, 1572864
  buffer_load_dwordx4 v6, s[60:63], s4 offen sc1 lds
  buffer_load_dwordx4 v13, s[60:63], s4 offen offset:1024 sc1 lds
  s_add_u32 m0, s20, 106496
  s_add_u32 s4, s36, 1703936
  buffer_load_dwordx4 v6, s[60:63], s4 offen sc1 lds
  buffer_load_dwordx4 v13, s[60:63], s4 offen offset:1024 sc1 lds
  s_add_u32 m0, s20, 114688
  s_add_u32 s4, s36, 1835008
  buffer_load_dwordx4 v6, s[60:63], s4 offen sc1 lds
  buffer_load_dwordx4 v13, s[60:63], s4 offen offset:1024 sc1 lds
  s_add_u32 m0, s20, 122880
  s_add_u32 s4, s36, 1966080
  buffer_load_dwordx4 v6, s[60:63], s4 offen sc1 lds
  buffer_load_dwordx4 v13, s[60:63], s4 offen offset:1024 sc1 lds
  s_add_u32 m0, s20, 131072
  s_add_u32 s4, s36, 2097152
  buffer_load_dwordx4 v6, s[60:63], s4 offen sc1 lds
  buffer_load_dwordx4 v13, s[60:63], s4 offen offset:1024 sc1 lds
  s_add_u32 m0, s20, 139264
  s_add_u32 s4, s36, 2228224
  buffer_load_dwordx4 v6, s[60:63], s4 offen sc1 lds
  buffer_load_dwordx4 v13, s[60:63], s4 offen offset:1024 sc1 lds
  s_add_u32 m0, s20, 147456
  s_add_u32 s4, s36, 2359296
  buffer_load_dwordx4 v6, s[60:63], s4 offen sc1 lds
  buffer_load_dwordx4 v13, s[60:63], s4 offen offset:1024 sc1 lds
  s_add_u32 m0, s20, 155648
  s_add_u32 s4, s36, 2490368
  buffer_load_dwordx4 v6, s[60:63], s4 offen sc1 lds
  buffer_load_dwordx4 v13, s[60:63], s4 offen offset:1024 sc1 lds
  s_mov_b32 m0, s5
  s_sub_u32 s11, s11, 1
  s_cbranch_scc0 HV12_spin
  s_waitcnt vmcnt(0)
  s_branch HV12_back
HC0_0_slow:
  s_waitcnt lgkmcnt(0)
  s_mov_b32 s11, 20000
  s_add_u32 s4, s24, 0xfffff000
  buffer_load_dwordx4 v[16:19], v5, s[60:63], s4 offen offset:0 sc1
  s_add_u32 s4, s25, 0xfffff000
  buffer_load_dwordx4 v[48:51], v5, s[60:63], s4 offen offset:0 sc1
HC0_0_spin:
  s_waitcnt vmcnt(0)
  v_max3_u32 v252, v16, v18, v48
  v_max_u32 v252, v252, v50
  v_cmp_eq_u32 vcc, -1, v252
  s_cbranch_vccz HC0_0_back
  s_add_u32 s4, s24, 0xfffff000
  buffer_load_dwordx4 v[16:19], v5, s[60:63], s4 offen offset:0 sc1
  s_add_u32 s4, s25, 0xfffff000
  buffer_load_dwordx4 v[48:51], v5, s[60:63], s4 offen offset:0 sc1
  s_sub_u32 s11, s11, 1
  s_cbranch_scc0 HC0_0_spin
  s_waitcnt vmcnt(0)
  s_branch HC0_0_back
HC0_1_slow:
  s_waitcnt lgkmcnt(0)
  s_mov_b32 s11, 20000
  s_add_u32 s4, s24, 0xfffff000
  buffer_load_dwordx4 v[80:83], v5, s[60:63], s4 offen offset:1024 sc1
  s_add_u32 s4, s25, 0xfffff000
  buffer_load_dwordx4 v[112:115], v5, s[60:63], s4 offen offset:1024 sc1
HC0_1_spin:
  s_waitcnt vmcnt(0)
  v_max3_u32 v252, v80, v82, v112
  v_max_u32 v252, v252, v114
  v_cmp_eq_u32 vcc, -1, v252
  s_cbranch_vccz HC0_1_back
  s_add_u32 s4, s24, 0xfffff000
  buffer_load_dwordx4 v[80:83], v5, s[60:63], s4 offen offset:1024 sc1
  s_add_u32 s4, s25, 0xfffff000
  buffer_load_dwordx4 v[112:115], v5, s[60:63], s4 offen offset:1024 sc1
  s_sub_u32 s11, s11, 1
  s_cbranch_scc0 HC0_1_spin
  s_waitcnt vmcnt(0)
  s_branch HC0_1_back
HC0_2_slow:
  s_waitcnt lgkmcnt(0)
  s_mov_b32 s11, 20000
  s_add_u32 s4, s24, 0xfffff000
  buffer_load_dwordx4 v[20:23], v5, s[60:63], s4 offen offset:2048 sc1
  s_add_u32 s4, s25, 0xfffff000
  buffer_load_dwordx4 v[52:55], v5, s[60:63], s4 offen offset:2048 sc1
HC0_2_spin:
  s_waitcnt vmcnt(0)
  v_max3_u32 v252, v20, v22, v52
  v_max_u32 v252, v252, v54
  v_cmp_eq_u32 vcc, -1, v252
  s_cbranch_vccz HC0_2_back
  s_add_u32 s4, s24, 0xfffff000
  buffer_load_dwordx4 v[20:23], v5, s[60:63], s4 offen offset:2048 sc1
  s_add_u32 s4, s25, 0xfffff000
  buffer_load_dwordx4 v[52:55], v5, s[60:63], s4 offen offset:2048 sc1
  s_sub_u32 s11, s11, 1
  s_cbranch_scc0 HC0_2_spin
  s_waitcnt vmcnt(0)
  s_branch HC0_2_back
HC0_3_slow:
  s_waitcnt lgkmcnt(0)
  s_mov_b32 s11, 20000
  s_add_u32 s4, s24, 0xffffe000
  buffer_load_dwordx4 v[84:87], v5, s[60:63], s4 offen offset:3072 sc1
  s_add_u32 s4, s25, 0xffffe000
  buffer_load_dwordx4 v[116:119], v5, s[60:63], s4 offen offset:3072 sc1
HC0_3_spin:
  s_waitcnt vmcnt(0)
  v_max3_u32 v252, v84, v86, v116
  v_max_u32 v252, v252, v118
  v_cmp_eq_u32 vcc, -1, v252
  s_cbranch_vccz HC0_3_back
  s_add_u32 s4, s24, 0xffffe000
  buffer_load_dwordx4 v[84:87], v5, s[60:63], s4 offen offset:3072 sc1
  s_add_u32 s4, s25, 0xffffe000
  buffer_load_dwordx4 v[116:119], v5, s[60:63], s4 offen offset:3072 sc1
  s_sub_u32 s11, s11, 1
  s_cbranch_scc0 HC0_3_spin
  s_waitcnt vmcnt(0)
  s_branch HC0_3_back
HC0_4_slow:
  s_waitcnt lgkmcnt(0)
  s_mov_b32 s11, 20000
  s_add_u32 s4, s24, 0xfffff000
  buffer_load_dwordx4 v[24:27], v5, s[60:63], s4 offen offset:0 sc1
  s_add_u32 s4, s25, 0xfffff000
  buffer_load_dwordx4 v[56:59], v5, s[60:63], s4 offen offset:0 sc1
HC0_4_spin:
  s_waitcnt vmcnt(0)
  v_max3_u32 v252, v24, v26, v56
  v_max_u32 v252, v252, v58
  v_cmp_eq_u32 vcc, -1, v252
  s_cbranch_vccz HC0_4_back
  s_add_u32 s4, s24, 0xfffff000
  buffer_load_dwordx4 v[24:27], v5, s[60:63], s4 offen offset:0 sc1
  s_add_u32 s4, s25, 0xfffff000
  buffer_load_dwordx4 v[56:59], v5, s[60:63], s4 offen offset:0 sc1
  s_sub_u32 s11, s11, 1
  s_cbranch_scc0 HC0_4_spin
  s_waitcnt vmcnt(0)
  s_branch HC0_4_back
HC0_5_slow:
  s_mov_b32 s11, 20000
  s_add_u32 s4, s24, 0xfffff000
  buffer_load_dwordx4 v[88:91], v5, s[60:63], s4 offen offset:1024 sc1
  s_add_u32 s4, s25, 0xfffff000
  buffer_load_dwordx4 v[28:31], v5, s[60:63], s4 offen offset:1024 sc1
HC0_5_spin:
  s_waitcnt vmcnt(0)
  v_max3_u32 v252, v88, v90, v28
  v_max_u32 v252, v252, v30
  v_cmp_eq_u32 vcc, -1, v252
  s_cbranch_vccz HC0_5_back
  s_add_u32 s4, s24, 0xfffff000
  buffer_load_dwordx4 v[88:91], v5, s[60:63], s4 offen offset:1024 sc1
  s_add_u32 s4, s25, 0xfffff000
  buffer_load_dwordx4 v[28:31], v5, s[60:63], s4 offen offset:1024 sc1
  s_sub_u32 s11, s11, 1
  s_cbranch_scc0 HC0_5_spin
  s_waitcnt vmcnt(0)
  s_branch HC0_5_back
HC0_6_slow:
  s_mov_b32 s11, 20000
  s_add_u32 s4, s24, 0xfffff000
  buffer_load_dwordx4 v[60:63], v5, s[60:63], s4 offen offset:2048 sc1
  s_add_u32 s4, s25, 0xfffff000
  buffer_load_dwordx4 v[92:95], v5, s[60:63], s4 offen offset:2048 sc1
HC0_6_spin:
  s_waitcnt vmcnt(0)
  v_max3_u32 v252, v60, v62, v92
  v_max_u32 v252, v252, v94
  v_cmp_eq_u32 vcc, -1, v252
  s_cbranch_vccz HC0_6_back
  s_add_u32 s4, s24, 0xfffff000
  buffer_load_dwordx4 v[60:63], v5, s[60:63], s4 offen offset:2048 sc1
  s_add_u32 s4, s25, 0xfffff000
  buffer_load_dwordx4 v[92:95], v5, s[60:63], s4 offen offset:2048 sc1
  s_sub_u32 s11, s11, 1
  s_cbranch_scc0 HC0_6_spin
  s_waitcnt vmcnt(0)
  s_branch HC0_6_back
HC0_7_slow:
  s_mov_b32 s11, 20000
  s_add_u32 s4, s24, 0xfffff000
  buffer_load_dwordx4 v[32:35], v5, s[60:63], s4 offen offset:3072 sc1
  s_add_u32 s4, s25, 0xfffff000
  buffer_load_dwordx4 v[64:67], v5, s[60:63], s4 offen offset:3072 sc1
HC0_7_spin:
  s_waitcnt vmcnt(0)
  v_max3_u32 v252, v32, v34, v64
  v_max_u32 v252, v252, v66
  v_cmp_eq_u32 vcc, -1, v252
  s_cbranch_vccz HC0_7_back
  s_add_u32 s4, s24, 0xfffff000
  buffer_load_dwordx4 v[32:35], v5, s[60:63], s4 offen offset:3072 sc1
  s_add_u32 s4, s25, 0xfffff000
  buffer_load_dwordx4 v[64:67], v5, s[60:63], s4 offen offset:3072 sc1
  s_sub_u32 s11, s11, 1
  s_cbranch_scc0 HC0_7_spin
  s_waitcnt vmcnt(0)
  s_branch HC0_7_back
HC0_8_slow:
  s_mov_b32 s11, 20000
  s_add_u32 s4, s24, 0x0
  buffer_load_dwordx4 v[96:99], v5, s[60:63], s4 offen offset:0 sc1
  s_add_u32 s4, s25, 0x0
  buffer_load_dwordx4 v[120:123], v5, s[60:63], s4 offen offset:0 sc1
HC0_8_spin:
  s_waitcnt vmcnt(0)
  v_max3_u32 v252, v96, v98, v120
  v_max_u32 v252, v252, v122
  v_cmp_eq_u32 vcc, -1, v252
  s_cbranch_vccz HC0_8_back
  s_add_u32 s4, s24, 0x0
  buffer_load_dwordx4 v[96:99], v5, s[60:63], s4 offen offset:0 sc1
  s_add_u32 s4, s25, 0x0
  buffer_load_dwordx4 v[120:123], v5, s[60:63], s4 offen offset:0 sc1
  s_sub_u32 s11, s11, 1
  s_cbranch_scc0 HC0_8_spin
  s_waitcnt vmcnt(0)
  s_branch HC0_8_back
HC0_9_slow:
  s_mov_b32 s11, 20000
  s_add_u32 s4, s24, 0xfffff000
  buffer_load_dwordx4 v[36:39], v5, s[60:63], s4 offen offset:1024 sc1
  s_add_u32 s4, s25, 0xfffff000
  buffer_load_dwordx4 v[68:71], v5, s[60:63], s4 offen offset:1024 sc1
HC0_9_spin:
  s_waitcnt vmcnt(0)
  v_max3_u32 v252, v36, v38, v68
  v_max_u32 v252, v252, v70
  v_cmp_eq_u32 vcc, -1, v252
  s_cbranch_vccz HC0_9_back
  s_add_u32 s4, s24, 0xfffff000
  buffer_load_dwordx4 v[36:39], v5, s[60:63], s4 offen offset:1024 sc1
  s_add_u32 s4, s25, 0xfffff000
  buffer_load_dwordx4 v[68:71], v5, s[60:63], s4 offen offset:1024 sc1
  s_sub_u32 s11, s11, 1
  s_cbranch_scc0 HC0_9_spin
  s_waitcnt vmcnt(0)
  s_branch HC0_9_back
HC0_10_slow:
  s_mov_b32 s11, 20000
  s_add_u32 s4, s24, 0xfffff000
  buffer_load_dwordx4 v[100:103], v5, s[60:63], s4 offen offset:2048 sc1
  s_add_u32 s4, s25, 0xfffff000
  buffer_load_dwordx4 v[124:127], v5, s[60:63], s4 offen offset:2048 sc1
HC0_10_spin:
  s_waitcnt vmcnt(0)
  v_max3_u32 v252, v100, v102, v124
  v_max_u32 v252, v252, v126
  v_cmp_eq_u32 vcc, -1, v252
  s_cbranch_vccz HC0_10_back
  s_add_u32 s4, s24, 0xfffff000
  buffer_load_dwordx4 v[100:103], v5, s[60:63], s4 offen offset:2048 sc1
  s_add_u32 s4, s25, 0xfffff000
  buffer_load_dwordx4 v[124:127], v5, s[60:63], s4 offen offset:2048 sc1
  s_sub_u32 s11, s11, 1
  s_cbranch_scc0 HC0_10_spin
  s_waitcnt vmcnt(0)
  s_branch HC0_10_back
HC0_11_slow:
  s_mov_b32 s11, 20000
  s_add_u32 s4, s24, 0xfffff000
  buffer_load_dwordx4 v[40:43], v5, s[60:63], s4 offen offset:3072 sc1
  s_add_u32 s4, s25, 0xfffff000
  buffer_load_dwordx4 v[72:75], v5, s[60:63], s4 offen offset:3072 sc1
HC0_11_spin:
  s_waitcnt vmcnt(0)
  v_max3_u32 v252, v40, v42, v72
  v_max_u32 v252, v252, v74
  v_cmp_eq_u32 vcc, -1, v252
  s_cbranch_vccz HC0_11_back
  s_add_u32 s4, s24, 0xfffff000
  buffer_load_dwordx4 v[40:43], v5, s[60:63], s4 offen offset:3072 sc1
  s_add_u32 s4, s25, 0xfffff000
  buffer_load_dwordx4 v[72:75], v5, s[60:63], s4 offen offset:3072 sc1
  s_sub_u32 s11, s11, 1
  s_cbranch_scc0 HC0_11_spin
  s_waitcnt vmcnt(0)
  s_branch HC0_11_back
HC0_12_slow:
  s_mov_b32 s11, 20000
  s_add_u32 s4, s24, 0x0
  buffer_load_dwordx4 v[104:107], v5, s[60:63], s4 offen offset:0 sc1
  s_add_u32 s4, s25, 0x0
  buffer_load_dwordx4 v[44:47], v5, s[60:63], s4 offen offset:0 sc1
HC0_12_spin:
  s_waitcnt vmcnt(0)
  v_max3_u32 v252, v104, v106, v44
  v_max_u32 v252, v252, v46
  v_cmp_eq_u32 vcc, -1, v252
  s_cbranch_vccz HC0_12_back
  s_add_u32 s4, s24, 0x0
  buffer_load_dwordx4 v[104:107], v5, s[60:63], s4 offen offset:0 sc1
  s_add_u32 s4, s25, 0x0
  buffer_load_dwordx4 v[44:47], v5, s[60:63], s4 offen offset:0 sc1
  s_sub_u32 s11, s11, 1
  s_cbranch_scc0 HC0_12_spin
  s_waitcnt vmcnt(0)
  s_branch HC0_12_back
HC0_13_slow:
  s_mov_b32 s11, 20000
  s_add_u32 s4, s24, 0x0
  buffer_load_dwordx4 v[76:79], v5, s[60:63], s4 offen offset:1024 sc1
  s_add_u32 s4, s25, 0x0
  buffer_load_dwordx4 v[108:111], v5, s[60:63], s4 offen offset:1024 sc1
HC0_13_spin:
  s_waitcnt vmcnt(0)
  v_max3_u32 v252, v76, v78, v108
  v_max_u32 v252, v252, v110
  v_cmp_eq_u32 vcc, -1, v252
  s_cbranch_vccz HC0_13_back
  s_add_u32 s4, s24, 0x0
  buffer_load_dwordx4 v[76:79], v5, s[60:63], s4 offen offset:1024 sc1
  s_add_u32 s4, s25, 0x0
  buffer_load_dwordx4 v[108:111], v5, s[60:63], s4 offen offset:1024 sc1
  s_sub_u32 s11, s11, 1
  s_cbranch_scc0 HC0_13_spin
  s_waitcnt vmcnt(0)
  s_branch HC0_13_back
HC1_0_slow:
  s_mov_b32 s11, 20000
  s_add_u32 s4, s26, 0xfffff000
  buffer_load_dwordx4 v[16:19], v5, s[60:63], s4 offen offset:0 sc1
  s_add_u32 s4, s27, 0xfffff000
  buffer_load_dwordx4 v[48:51], v5, s[60:63], s4 offen offset:0 sc1
HC1_0_spin:
  s_waitcnt vmcnt(0)
  v_max3_u32 v252, v16, v18, v48
  v_max_u32 v252, v252, v50
  v_cmp_eq_u32 vcc, -1, v252
  s_cbranch_vccz HC1_0_back
  s_add_u32 s4, s26, 0xfffff000
  buffer_load_dwordx4 v[16:19], v5, s[60:63], s4 offen offset:0 sc1
  s_add_u32 s4, s27, 0xfffff000
  buffer_load_dwordx4 v[48:51], v5, s[60:63], s4 offen offset:0 sc1
  s_sub_u32 s11, s11, 1
  s_cbranch_scc0 HC1_0_spin
  s_waitcnt vmcnt(0)
  s_branch HC1_0_back
HC1_1_slow:
  s_waitcnt lgkmcnt(0)
  s_mov_b32 s11, 20000
  s_add_u32 s4, s26, 0xfffff000
  buffer_load_dwordx4 v[80:83], v5, s[60:63], s4 offen offset:1024 sc1
  s_add_u32 s4, s27, 0xfffff000
  buffer_load_dwordx4 v[112:115], v5, s[60:63], s4 offen offset:1024 sc1
HC1_1_spin:
  s_waitcnt vmcnt(0)
  v_max3_u32 v252, v80, v82, v112
  v_max_u32 v252, v252, v114
  v_cmp_eq_u32 vcc, -1, v252
  s_cbranch_vccz HC1_1_back
  s_add_u32 s4, s26, 0xfffff000
  buffer_load_dwordx4 v[80:83], v5, s[60:63], s4 offen offset:1024 sc1
  s_add_u32 s4, s27, 0xfffff000
  buffer_load_dwordx4 v[112:115], v5, s[60:63], s4 offen offset:1024 sc1
  s_sub_u32 s11, s11, 1
  s_cbranch_scc0 HC1_1_spin
  s_waitcnt vmcnt(0)
  s_branch HC1_1_back
HC1_2_slow:
  s_waitcnt lgkmcnt(0)
  s_mov_b32 s11, 20000
  s_add_u32 s4, s26, 0xfffff000
  buffer_load_dwordx4 v[20:23], v5, s[60:63], s4 offen offset:2048 sc1
  s_add_u32 s4, s27, 0xfffff000
  buffer_load_dwordx4 v[52:55], v5, s[60:63], s4 offen offset:2048 sc1
HC1_2_spin:
  s_waitcnt vmcnt(0)
  v_max3_u32 v252, v20, v22, v52
  v_max_u32 v252, v252, v54
  v_cmp_eq_u32 vcc, -1, v252
  s_cbranch_vccz HC1_2_back
  s_add_u32 s4, s26, 0xfffff000
  buffer_load_dwordx4 v[20:23], v5, s[60:63], s4 offen offset:2048 sc1
  s_add_u32 s4, s27, 0xfffff000
  buffer_load_dwordx4 v[52:55], v5, s[60:63], s4 offen offset:2048 sc1
  s_sub_u32 s11, s11, 1
  s_cbranch_scc0 HC1_2_spin
  s_waitcnt vmcnt(0)
  s_branch HC1_2_back
HC1_3_slow:
  s_waitcnt lgkmcnt(0)
  s_mov_b32 s11, 20000
  s_add_u32 s4, s26, 0xffffe000
  buffer_load_dwordx4 v[84:87], v5, s[60:63], s4 offen offset:3072 sc1
  s_add_u32 s4, s27, 0xffffe000
  buffer_load_dwordx4 v[116:119], v5, s[60:63], s4 offen offset:3072 sc1
HC1_3_spin:
  s_waitcnt vmcnt(0)
  v_max3_u32 v252, v84, v86, v116
  v_max_u32 v252, v252, v118
  v_cmp_eq_u32 vcc, -1, v252
  s_cbranch_vccz HC1_3_back
  s_add_u32 s4, s26, 0xffffe000
  buffer_load_dwordx4 v[84:87], v5, s[60:63], s4 offen offset:3072 sc1
  s_add_u32 s4, s27, 0xffffe000
  buffer_load_dwordx4 v[116:119], v5, s[60:63], s4 offen offset:3072 sc1
  s_sub_u32 s11, s11, 1
  s_cbranch_scc0 HC1_3_spin
  s_waitcnt vmcnt(0)
  s_branch HC1_3_back
HC1_4_slow:
  s_waitcnt lgkmcnt(0)
  s_mov_b32 s11, 20000
  s_add_u32 s4, s26, 0xfffff000
  buffer_load_dwordx4 v[24:27], v5, s[60:63], s4 offen offset:0 sc1
  s_add_u32 s4, s27, 0xfffff000
  buffer_load_dwordx4 v[56:59], v5, s[60:63], s4 offen offset:0 sc1
HC1_4_spin:
  s_waitcnt vmcnt(0)
  v_max3_u32 v252, v24, v26, v56
  v_max_u32 v252, v252, v58
  v_cmp_eq_u32 vcc, -1, v252
  s_cbranch_vccz HC1_4_back
  s_add_u32 s4, s26, 0xfffff000
  buffer_load_dwordx4 v[24:27], v5, s[60:63], s4 offen offset:0 sc1
  s_add_u32 s4, s27, 0xfffff000
  buffer_load_dwordx4 v[56:59], v5, s[60:63], s4 offen offset:0 sc1
  s_sub_u32 s11, s11, 1
  s_cbranch_scc0 HC1_4_spin
  s_waitcnt vmcnt(0)
  s_branch HC1_4_back
HC1_5_slow:
  s_waitcnt lgkmcnt(0)
  s_mov_b32 s11, 20000
  s_add_u32 s4, s26, 0xfffff000
  buffer_load_dwordx4 v[88:91], v5, s[60:63], s4 offen offset:1024 sc1
  s_add_u32 s4, s27, 0xfffff000
  buffer_load_dwordx4 v[28:31], v5, s[60:63], s4 offen offset:1024 sc1
HC1_5_spin:
  s_waitcnt vmcnt(0)
  v_max3_u32 v252, v88, v90, v28
  v_max_u32 v252, v252, v30
  v_cmp_eq_u32 vcc, -1, v252
  s_cbranch_vccz HC1_5_back
  s_add_u32 s4, s26, 0xfffff000
  buffer_load_dwordx4 v[88:91], v5, s[60:63], s4 offen offset:1024 sc1
  s_add_u32 s4, s27, 0xfffff000
  buffer_load_dwordx4 v[28:31], v5, s[60:63], s4 offen offset:1024 sc1
  s_sub_u32 s11, s11, 1
  s_cbranch_scc0 HC1_5_spin
  s_waitcnt vmcnt(0)
  s_branch HC1_5_back
HC1_6_slow:
  s_mov_b32 s11, 20000
  s_add_u32 s4, s26, 0xffffe000
  buffer_load_dwordx4 v[60:63], v5, s[60:63], s4 offen offset:2048 sc1
  s_add_u32 s4, s27, 0xfffff000
  buffer_load_dwordx4 v[92:95], v5, s[60:63], s4 offen offset:2048 sc1
HC1_6_spin:
  s_waitcnt vmcnt(0)
  v_max3_u32 v252, v60, v62, v92
  v_max_u32 v252, v252, v94
  v_cmp_eq_u32 vcc, -1, v252
  s_cbranch_vccz HC1_6_back
  s_add_u32 s4, s26, 0xffffe000
  buffer_load_dwordx4 v[60:63], v5, s[60:63], s4 offen offset:2048 sc1
  s_add_u32 s4, s27, 0xfffff000
  buffer_load_dwordx4 v[92:95], v5, s[60:63], s4 offen offset:2048 sc1
  s_sub_u32 s11, s11, 1
  s_cbranch_scc0 HC1_6_spin
  s_waitcnt vmcnt(0)
  s_branch HC1_6_back
SQC_slow:
  s_mov_b32 s11, 20000
  buffer_load_dwordx4 v[136:139], v2, s[60:63], s29 offen offset:0 sc1
  buffer_load_dwordx4 v[140:143], v2, s[60:63], s29 offen offset:16 sc1
SQC_spin:
  s_waitcnt vmcnt(0)
  v_max3_u32 v252, v136, v137, v138
  v_max3_u32 v252, v252, v139, v140
  v_max3_u32 v252, v252, v141, v142
  v_max_u32 v252, v252, v143
  v_cmp_eq_u32 vcc, -1, v252
  s_cbranch_vccz SQC_back
  buffer_load_dwordx4 v[136:139], v2, s[60:63], s29 offen offset:0 sc1
  buffer_load_dwordx4 v[140:143], v2, s[60:63], s29 offen offset:16 sc1
  s_sub_u32 s11, s11, 1
  s_cbranch_scc0 SQC_spin
  s_waitcnt vmcnt(0)
  s_branch SQC_back
HC1_7_slow:
  s_mov_b32 s11, 20000
  s_add_u32 s4, s26, 0xffffe000
  buffer_load_dwordx4 v[32:35], v5, s[60:63], s4 offen offset:3072 sc1
  s_add_u32 s4, s27, 0xffffe000
  buffer_load_dwordx4 v[64:67], v5, s[60:63], s4 offen offset:3072 sc1
HC1_7_spin:
  s_waitcnt vmcnt(0)
  v_max3_u32 v252, v32, v34, v64
  v_max_u32 v252, v252, v66
  v_cmp_eq_u32 vcc, -1, v252
  s_cbranch_vccz HC1_7_back
  s_add_u32 s4, s26, 0xffffe000
  buffer_load_dwordx4 v[32:35], v5, s[60:63], s4 offen offset:3072 sc1
  s_add_u32 s4, s27, 0xffffe000
  buffer_load_dwordx4 v[64:67], v5, s[60:63], s4 offen offset:3072 sc1
  s_sub_u32 s11, s11, 1
  s_cbranch_scc0 HC1_7_spin
  s_waitcnt vmcnt(0)
  s_branch HC1_7_back
HC1_8_slow:
  s_mov_b32 s11, 20000
  s_add_u32 s4, s26, 0xfffff000
  buffer_load_dwordx4 v[96:99], v5, s[60:63], s4 offen offset:0 sc1
  s_add_u32 s4, s27, 0xfffff000
  buffer_load_dwordx4 v[120:123], v5, s[60:63], s4 offen offset:0 sc1
HC1_8_spin:
  s_waitcnt vmcnt(0)
  v_max3_u32 v252, v96, v98, v120
  v_max_u32 v252, v252, v122
  v_cmp_eq_u32 vcc, -1, v252
  s_cbranch_vccz HC1_8_back
  s_add_u32 s4, s26, 0xfffff000
  buffer_load_dwordx4 v[96:99], v5, s[60:63], s4 offen offset:0 sc1
  s_add_u32 s4, s27, 0xfffff000
  buffer_load_dwordx4 v[120:123], v5, s[60:63], s4 offen offset:0 sc1
  s_sub_u32 s11, s11, 1
  s_cbranch_scc0 HC1_8_spin
  s_waitcnt vmcnt(0)
  s_branch HC1_8_back
HC1_9_slow:
  s_mov_b32 s11, 20000
  s_add_u32 s4, s26, 0xfffff000
  buffer_load_dwordx4 v[36:39], v5, s[60:63], s4 offen offset:1024 sc1
  s_add_u32 s4, s27, 0xfffff000
  buffer_load_dwordx4 v[68:71], v5, s[60:63], s4 offen offset:1024 sc1
HC1_9_spin:
  s_waitcnt vmcnt(0)
  v_max3_u32 v252, v36, v38, v68
  v_max_u32 v252, v252, v70
  v_cmp_eq_u32 vcc, -1, v252
  s_cbranch_vccz HC1_9_back
  s_add_u32 s4, s26, 0xfffff000
  buffer_load_dwordx4 v[36:39], v5, s[60:63], s4 offen offset:1024 sc1
  s_add_u32 s4, s27, 0xfffff000
  buffer_load_dwordx4 v[68:71], v5, s[60:63], s4 offen offset:1024 sc1
  s_sub_u32 s11, s11, 1
  s_cbranch_scc0 HC1_9_spin
  s_waitcnt vmcnt(0)
  s_branch HC1_9_back
HC1_10_slow:
  s_mov_b32 s11, 20000
  s_add_u32 s4, s26, 0xfffff000
  buffer_load_dwordx4 v[100:103], v5, s[60:63], s4 offen offset:2048 sc1
  s_add_u32 s4, s27, 0xfffff000
  buffer_load_dwordx4 v[124:127], v5, s[60:63], s4 offen offset:2048 sc1
HC1_10_spin:
  s_waitcnt vmcnt(0)
  v_max3_u32 v252, v100, v102, v124
  v_max_u32 v252, v252, v126
  v_cmp_eq_u32 vcc, -1, v252
  s_cbranch_vccz HC1_10_back
  s_add_u32 s4, s26, 0xfffff000
  buffer_load_dwordx4 v[100:103], v5, s[60:63], s4 offen offset:2048 sc1
  s_add_u32 s4, s27, 0xfffff000
  buffer_load_dwordx4 v[124:127], v5, s[60:63], s4 offen offset:2048 sc1
  s_sub_u32 s11, s11, 1
  s_cbranch_scc0 HC1_10_spin
  s_waitcnt vmcnt(0)
  s_branch HC1_10_back
HC1_11_slow:
  s_mov_b32 s11, 20000
  s_add_u32 s4, s26, 0xfffff000
  buffer_load_dwordx4 v[40:43], v5, s[60:63], s4 offen offset:3072 sc1
  s_add_u32 s4, s27, 0xfffff000
  buffer_load_dwordx4 v[72:75], v5, s[60:63], s4 offen offset:3072 sc1
HC1_11_spin:
  s_waitcnt vmcnt(0)
  v_max3_u32 v252, v40, v42, v72
  v_max_u32 v252, v252, v74
  v_cmp_eq_u32 vcc, -1, v252
  s_cbranch_vccz HC1_11_back
  s_add_u32 s4, s26, 0xfffff000
  buffer_load_dwordx4 v[40:43], v5, s[60:63], s4 offen offset:3072 sc1
  s_add_u32 s4, s27, 0xfffff000
  buffer_load_dwordx4 v[72:75], v5, s[60:63], s4 offen offset:3072 sc1
  s_sub_u32 s11, s11, 1
  s_cbranch_scc0 HC1_11_spin
  s_waitcnt vmcnt(0)
  s_branch HC1_11_back
HC1_12_slow:
  s_mov_b32 s11, 20000
  s_add_u32 s4, s26, 0x0
  buffer_load_dwordx4 v[104:107], v5, s[60:63], s4 offen offset:0 sc1
  s_add_u32 s4, s27, 0x0
  buffer_load_dwordx4 v[44:47], v5, s[60:63], s4 offen offset:0 sc1
HC1_12_spin:
  s_waitcnt vmcnt(0)
  v_max3_u32 v252, v104, v106, v44
  v_max_u32 v252, v252, v46
  v_cmp_eq_u32 vcc, -1, v252
  s_cbranch_vccz HC1_12_back
  s_add_u32 s4, s26, 0x0
  buffer_load_dwordx4 v[104:107], v5, s[60:63], s4 offen offset:0 sc1
  s_add_u32 s4, s27, 0x0
  buffer_load_dwordx4 v[44:47], v5, s[60:63], s4 offen offset:0 sc1
  s_sub_u32 s11, s11, 1
  s_cbranch_scc0 HC1_12_spin
  s_waitcnt vmcnt(0)
  s_branch HC1_12_back
HC1_13_slow:
  s_mov_b32 s11, 20000
  s_add_u32 s4, s26, 0x0
  buffer_load_dwordx4 v[76:79], v5, s[60:63], s4 offen offset:1024 sc1
  s_add_u32 s4, s27, 0x0
  buffer_load_dwordx4 v[108:111], v5, s[60:63], s4 offen offset:1024 sc1
HC1_13_spin:
  s_waitcnt vmcnt(0)
  v_max3_u32 v252, v76, v78, v108
  v_max_u32 v252, v252, v110
  v_cmp_eq_u32 vcc, -1, v252
  s_cbranch_vccz HC1_13_back
  s_add_u32 s4, s26, 0x0
  buffer_load_dwordx4 v[76:79], v5, s[60:63], s4 offen offset:1024 sc1
  s_add_u32 s4, s27, 0x0
  buffer_load_dwordx4 v[108:111], v5, s[60:63], s4 offen offset:1024 sc1
  s_sub_u32 s11, s11, 1
  s_cbranch_scc0 HC1_13_spin
  s_waitcnt vmcnt(0)
  s_branch HC1_13_back
CODE_END:
.section .rodata,"a"
.p2align 6
.amdhsa_kernel sequential_preLN__ssm_conv_h3__glu_gated_reglu__prompt_kernel
  .amdhsa_next_free_vgpr 512
  .amdhsa_next_free_sgpr 102
  .amdhsa_accum_offset 256
  .amdhsa_group_segment_fixed_size 0
  .amdhsa_kernarg_size 104
  .amdhsa_user_sgpr_count 2
  .amdhsa_user_sgpr_kernarg_segment_ptr 1
  .amdhsa_system_sgpr_workgroup_id_x 1
.end_amdhsa_kernel
```
